```python
import torch

def _softmax(x, axis=-1):
    return torch.softmax(x, dim=axis)
def _gelu(x):
    return torch.nn.functional.gelu(x, approximate="tanh")
def _silu(x):
    return torch.nn.functional.silu(x)
def _sigmoid(x):
    return torch.sigmoid(x)
def _layernorm(x, axis=-1, eps=1e-5):
    m = x.mean(dim=axis, keepdim=True)
    v = x.var(dim=axis, keepdim=True, unbiased=False)
    return (x - m) / torch.sqrt(v + eps)
def _scatter_add(tgt, idx, src, axis=0):
    return tgt.clone().index_add_(axis, idx, src)
def _segment_sum(src, seg, n):
    out = torch.zeros((n,) + src.shape[1:], dtype=src.dtype)
    return out.index_add_(0, seg, src)
def _pad(x, pw):
    flat = tuple(v for pair in reversed(pw) for v in pair)
    return torch.nn.functional.pad(x, flat)

kernel_name = 'parallel_sum__linear_kernel_hedgehog__dense_activation_gelu__prompt'

def setup_inputs():

    _w = (lambda a: (lambda t: t.to(torch.bfloat16) if t.is_floating_point() else t)(torch.as_tensor(a)))
    def _A_setup():
        B, S, D, H = 1, 2048, 512, 32
        Dh = D // H
        return {
            "x": _w((lambda *s: torch.randn(*s, dtype=torch.bfloat16) * 0.05)(B, S, D)),
            "wqkv": _w((lambda *s: torch.randn(*s, dtype=torch.bfloat16) * 0.2)(D, 3 * D)),
            "w_phi": _w((lambda *s: torch.randn(*s, dtype=torch.bfloat16) * 0.2)(H, Dh, Dh) * (Dh ** -0.5)),
            "wo": _w((lambda *s: torch.randn(*s, dtype=torch.bfloat16) * 0.05)(D, D)),
        }
    _A_in = _A_setup()

    def _B_setup():
        B, S, D, F = 1, 2048, 512, 1376
        return {
            "x": _w((lambda *s: torch.randn(*s, dtype=torch.bfloat16) * 0.05)(B, S, D)),
            "w1": _w((lambda *s: torch.randn(*s, dtype=torch.bfloat16) * 0.8)(D, F) * (D ** -0.5)),
            "b1": _w((lambda *s: torch.randn(*s, dtype=torch.bfloat16) * 12.8)(F) * 0.01),
            "w2": _w((lambda *s: torch.randn(*s, dtype=torch.bfloat16) * 0.4)(F, D) * (F ** -0.5)),
            "b2": _w((lambda *s: torch.randn(*s, dtype=torch.bfloat16) * 6.4)(D) * 0.01),
        }
    _B_in = _B_setup()

    return {
        "A_x": _A_in["x"],
        "A_wqkv": _A_in["wqkv"],
        "A_w_phi": _A_in["w_phi"],
        "A_wo": _A_in["wo"],
        "B_x": _B_in["x"],
        "B_w1": _B_in["w1"],
        "B_b1": _B_in["b1"],
        "B_w2": _B_in["w2"],
        "B_b2": _B_in["b2"],
    }

def reference(A_x, A_wqkv, A_w_phi, A_wo, B_x, B_w1, B_b1, B_w2, B_b2):
    def _A_ref(x, wqkv, w_phi, wo):
        B, S, D = x.shape
        H = 32; Dh = D // H
        qkv = (lambda x, *d: x.permute(*d))((x @ wqkv).reshape(B, S, 3, H, Dh), 2, 0, 3, 1, 4)
        q, k, v = qkv[0], qkv[1], qkv[2]
        pq = torch.einsum("bhsd,hdf->bhsf", q, w_phi)
        pk = torch.einsum("bhsd,hdf->bhsf", k, w_phi)
        phi_q = torch.concatenate([_softmax(pq, axis=-1), _softmax(-pq, axis=-1)], axis=-1)
        phi_k = torch.concatenate([_softmax(pk, axis=-1), _softmax(-pk, axis=-1)], axis=-1)
        kv = torch.einsum("bhsf,bhsd->bhfd", phi_k, v)
        z  = torch.einsum("bhsf->bhf", phi_k)
        num = torch.einsum("bhqf,bhfd->bhqd", phi_q, kv)
        den = torch.einsum("bhqf,bhf->bhq", phi_q, z)[..., None] + 1e-6
        o = num / den
        return (lambda x, *d: x.permute(*d))(o, 0, 2, 1, 3).reshape(B, S, D) @ wo

    def _B_ref(x, w1, b1, w2, b2):
        h = torch.einsum("bsd,df->bsf", x, w1) + b1
        h = _gelu(h)
        return torch.einsum("bsf,fd->bsd", h, w2) + b2

    x = A_x
    xn = _layernorm(x, axis=-1)
    return x + _A_ref(xn, A_wqkv, A_w_phi, A_wo) + _B_ref(xn, B_w1, B_b1, B_w2, B_b2)
```

```asm
; @launch grid=(256,1,1) block=(256,1,1) lds=163840
.amdgcn_target "amdgcn-amd-amdhsa--gfx950"
.text
.p2align 12
.globl parallel_sum__linear_kernel_hedgehog__dense_activation_gelu__prompt_kernel
.p2align 8
.type parallel_sum__linear_kernel_hedgehog__dense_activation_gelu__prompt_kernel,@function
parallel_sum__linear_kernel_hedgehog__dense_activation_gelu__prompt_kernel:
    s_cmp_ge_u32 s2, 256
    s_cbranch_scc1 L_end
    s_load_dwordx16 s[40:55], s[0:1], 0
    s_load_dwordx8 s[56:63], s[0:1], 64
    s_lshr_b32 s7, s2, 3
    s_getpc_b64 s[72:73]
L_pc:
    s_sub_u32 s72, s72, L_pc-parallel_sum__linear_kernel_hedgehog__dense_activation_gelu__prompt_kernel
    s_subb_u32 s73, s73, 0
    s_lshl_b32 s70, s7, 11
    v_lshrrev_b32 v1, 4, v0
    v_lshl_add_u32 v1, v1, 7, s70
    v_min_u32 v1, L_end-parallel_sum__linear_kernel_hedgehog__dense_activation_gelu__prompt_kernel, v1
    global_load_dword v40, v1, s[72:73]
    v_lshrrev_b32 v1, 6, v0
    v_and_b32 v0, 63, v0
    v_readfirstlane_b32 s3, v1
    v_lshlrev_b32 v1, 4, v0
    s_and_b32 s70, s2, 7
    s_lshr_b32 s64, s7, 2
    s_and_b32 s6, s7, 3
    s_and_b32 s4, s70, 1
    s_lshl3_add_u32 s4, s4, s64
    s_lshr_b32 s65, s70, 1
    s_andn2_b32 s72, 1, s70
    s_lshl2_add_u32 s70, s72, s65
    s_lshr_b32 s72, s7, 3
    s_lshl2_add_u32 s66, s70, s72
    s_lshl2_add_u32 s70, s4, s65
    s_lshl_b32 s74, s70, 15
    s_lshl2_add_u32 s73, s6, s3
    s_lshl_b32 s70, s73, 11
    s_add_u32 s84, s74, s70
    s_lshl_b32 s69, s4, 11
    s_add_u32 s69, s69, 32768
    s_lshl4_add_u32 s73, s65, s73
    s_lshl_b32 s73, s73, 5
    s_add_u32 s68, s73, s69
    v_and_b32 v7, 0x70, v1
    v_and_b32 v3, 0x30, v0
    v_xor_b32 v2, v7, v3
    v_lshrrev_b32 v3, 3, v0
    v_lshl_add_u32 v3, v3, 10, v2
    v_xor_b32_e64 v6, 64, v3
    v_add_u32 v6, 21504, v6
    v_xor_b32_e64 v5, 0, v3
    v_add_u32 v5, 14336, v5
    v_xor_b32_e64 v4, 64, v3
    v_add_u32 v4, 7168, v4
    s_lshr_b32 s71, s3, 1
    s_add_u32 s70, s65, s71
    s_and_b32 s70, s70, 3
    s_lshl2_add_u32 s70, s4, s70
    s_lshl_b32 s75, s70, 15
    s_and_b32 s70, s3, 1
    s_lshl3_add_u32 s71, s71, s70
    s_lshl_b32 s82, s71, 12
    s_add_u32 s70, s70, s64
    s_lshl_b32 s70, s70, 7
    s_and_b32 s83, s70, 0x380
    s_mov_b32 s10, 2097152
    s_mov_b32 s11, 0x20000
    s_mov_b32 s18, 0x10000000
    s_mov_b32 s19, 0x20000
    s_waitcnt lgkmcnt(0)
    s_mov_b64 s[8:9], s[40:41]
    s_mov_b64 s[16:17], s[62:63]
    s_load_dword s86, s[62:63], 0
    buffer_load_dwordx4 v[48:51], v1, s[8:11], s84 offen offset:0
    s_and_b32 s5, s6, 1
    buffer_load_dwordx4 v[52:55], v1, s[8:11], s84 offen offset:1024
    s_lshl1_add_u32 s5, s65, s5
    s_lshl_b32 s97, s3, 12
    s_mov_b32 s70, 0x100b0600
    s_add_u32 m0, s82, 0
    s_add_u32 s0, s75, s83
    buffer_load_dwordx4 v3, s[8:11], s0 offen offset:0 lds
    s_mov_b32 s71, 0x26201b16
    s_lshl_b32 s72, s5, 3
    s_lshr_b64 s[70:71], s[70:71], s72
    s_and_b32 s94, s70, 0xff
    s_lshl_b32 s91, s94, 6
    buffer_load_dwordx4 v4, s[8:11], s0 offen offset:1024 lds
    s_lshl_b32 s73, s5, 7
    s_add_u32 s73, s73, 1024
    s_movk_i32 s70, 2752
    s_movk_i32 s72, 128
    s_mov_b32 s15, 0x20000
    s_cmp_lt_u32 s6, 2
    s_cselect_b32 s91, s73, s91
    s_cselect_b32 s70, 3072, s70
    s_cselect_b32 s71, 1, 2
    s_cselect_b32 s72, 1024, s72
    s_cselect_b32 s96, 7, 5
    buffer_load_dwordx4 v5, s[8:11], s0 offen offset:2048 lds
    s_lshl_b32 s14, s70, 9
    s_mul_i32 s73, s3, s70
    s_mov_b32 s85, s91
    s_lshl4_add_u32 s91, s73, s91
    s_lshl_b32 s95, s70, 6
    buffer_load_dwordx4 v6, s[8:11], s0 offen offset:3072 lds
    v_lshrrev_b32 v16, 4, v0
    v_and_b32 v17, 15, v0
    v_lshlrev_b32 v19, s71, v16
    v_xor_b32 v17, v17, v19
    v_mul_u32_u24 v16, s70, v16
    v_lshrrev_b32 v19, 3, v17
    v_mad_u32_u24 v16, v19, s72, v16
    v_and_b32 v17, 7, v17
    v_lshl_add_u32 v136, v17, 4, v16
    s_lshl_b32 s70, s70, 2
    s_sub_u32 s70, s70, 1024
    v_add_u32 v137, s70, v136
    v_add_u32 v138, s70, v137
    v_add_u32 v139, s70, v138
    s_cmp_lt_u32 s6, 2
    s_cselect_b64 s[12:13], s[42:43], s[50:51]
    v_and_b32 v16, 31, v0
    s_add_u32 s0, s64, 0
    s_and_b32 s0, s0, 7
    s_mul_i32 s0, s0, s95
    s_add_u32 m0, s97, 131072
    s_add_u32 s0, s0, s91
    buffer_load_dwordx4 v136, s[12:15], s0 offen offset:0 lds
    v_lshlrev_b32 v10, 4, v16
    v_lshlrev_b32_e64 v17, 7, v16
    v_bfe_u32 v16, v0, 1, 3
    buffer_load_dwordx4 v137, s[12:15], s0 offen offset:1024 lds
    v_lshrrev_b32 v18, 5, v0
    v_xor_b32 v16, v16, v18
    v_lshl_add_u32 v11, v16, 4, v17
    buffer_load_dwordx4 v138, s[12:15], s0 offen offset:2048 lds
    v_xor_b32 v12, 32, v11
    v_xor_b32 v13, 64, v11
    v_xor_b32 v14, 96, v11
    buffer_load_dwordx4 v139, s[12:15], s0 offen offset:3072 lds
    v_bfe_u32 v64, v0, 2, 2
    v_bfe_u32 v65, v0, 4, 1
    s_add_u32 s71, s71, 4
    v_and_b32 v66, 16, v1
    v_and_b32_e64 v67, 2, v0
    v_lshl_add_u32 v66, v67, 2, v66
    v_lshl_add_u32 v67, v18, 3, v64
    v_xor_b32 v68, s3, v64
    v_lshl_add_u32 v68, v68, s71, v66
    v_lshl_add_u32 v68, v65, s96, v68
    v_cmp_eq_u32 vcc, v64, v65
    v_mov_b32 v17, 0x3f803f80
    v_lshl_add_u32 v68, v67, 8, v68
    v_add_u32 v25, 65536, v68
    v_add_u32 v26, 131072, v68
    v_cndmask_b32 v144, 0, v17, vcc
    v_cndmask_b32 v145, 0, v17, vcc
    v_cndmask_b32 v146, 0, v17, vcc
    v_cndmask_b32 v147, 0, v17, vcc
    s_xor_b32 s67, s7, 2
    s_and_b32 s67, s67, 7
    s_lshl_b32 s67, s67, 7
    s_lshl_b32 s93, s3, 14
    s_lshl_b32 s92, s3, 13
    v_mov_b32_e64 v33, 0
    s_and_b32 s70, s3, 1
    s_cmp_eq_u32 s70, 1
    s_cselect_b64 s[98:99], -1, 0
    s_add_u32 s70, s65, 0
    s_and_b32 s70, s70, 3
    s_lshl2_add_u32 s70, s4, s70
    s_mul_i32 s78, s70, 120832
    s_add_u32 s78, s78, 2097152
    s_add_u32 s70, s65, 1
    s_and_b32 s70, s70, 3
    s_lshl2_add_u32 s70, s4, s70
    s_mul_i32 s79, s70, 120832
    s_add_u32 s79, s79, 2097152
    s_add_u32 s70, s65, 2
    s_and_b32 s70, s70, 3
    s_lshl2_add_u32 s70, s4, s70
    s_lshl_b32 s76, s70, 15
    s_mul_i32 s80, s70, 120832
    s_add_u32 s80, s80, 2097152
    s_add_u32 s70, s65, 3
    s_and_b32 s70, s70, 3
    s_lshl2_add_u32 s70, s4, s70
    s_lshl_b32 s77, s70, 15
    s_mul_i32 s81, s70, 120832
    s_add_u32 s81, s81, 2097152
    s_mov_b32 s36, s56
    s_mov_b32 s37, s57
    s_mov_b32 s38, 1024
    s_mov_b32 s39, 0x20000
    s_mov_b32 s20, s54
    s_mov_b32 s21, s55
    s_mov_b32 s22, 1409024
    s_mov_b32 s23, 0x20000
    s_mov_b32 s24, s46
    s_mov_b32 s25, s47
    s_mov_b32 s26, 524288
    s_mov_b32 s27, 0x20000
    s_mov_b32 s28, s58
    s_mov_b32 s29, s59
    s_mov_b32 s30, 2097152
    s_mov_b32 s31, 0x20000
    s_cmp_ge_u32 s6, 2
    s_cbranch_scc1 L_ffn
    s_branch L_att
    .p2align 12
L_att:
    s_lshl2_add_u32 s6, s5, s3
    s_lshl_b32 s73, s94, 6
    s_add_u32 s73, s73, 256
    s_lshr_b32 s71, s3, 1
    s_add_u32 s95, s94, s71
    s_add_u32 s95, s95, 4
    s_mov_b32 s32, s44
    s_mov_b32 s33, s45
    s_mov_b32 s34, 16384
    s_mov_b32 s35, 0x20000
    v_and_b32 v164, 0x13, v0
    v_and_b32_e64 v165, 4, v0
    v_lshl_add_u32 v164, v165, 1, v164
    v_bfe_u32 v165, v0, 3, 1
    v_lshl_add_u32 v164, v165, 2, v164
    v_and_b32_e64 v165, 32, v0
    v_lshl_add_u32 v164, v165, 8, v164
    v_lshlrev_b32 v164, 1, v164
    v_bfe_u32 v68, v0, 1, 1
    buffer_load_dwordx4 v[44:47], v7, s[36:39], s67 offen
    v_lshl_add_u32 v68, v65, 1, v68
    s_mov_b64 s[36:37], s[52:53]
    s_movk_i32 s38, 2752
    s_lshl_b32 s0, s95, 6
    buffer_load_ushort v163, v164, s[36:39], s0 offen
    v_lshlrev_b32 v68, 3, v68
    s_mov_b64 s[36:37], s[50:51]
    s_mov_b32 s38, 1409024
    s_lshr_b32 s0, s6, 1
    s_add_u32 m0, s97, 114688
    s_lshl_b32 s0, s0, 10
    buffer_load_dwordx4 v1, s[32:35], s0 offen lds
    v_lshl_add_u32 v68, v67, 5, v68
    s_and_b32 s72, s98, 0x200
    s_add_u32 s70, s97, s72
    s_add_u32 s70, s70, 114688
    v_add_u32 v176, s70, v68
    v_xor_b32 v177, 0x200, v176
    s_movk_i32 s71, 2752
    s_mul_i32 s84, s64, 176128
    s_lshl_b32 s85, s3, 11
    s_mul_i32 s70, s3, 44032
    s_add_u32 s73, s73, s70
    v_lshrrev_b32 v16, 3, v0
    v_lshlrev_b32 v17, 2, v0
    v_and_b32 v17, 64, v17
    v_xor_b32 v17, v17, v7
    v_mad_u32_u24 v20, v16, s71, v17
    v_add_u32 v20, s73, v20
    s_lshr_b32 s72, 182, s5
    s_and_b32 s72, s72, 1
    s_lshl_b32 s72, s72, 6
    v_and_b32_e64 v21, s72, v17
    v_lshl_add_u32 v20, v21, 20, v20
    v_add_u32 v21, 20992, v20
    v_lshl_add_u32 v27, v16, 10, v17
    v_lshl_add_u32 v19, v18, 9, v10
    v_lshlrev_b32_e64 v18, 5, v18
    v_add_u32 v18, 0x400, v18
    v_cmp_gt_u32 vcc, 0x100, v10
    v_add_u32 v16, 16, v18
    v_add_u32 v17, 0x100, v19
    v_cndmask_b32 v34, v18, v19, vcc
    v_cndmask_b32 v35, v16, v17, vcc
    v_lshrrev_b32 v68, 1, v64
    v_lshl_add_u32 v68, v68, 6, v66
    v_lshl_add_u32 v68, v65, 5, v68
    v_lshl_add_u32 v68, v67, 7, v68
    v_lshrrev_b32 v28, 4, v0
    v_lshl_add_u32 v28, v28, 3, v64
    v_and_b32 v69, 2, v64
    v_or_b32 v69, v69, v65
    v_lshl_add_u32 v28, v28, 2, v69
    v_and_b32 v69, 3, v0
    v_lshl_add_u32 v28, v28, 2, v69
    v_lshlrev_b32 v28, 3, v28
    s_and_b32 s70, s3, 2
    s_lshl_b32 s70, s70, 5
    v_xor_b32 v68, s70, v68
    v_add_u32 v15, 131072, v68
    v_mov_b32 v204, 0x3f803f80
    v_mov_b32 v205, 0x3f803f80
    v_mov_b32 v206, 0x3f803f80
    v_mov_b32 v207, 0x3f803f80
    v_mov_b32 v208, 0x3f803f80
    v_mov_b32 v209, 0x3f803f80
    v_mov_b32 v210, 0x3f803f80
    v_mov_b32 v211, 0x3f803f80
    v_and_b32 v32, 7, v0
    v_lshlrev_b32 v32, 3, v32
    v_bfe_u32 v16, v0, 2, 1
    v_lshrrev_b32 v18, 5, v0
    v_cmp_eq_u32 vcc, v16, v18
    v_and_b32_e64 v16, 16, v1
    v_mov_b32 v18, 0x3f80
    v_lshlrev_b32_e64 v18, v16, v18
    v_cndmask_b32_e64 v18, 0, v18, vcc
    v_bfe_u32 v16, v0, 1, 1
    v_bfe_u32 v19, v0, 3, 2
    v_lshl_add_u32 v16, v19, 1, v16
    v_cmp_eq_u32 vcc, 0, v16
    v_cmp_eq_u32 s[70:71], 1, v16
    s_nop 0
    v_cndmask_b32 v196, 0, v18, vcc
    v_cndmask_b32 v197, 0, v18, s[70:71]
    v_cmp_eq_u32_e64 vcc, 2, v16
    v_cmp_eq_u32 s[70:71], 3, v16
    s_nop 0
    v_cndmask_b32 v198, 0, v18, vcc
    v_cndmask_b32 v199, 0, v18, s[70:71]
    v_cmp_eq_u32_e64 vcc, 4, v16
    v_cmp_eq_u32 s[70:71], 5, v16
    s_nop 0
    v_cndmask_b32 v200, 0, v18, vcc
    v_cndmask_b32 v201, 0, v18, s[70:71]
    v_cmp_eq_u32_e64 vcc, 6, v16
    v_cmp_eq_u32 s[70:71], 7, v16
    s_nop 0
    v_cndmask_b32 v202, 0, v18, vcc
    v_cndmask_b32 v203, 0, v18, s[70:71]
    s_waitcnt vmcnt(11)
    s_add_u32 s0, s64, 1
    s_and_b32 s0, s0, 7
    s_mul_i32 s0, s0, 196608
    s_add_u32 m0, s97, 147456
    s_add_u32 s0, s0, s91
    buffer_load_dwordx4 v136, s[12:15], s0 offen offset:0 lds
    v_mov_b32 v17, 0x3f803f80
    v_mov_b32 v120, 0
    v_mov_b32 v121, 0
    v_mov_b32 v122, 0
    v_mov_b32 v123, 0
    v_dot2c_f32_bf16 v120, v48, v17
    v_dot2c_f32_bf16 v122, v48, v48
    v_dot2c_f32_bf16 v121, v52, v17
    v_dot2c_f32_bf16 v123, v52, v52
    v_dot2c_f32_bf16 v120, v49, v17
    v_dot2c_f32_bf16 v122, v49, v49
    buffer_load_dwordx4 v137, s[12:15], s0 offen offset:1024 lds
    v_dot2c_f32_bf16 v121, v53, v17
    v_dot2c_f32_bf16 v123, v53, v53
    v_dot2c_f32_bf16 v120, v50, v17
    v_dot2c_f32_bf16 v122, v50, v50
    v_dot2c_f32_bf16 v121, v54, v17
    v_dot2c_f32_bf16 v123, v54, v54
    v_dot2c_f32_bf16 v120, v51, v17
    v_dot2c_f32_bf16 v122, v51, v51
    v_dot2c_f32_bf16 v121, v55, v17
    v_dot2c_f32_bf16_e64 v123, v55, v55
    s_waitcnt lgkmcnt(0)
    s_mov_b32 s70, s86
    buffer_load_dwordx4 v138, s[12:15], s0 offen offset:2048 lds
    v_lshrrev_b32 v16, 1, v0
    v_permlane32_swap_b32 v120, v121
    v_permlane32_swap_b32 v122, v123
    v_add_f32 v120, v120, v121
    v_add_f32_e64 v122, v122, v123
    s_add_u32 s70, s70, 0x9e3779b9
    v_mov_b32 v8, s70
    v_permlane16_swap_b32 v120, v122
    v_add_f32 v120, v120, v122
    v_mov_b32 v9, s70
    v_mov_b32_e64 v121, s70
    buffer_load_dwordx4 v139, s[12:15], s0 offen offset:3072 lds
    v_add_f32_dpp v120, v120, v120 quad_perm:[1,0,3,2] row_mask:0xf bank_mask:0xf
    s_nop 1
    v_add_f32_dpp v120, v120, v120 quad_perm:[2,3,0,1] row_mask:0xf bank_mask:0xf
    s_nop 1
    v_add_f32_dpp v120, v120, v120 row_half_mirror row_mask:0xf bank_mask:0xf
    s_add_u32 s83, s83, 256
    s_and_b32 s83, s83, 0x380
    s_add_u32 m0, s82, 8192
    s_add_u32 s0, s75, s83
    buffer_load_dwordx4 v3, s[8:11], s0 offen offset:0 lds
    v_add_f32_dpp v120, v120, v120 row_mirror row_mask:0xf bank_mask:0xf
    v_mul_f32 v120, 0x3b000000, v120
    v_mov_b32 v122, v120
    v_mov_b32 v123, v120
    v_and_b32_e64 v17, 16, v0
    s_nop 0
    v_permlane16_swap_b32_e64 v122, v123
    v_cmp_ne_u32_e64 vcc, 0, v17
    v_fma_f32 v123, -v122, v122, v123
    v_max_f32_e64 v123, 0, v123
    v_add_f32 v123, 0x3727c5ac, v123
    buffer_load_dwordx4 v4, s[8:11], s0 offen offset:1024 lds
    v_sqrt_f32 v123, v123
    s_nop 0
    v_cndmask_b32 v122, -v122, v123, vcc
    v_cvt_pk_bf16_f32 v120, v122, v122
    v_lshlrev_b32_e64 v123, 16, v120
    v_sub_f32_e64 v122, v122, v123
    v_cvt_pk_bf16_f32 v120, v123, v122
    s_mov_b32 exec_lo, 0x00010001
    s_mov_b32 exec_hi, 0x00010001
    buffer_store_dwordx2 v[120:121], v16, s[16:19], s68 offen sc1
    s_mov_b64 exec, -1
    s_mov_b64 exec, 0
    s_cmp_eq_u32 s3, 0
    s_cbranch_scc1 L_pad_att_0
    s_cmp_eq_u32 s3, 1
    s_cbranch_scc1 L_pad_att_1
    s_cmp_eq_u32 s3, 2
    s_cbranch_scc1 L_pad_att_2
    s_branch L_pad_att_3
L_ret_att:
    s_mov_b64 exec, -1
    s_lshr_b32 s68, s66, 1
    buffer_load_dwordx4 v5, s[8:11], s0 offen offset:2048 lds
    s_lshl4_add_u32 s68, s68, s3
    s_lshl_b32 s68, s68, 6
    s_add_u32 s68, s68, 12288
    s_lshl_b32 s72, s3, 3
    s_lshr_b32 s86, 0x20160b00, s72
    s_and_b32 s86, s86, 0xff
    s_lshl_b32 s86, s86, 11
    s_lshr_b32 s87, 0x261b1006, s72
    s_and_b32 s87, s87, 0xff
    s_lshl_b32 s87, s87, 11
    s_lshr_b32 s88, 0x241a0f04, s72
    buffer_load_dwordx4 v6, s[8:11], s0 offen offset:3072 lds
    s_and_b32 s88, s88, 0xff
    s_lshl_b32 s88, s88, 11
    s_lshr_b32 s89, 0x251f1405, s72
    s_and_b32 s89, s89, 0xff
    s_lshl_b32 s89, s89, 11
    s_lshr_b32 s90, 0x2a2b150a, s72
    s_add_u32 s0, s64, 2
    s_and_b32 s0, s0, 7
    s_mul_i32 s0, s0, 196608
    s_add_u32 m0, s97, 65536
    s_add_u32 s0, s0, s91
    buffer_load_dwordx4 v136, s[12:15], s0 offen offset:0 lds
    s_and_b32 s90, s90, 0xff
    s_lshl_b32 s90, s90, 11
    s_and_b32 s70, s98, 0x8000
    s_xor_b32 s71, s70, 0x8000
    v_add_u32 v248, s70, v11
    v_add_u32 v11, s71, v11
    v_add_u32 v249, s70, v12
    v_add_u32 v12, s71, v12
    v_add_u32_e64 v250, s70, v13
    v_add_u32_e64 v13, s71, v13
    v_add_u32_e64 v251, s70, v14
    buffer_load_dwordx4 v137, s[12:15], s0 offen offset:1024 lds
    v_add_u32 v14, s71, v14
    v_lshrrev_b32_e64 v16, 3, v0
    v_lshl_add_u32 v7, v16, 10, v7
    s_lshr_b32 s72, 73, s5
    s_lshr_b32 s70, s3, 1
    s_andn2_b32 s72, s70, s72
    s_and_b32 s72, s72, 1
    s_lshl_b32 s72, s72, 18
    s_or_b32 s95, s95, s72
    v_and_b32_e64 v18, 4, v0
    v_cmp_ne_u32_e64 vcc, 0, v18
    buffer_load_dwordx4 v138, s[12:15], s0 offen offset:2048 lds
    v_mov_b32 v19, 0x80008000
    s_nop 0
    v_cndmask_b32_e64 v19, 0, v19, vcc
    s_waitcnt vmcnt(15)
    s_barrier
    ds_read_b64_tr_b16 a[0:1], v26 offset:0
    ds_read_b64_tr_b16 a[2:3], v26 offset:1024
    ds_read_b128 a[128:131], v248 offset:0
    s_waitcnt vmcnt(12)
    ds_read_b64_tr_b16 v[212:213], v176 offset:0
    ds_read_b64_tr_b16 v[214:215], v176 offset:128
    buffer_load_dwordx4 v139, s[12:15], s0 offen offset:3072 lds
    ds_read_b64_tr_b16 a[4:5], v26 offset:4096
    ds_read_b64_tr_b16 a[6:7], v26 offset:5120
    ds_read_b128 a[132:135], v249 offset:0
    ds_read_b128 v[80:83], v11 offset:0
    s_waitcnt lgkmcnt(6)
    v_mfma_f32_32x32x16_bf16 v[48:63], a[0:3], a[128:131], 0
    ds_read_b64_tr_b16 a[8:9], v26 offset:8192
    ds_read_b64_tr_b16 a[10:11], v26 offset:9216
    ds_read_b128 a[136:139], v250 offset:0
    s_add_u32 s0, s64, 3
    s_and_b32 s0, s0, 7
    s_mul_i32 s0, s0, 196608
    s_add_u32 m0, s97, 81920
    s_add_u32 s0, s0, s91
    buffer_load_dwordx4 v136, s[12:15], s0 offen offset:0 lds
    v_mfma_f32_16x16x32_bf16 v[140:143], v[144:147], a[0:3], 0
    s_waitcnt lgkmcnt(7)
    v_xor_b32_e64 v212, v19, v212
    s_waitcnt lgkmcnt(3)
    v_mfma_f32_32x32x16_bf16 v[48:63], a[4:7], a[132:135], v[48:63]
    ds_read_b64_tr_b16 a[12:13], v26 offset:12288
    ds_read_b64_tr_b16 a[14:15], v26 offset:13312
    v_xor_b32 v213, v19, v213
    v_xor_b32 v214, v19, v214
    v_xor_b32_e64 v215, v19, v215
    v_mov_b32_e64 v115, 0
    v_mfma_f32_32x32x16_bf16 v[64:79], a[0:3], v[80:83], 0
    ds_read_b128 a[140:143], v251 offset:0
    ds_read_b128 v[84:87], v12 offset:0
    buffer_load_dwordx4 v137, s[12:15], s0 offen offset:1024 lds
    v_mov_b32 v114, 0
    v_mov_b32_e64 v119, 0
    v_lshl_or_b32 v118, v163, 16, v163
    v_mfma_f32_16x16x32_bf16 v[140:143], v[144:147], a[4:7], v[140:143]
    s_waitcnt vmcnt(11)
    s_barrier
    s_waitcnt lgkmcnt(4)
    v_mfma_f32_32x32x16_bf16 v[48:63], a[8:11], a[136:139], v[48:63]
    ds_read_b64_tr_b16 a[16:17], v26 offset:16384
    ds_read_b64_tr_b16 a[18:19], v26 offset:17408
    ds_read_b128 a[144:147], v248 offset:4096
    buffer_load_dwordx4 v138, s[12:15], s0 offen offset:2048 lds
    v_mfma_f32_16x16x32_bf16 v[140:143], v[144:147], a[8:11], v[140:143]
    s_waitcnt lgkmcnt(3)
    v_mfma_f32_32x32x16_bf16 v[48:63], a[12:15], a[140:143], v[48:63]
    ds_read_b64_tr_b16 a[20:21], v26 offset:20480
    ds_read_b64_tr_b16 a[22:23], v26 offset:21504
    buffer_load_dwordx4 v139, s[12:15], s0 offen offset:3072 lds
    v_mfma_f32_32x32x16_bf16 v[64:79], a[4:7], v[84:87], v[64:79]
    ds_read_b128 a[148:151], v249 offset:4096
    ds_read_b128 v[88:91], v13 offset:0
    v_mfma_f32_16x16x32_bf16 v[140:143], v[144:147], a[12:15], v[140:143]
    s_add_u32 s83, s83, 256
    s_and_b32 s83, s83, 0x380
    s_add_u32 m0, s82, 16384
    s_add_u32 s0, s75, s83
    buffer_load_dwordx4 v3, s[8:11], s0 offen offset:0 lds
    s_waitcnt lgkmcnt(4)
    v_mfma_f32_32x32x16_bf16 v[48:63], a[16:19], a[144:147], v[48:63]
    ds_read_b64_tr_b16 a[24:25], v26 offset:24576
    ds_read_b64_tr_b16 a[26:27], v26 offset:25600
    ds_read_b128 a[152:155], v250 offset:4096
    v_mfma_f32_16x16x32_bf16 v[140:143], v[144:147], a[16:19], v[140:143]
    buffer_load_dwordx4 v4, s[8:11], s0 offen offset:1024 lds
    s_waitcnt lgkmcnt(3)
    v_mfma_f32_32x32x16_bf16 v[48:63], a[20:23], a[148:151], v[48:63]
    ds_read_b64_tr_b16 a[28:29], v26 offset:28672
    ds_read_b64_tr_b16 a[30:31], v26 offset:29696
    v_mfma_f32_32x32x16_bf16 v[64:79], a[8:11], v[88:91], v[64:79]
    ds_read_b128 a[156:159], v251 offset:4096
    ds_read_b128 v[92:95], v14 offset:0
    buffer_load_dwordx4 v5, s[8:11], s0 offen offset:2048 lds
    v_mfma_f32_16x16x32_bf16 v[140:143], v[144:147], a[20:23], v[140:143]
    buffer_load_dwordx4 v6, s[8:11], s0 offen offset:3072 lds
    s_add_u32 s0, s64, 4
    s_and_b32 s0, s0, 7
    s_mul_i32 s0, s0, 196608
    s_add_u32 m0, s97, 98304
    s_add_u32 s0, s0, s91
    buffer_load_dwordx4 v136, s[12:15], s0 offen offset:0 lds
    buffer_load_dwordx4 v137, s[12:15], s0 offen offset:1024 lds
    s_waitcnt vmcnt(10)
    s_barrier
    s_waitcnt lgkmcnt(4)
    v_mfma_f32_32x32x16_bf16 v[48:63], a[24:27], a[152:155], v[48:63]
    ds_read_b64_tr_b16 a[32:33], v25 offset:0
    ds_read_b64_tr_b16 a[34:35], v25 offset:1024
    ds_read_b128 a[160:163], v248 offset:8192
    buffer_load_dwordx4 v138, s[12:15], s0 offen offset:2048 lds
    v_mfma_f32_16x16x32_bf16 v[140:143], v[144:147], a[24:27], v[140:143]
    s_waitcnt lgkmcnt(3)
    v_mfma_f32_32x32x16_bf16 v[48:63], a[28:31], a[156:159], v[48:63]
    ds_read_b64_tr_b16 a[36:37], v25 offset:4096
    ds_read_b64_tr_b16 a[38:39], v25 offset:5120
    v_mfma_f32_32x32x16_bf16 v[64:79], a[12:15], v[92:95], v[64:79]
    ds_read_b128 a[164:167], v249 offset:8192
    ds_read_b128 v[96:99], v11 offset:4096
    buffer_load_dwordx4 v139, s[12:15], s0 offen offset:3072 lds
    v_mfma_f32_16x16x32_bf16 v[140:143], v[144:147], a[28:31], v[140:143]
    s_waitcnt lgkmcnt(4)
    v_mfma_f32_32x32x16_bf16 v[48:63], a[32:35], a[160:163], v[48:63]
    ds_read_b64_tr_b16 a[40:41], v25 offset:8192
    ds_read_b64_tr_b16 a[42:43], v25 offset:9216
    ds_read_b128 a[168:171], v250 offset:8192
    s_add_u32 s0, s64, 5
    s_and_b32 s0, s0, 7
    s_mul_i32 s0, s0, 196608
    s_add_u32 m0, s97, 114688
    s_add_u32 s0, s0, s91
    buffer_load_dwordx4 v136, s[12:15], s0 offen offset:0 lds
    v_mfma_f32_16x16x32_bf16 v[140:143], v[144:147], a[32:35], v[140:143]
    s_waitcnt lgkmcnt(3)
    v_mfma_f32_32x32x16_bf16 v[48:63], a[36:39], a[164:167], v[48:63]
    ds_read_b64_tr_b16 a[44:45], v25 offset:12288
    ds_read_b64_tr_b16 a[46:47], v25 offset:13312
    buffer_load_dwordx4 v137, s[12:15], s0 offen offset:1024 lds
    v_mfma_f32_32x32x16_bf16 v[64:79], a[16:19], v[96:99], v[64:79]
    ds_read_b128 a[172:175], v251 offset:8192
    ds_read_b128 v[100:103], v12 offset:4096
    v_mfma_f32_16x16x32_bf16 v[140:143], v[144:147], a[36:39], v[140:143]
    s_waitcnt vmcnt(10)
    s_barrier
    s_waitcnt lgkmcnt(4)
    v_mfma_f32_32x32x16_bf16 v[48:63], a[40:43], a[168:171], v[48:63]
    ds_read_b64_tr_b16 a[48:49], v25 offset:16384
    ds_read_b64_tr_b16 a[50:51], v25 offset:17408
    ds_read_b128 a[176:179], v248 offset:12288
    buffer_load_dwordx4 v138, s[12:15], s0 offen offset:2048 lds
    v_mfma_f32_16x16x32_bf16 v[140:143], v[144:147], a[40:43], v[140:143]
    s_waitcnt lgkmcnt(3)
    v_mfma_f32_32x32x16_bf16 v[48:63], a[44:47], a[172:175], v[48:63]
    ds_read_b64_tr_b16 a[52:53], v25 offset:20480
    ds_read_b64_tr_b16 a[54:55], v25 offset:21504
    buffer_load_dwordx4 v139, s[12:15], s0 offen offset:3072 lds
    v_mfma_f32_32x32x16_bf16 v[64:79], a[20:23], v[100:103], v[64:79]
    ds_read_b128 a[180:183], v249 offset:12288
    ds_read_b128 v[104:107], v13 offset:4096
    v_mfma_f32_16x16x32_bf16 v[140:143], v[144:147], a[44:47], v[140:143]
    s_add_u32 s83, s83, 256
    s_and_b32 s83, s83, 0x380
    s_add_u32 m0, s82, 24576
    s_add_u32 s0, s75, s83
    buffer_load_dwordx4 v3, s[8:11], s0 offen offset:0 lds
    s_waitcnt lgkmcnt(4)
    v_mfma_f32_32x32x16_bf16 v[48:63], a[48:51], a[176:179], v[48:63]
    ds_read_b64_tr_b16 a[56:57], v25 offset:24576
    ds_read_b64_tr_b16 a[58:59], v25 offset:25600
    ds_read_b128 a[184:187], v250 offset:12288
    v_mfma_f32_16x16x32_bf16 v[140:143], v[144:147], a[48:51], v[140:143]
    buffer_load_dwordx4 v4, s[8:11], s0 offen offset:1024 lds
    s_waitcnt lgkmcnt(3)
    v_mfma_f32_32x32x16_bf16 v[48:63], a[52:55], a[180:183], v[48:63]
    ds_read_b64_tr_b16 a[60:61], v25 offset:28672
    ds_read_b64_tr_b16 a[62:63], v25 offset:29696
    v_mfma_f32_32x32x16_bf16 v[64:79], a[24:27], v[104:107], v[64:79]
    ds_read_b128 a[188:191], v251 offset:12288
    ds_read_b128 v[108:111], v14 offset:4096
    buffer_load_dwordx4 v5, s[8:11], s0 offen offset:2048 lds
    v_mfma_f32_16x16x32_bf16 v[140:143], v[144:147], a[52:55], v[140:143]
    buffer_load_dwordx4 v6, s[8:11], s0 offen offset:3072 lds
    s_add_u32 s0, s64, 6
    s_and_b32 s0, s0, 7
    s_mul_i32 s0, s0, 196608
    s_add_u32 m0, s97, 131072
    s_add_u32 s0, s0, s91
    buffer_load_dwordx4 v136, s[12:15], s0 offen offset:0 lds
    buffer_load_dwordx4 v137, s[12:15], s0 offen offset:1024 lds
    s_waitcnt vmcnt(10)
    s_barrier
    s_waitcnt lgkmcnt(4)
    v_mfma_f32_32x32x16_bf16 v[48:63], a[56:59], a[184:187], v[48:63]
    ds_read_b64_tr_b16 a[64:65], v25 offset:32768
    ds_read_b64_tr_b16 a[66:67], v25 offset:33792
    ds_read_b128 a[192:195], v248 offset:16384
    buffer_load_dwordx4 v138, s[12:15], s0 offen offset:2048 lds
    v_mfma_f32_16x16x32_bf16 v[140:143], v[144:147], a[56:59], v[140:143]
    s_waitcnt lgkmcnt(3)
    v_mfma_f32_32x32x16_bf16 v[48:63], a[60:63], a[188:191], v[48:63]
    ds_read_b64_tr_b16 a[68:69], v25 offset:36864
    ds_read_b64_tr_b16 a[70:71], v25 offset:37888
    v_mfma_f32_32x32x16_bf16 v[64:79], a[28:31], v[108:111], v[64:79]
    ds_read_b128 a[196:199], v249 offset:16384
    ds_read_b128 v[80:83], v11 offset:8192
    buffer_load_dwordx4 v139, s[12:15], s0 offen offset:3072 lds
    v_mfma_f32_16x16x32_bf16 v[140:143], v[144:147], a[60:63], v[140:143]
    s_and_b32 s0, s3, 1
    s_xor_b32 s0, s0, 0
    s_add_u32 s0, s0, s65
    s_and_b32 s0, s0, 3
    s_lshl_b32 s0, s0, 9
    s_add_u32 s0, s0, s69
    buffer_load_dwordx4 v[120:123], v10, s[16:19], s0 offen sc1
    s_waitcnt lgkmcnt(4)
    v_mfma_f32_32x32x16_bf16 v[48:63], a[64:67], a[192:195], v[48:63]
    ds_read_b64_tr_b16 a[72:73], v25 offset:40960
    ds_read_b64_tr_b16 a[74:75], v25 offset:41984
    ds_read_b128 a[200:203], v250 offset:16384
    s_and_b32 s0, s3, 1
    s_xor_b32 s0, s0, 1
    s_add_u32 s0, s0, s65
    s_and_b32 s0, s0, 3
    s_lshl_b32 s0, s0, 9
    s_add_u32 s0, s0, s69
    buffer_load_dwordx4 v[124:127], v10, s[16:19], s0 offen sc1
    v_mfma_f32_16x16x32_bf16 v[140:143], v[144:147], a[64:67], v[140:143]
    s_waitcnt lgkmcnt(3)
    v_mfma_f32_32x32x16_bf16 v[48:63], a[68:71], a[196:199], v[48:63]
    ds_read_b64_tr_b16 a[76:77], v25 offset:45056
    ds_read_b64_tr_b16 a[78:79], v25 offset:46080
    s_add_u32 s0, s64, 7
    s_and_b32 s0, s0, 7
    s_mul_i32 s0, s0, 196608
    s_add_u32 m0, s97, 147456
    s_add_u32 s0, s0, s91
    buffer_load_dwordx4 v136, s[12:15], s0 offen offset:0 lds
    v_mfma_f32_32x32x16_bf16 v[64:79], a[32:35], v[80:83], v[64:79]
    ds_read_b128 a[204:207], v251 offset:16384
    ds_read_b128 v[84:87], v12 offset:8192
    v_mfma_f32_16x16x32_bf16 v[140:143], v[144:147], a[68:71], v[140:143]
    s_waitcnt vmcnt(11)
    s_barrier
    s_waitcnt lgkmcnt(4)
    v_mfma_f32_32x32x16_bf16 v[48:63], a[72:75], a[200:203], v[48:63]
    ds_read_b64_tr_b16 a[80:81], v25 offset:49152
    ds_read_b64_tr_b16 a[82:83], v25 offset:50176
    ds_read_b128 a[208:211], v248 offset:20480
    ds_read_b128 v[88:91], v13 offset:8192
    buffer_load_dwordx4 v137, s[12:15], s0 offen offset:1024 lds
    v_mfma_f32_16x16x32_bf16 v[140:143], v[144:147], a[72:75], v[140:143]
    s_waitcnt lgkmcnt(4)
    v_mfma_f32_32x32x16_bf16 v[48:63], a[76:79], a[204:207], v[48:63]
    ds_read_b64_tr_b16 a[84:85], v25 offset:53248
    ds_read_b64_tr_b16 a[86:87], v25 offset:54272
    buffer_load_dwordx4 v138, s[12:15], s0 offen offset:2048 lds
    v_mfma_f32_32x32x16_bf16 v[64:79], a[36:39], v[84:87], v[64:79]
    ds_read_b128 a[212:215], v249 offset:20480
    ds_read_b128 v[92:95], v14 offset:8192
    v_mfma_f32_16x16x32_bf16 v[140:143], v[144:147], a[76:79], v[140:143]
    s_waitcnt lgkmcnt(4)
    v_mfma_f32_32x32x16_bf16 v[48:63], a[80:83], a[208:211], v[48:63]
    ds_read_b64_tr_b16 a[88:89], v25 offset:57344
    ds_read_b64_tr_b16 a[90:91], v25 offset:58368
    buffer_load_dwordx4 v139, s[12:15], s0 offen offset:3072 lds
    v_mfma_f32_32x32x16_bf16 v[64:79], a[40:43], v[88:91], v[64:79]
    ds_read_b128 a[216:219], v250 offset:20480
    ds_read_b128 v[96:99], v11 offset:12288
    s_lshl1_add_u32 s0, s3, s64
    s_lshl_b32 s0, s0, 7
    s_and_b32 s82, s0, 0x380
    s_add_u32 s0, s0, 128
    s_and_b32 s83, s0, 0x380
    s_bitcmp1_b32 s7, 0
    s_cselect_b32 s0, s83, s82
    s_cselect_b32 s83, s82, s83
    s_cselect_b32 s74, 0x1000, 0
    s_mov_b32 s82, s0
    s_or_b32 s74, s74, s92
    s_xor_b32 m0, s74, 65536
    s_add_u32 s0, s76, s82
    buffer_load_dwordx4 v3, s[8:11], s0 offen offset:0 lds
    v_mfma_f32_16x16x32_bf16 v[140:143], v[144:147], a[80:83], v[140:143]
    s_waitcnt lgkmcnt(4)
    v_mfma_f32_32x32x16_bf16 v[48:63], a[84:87], a[212:215], v[48:63]
    ds_read_b64_tr_b16 a[92:93], v25 offset:61440
    ds_read_b64_tr_b16 a[94:95], v25 offset:62464
    v_mfma_f32_32x32x16_bf16 v[64:79], a[44:47], v[92:95], v[64:79]
    ds_read_b128 a[220:223], v251 offset:20480
    ds_read_b128 v[100:103], v12 offset:12288
    buffer_load_dwordx4 v4, s[8:11], s0 offen offset:1024 lds
    v_mfma_f32_16x16x32_bf16 v[140:143], v[144:147], a[84:87], v[140:143]
    buffer_load_dwordx4 v5, s[8:11], s0 offen offset:2048 lds
    buffer_load_dwordx4 v6, s[8:11], s0 offen offset:3072 lds
    s_waitcnt vmcnt(10)
    s_barrier
    s_waitcnt lgkmcnt(4)
    v_mfma_f32_32x32x16_bf16 v[48:63], a[88:91], a[216:219], v[48:63]
    ds_read_b64_tr_b16 a[96:97], v26 offset:0
    ds_read_b64_tr_b16 a[98:99], v26 offset:1024
    s_waitcnt vmcnt(8)
    v_xor_b32 v16, v8, v121
    v_xor_b32 v17, v8, v123
    v_xor_b32 v30, v8, v125
    v_xor_b32_e64 v31, v8, v127
    v_or3_b32 v16, v16, v30, v31
    v_cmp_ne_u64_e64 vcc, 0, v[16:17]
    s_nop 1
    s_cbranch_vccnz L_retry_1
L_ok_3:
    v_mfma_f32_32x32x16_bf16 v[64:79], a[48:51], v[96:99], v[64:79]
    ds_read_b128 a[224:227], v248 offset:24576
    ds_read_b128 v[104:107], v13 offset:12288
    s_xor_b32 m0, s74, 69632
    s_add_u32 s0, s76, s83
    buffer_load_dwordx4 v3, s[8:11], s0 offen offset:0 lds
    v_lshlrev_b32 v148, 16, v122
    v_mfma_f32_16x16x32_bf16 v[140:143], v[144:147], a[88:91], v[140:143]
    v_and_b32 v150, 0xffff0000, v122
    v_add_f32 v150, v150, v148
    s_waitcnt lgkmcnt(4)
    v_mfma_f32_32x32x16_bf16 v[48:63], a[92:95], a[220:223], v[48:63]
    ds_read_b64_tr_b16 a[100:101], v26 offset:4096
    ds_read_b64_tr_b16 a[102:103], v26 offset:5120
    v_rcp_f32_e64 v148, v150
    v_mov_b32_e64 v121, v120
    v_mov_b32_e64 v123, 0
    v_mfma_f32_32x32x16_bf16 v[64:79], a[52:55], v[100:103], v[64:79]
    ds_read_b128 a[228:231], v249 offset:24576
    ds_read_b128 v[108:111], v14 offset:12288
    buffer_load_dwordx4 v4, s[8:11], s0 offen offset:1024 lds
    v_mul_f32 v149, 0x3fb8aa3b, v148
    v_lshlrev_b32_e64 v151, 16, v126
    v_and_b32 v153, 0xffff0000, v126
    v_mfma_f32_16x16x32_bf16 v[140:143], v[144:147], a[92:95], v[140:143]
    v_add_f32 v153, v153, v151
    v_rcp_f32_e64 v151, v153
    s_waitcnt lgkmcnt(4)
    v_mfma_f32_32x32x16_bf16 v[48:63], a[96:99], a[224:227], v[48:63]
    ds_read_b64_tr_b16 a[104:105], v26 offset:8192
    ds_read_b64_tr_b16 a[106:107], v26 offset:9216
    buffer_load_dwordx4 v5, s[8:11], s0 offen offset:2048 lds
    v_mov_b32_e64 v125, v124
    v_mfma_f32_32x32x16_bf16 v[64:79], a[56:59], v[104:107], v[64:79]
    ds_read_b128 a[232:235], v250 offset:24576
    ds_read_b128 v[80:83], v11 offset:16384
    v_mov_b32 v127, 0
    v_mul_f32 v152, 0x3fb8aa3b, v151
    s_cmp_lg_u32 s98, 0
    s_cselect_b32 s71, s79, s78
    s_cselect_b32 s79, s78, s79
    s_mov_b32 s78, s71
    v_mfma_f32_16x16x32_bf16 v[140:143], v[144:147], a[96:99], v[140:143]
    buffer_load_dwordx4 v6, s[8:11], s0 offen offset:3072 lds
    s_waitcnt lgkmcnt(4)
    v_mfma_f32_32x32x16_bf16 v[48:63], a[100:103], a[228:231], v[48:63]
    ds_read_b64_tr_b16 a[108:109], v26 offset:12288
    ds_read_b64_tr_b16 a[110:111], v26 offset:13312
    s_add_u32 s0, s65, 2
    s_and_b32 s0, s0, 3
    s_lshl_b32 s0, s0, 9
    s_add_u32 s0, s0, s69
    buffer_load_dwordx4 v[128:131], v10, s[16:19], s0 offen sc1
    v_mfma_f32_32x32x16_bf16 v[64:79], a[60:63], v[108:111], v[64:79]
    ds_read_b128 a[236:239], v251 offset:24576
    ds_read_b128 v[84:87], v12 offset:16384
    s_add_u32 s0, s65, 3
    s_and_b32 s0, s0, 3
    s_lshl_b32 s0, s0, 9
    s_add_u32 s0, s0, s69
    buffer_load_dwordx4 v[132:135], v10, s[16:19], s0 offen sc1
    v_mfma_f32_16x16x32_bf16 v[140:143], v[144:147], a[100:103], v[140:143]
    s_mov_b32 s32, 0xffff
    s_mov_b32 s33, 0xffff
    s_waitcnt vmcnt(10)
    s_barrier
    s_waitcnt lgkmcnt(4)
    v_mfma_f32_32x32x16_bf16 v[48:63], a[104:107], a[232:235], v[48:63]
    ds_read_b64_tr_b16 a[112:113], v26 offset:16384
    ds_read_b64_tr_b16 a[114:115], v26 offset:17408
    s_xor_b32 m0, s74, 98304
    s_add_u32 s0, s77, s82
    buffer_load_dwordx4 v3, s[8:11], s0 offen offset:0 lds
    v_mfma_f32_32x32x16_bf16 v[64:79], a[64:67], v[80:83], v[64:79]
    ds_read_b128 a[240:243], v248 offset:28672
L_pad_att_0:
    s_cbranch_execz L_ret_att
    ds_read_b128 v[88:91], v13 offset:16384
    v_mfma_f32_16x16x32_bf16 v[140:143], v[144:147], a[104:107], v[140:143]
    s_waitcnt lgkmcnt(4)
    v_mfma_f32_32x32x16_bf16 v[48:63], a[108:111], a[236:239], v[48:63]
    ds_read_b64_tr_b16 a[116:117], v26 offset:20480
    ds_read_b64_tr_b16 a[118:119], v26 offset:21504
    buffer_load_dwordx4 v4, s[8:11], s0 offen offset:1024 lds
    v_mfma_f32_32x32x16_bf16 v[64:79], a[68:71], v[84:87], v[64:79]
    ds_read_b128 a[244:247], v249 offset:28672
    ds_read_b128 v[92:95], v14 offset:16384
    v_mfma_f32_16x16x32_bf16 v[140:143], v[144:147], a[108:111], v[140:143]
    s_waitcnt lgkmcnt(4)
    v_mfma_f32_32x32x16_bf16 v[48:63], a[112:115], a[240:243], v[48:63]
    ds_read_b64_tr_b16 a[120:121], v26 offset:24576
    ds_read_b64_tr_b16 a[122:123], v26 offset:25600
    buffer_load_dwordx4 v5, s[8:11], s0 offen offset:2048 lds
    v_mfma_f32_32x32x16_bf16 v[64:79], a[72:75], v[88:91], v[64:79]
    ds_read_b128 a[248:251], v250 offset:28672
    ds_read_b128 v[96:99], v11 offset:20480
    v_mfma_f32_16x16x32_bf16 v[140:143], v[144:147], a[112:115], v[140:143]
    s_waitcnt lgkmcnt(4)
    v_mfma_f32_32x32x16_bf16 v[48:63], a[116:119], a[244:247], v[48:63]
    ds_read_b64_tr_b16 a[124:125], v26 offset:28672
    ds_read_b64_tr_b16 a[126:127], v26 offset:29696
    buffer_load_dwordx4 v6, s[8:11], s0 offen offset:3072 lds
    v_mfma_f32_32x32x16_bf16 v[64:79], a[76:79], v[92:95], v[64:79]
    ds_read_b128 a[252:255], v251 offset:28672
    ds_read_b128 v[100:103], v12 offset:20480
    v_mov_b32_e64 v24, v27
    v_add_u32 v25, 7168, v24
    v_add_u32 v26, 14336, v24
    v_add_u32 v27, 21504, v24
    v_mfma_f32_16x16x32_bf16 v[140:143], v[144:147], a[116:119], v[140:143]
    s_xor_b32 m0, s74, 102400
    s_add_u32 s0, s77, s83
    buffer_load_dwordx4 v3, s[8:11], s0 offen offset:0 lds
    s_waitcnt lgkmcnt(0)
    v_mfma_f32_16x16x32_bf16 v[140:143], v[144:147], a[120:123], v[140:143]
    buffer_load_dwordx4 v4, s[8:11], s0 offen offset:1024 lds
    v_xor_b32 v25, 32, v25
    v_mfma_f32_16x16x32_bf16 v[140:143], v[144:147], a[124:127], v[140:143]
    v_xor_b32_e64 v27, 32, v27
    s_lshl_b32 s91, s66, 16
    v_mfma_f32_32x32x16_bf16 v[48:63], a[120:123], a[248:251], v[48:63]
    ds_read_b128 v[104:107], v13 offset:20480
    ds_read_b128 v[108:111], v14 offset:20480
    s_add_u32 s91, s91, s93
    s_add_u32 s91, s91, s67
    s_and_b32 s97, s98, 0x8000
    s_add_u32 s96, s97, 0x8000
    v_mfma_f32_32x32x16_bf16 v[48:63], a[124:127], a[252:255], v[48:63]
    ds_read_b128 v[80:83], v11 offset:24576
    ds_read_b128 v[84:87], v12 offset:24576
    buffer_load_dwordx4 v5, s[8:11], s0 offen offset:2048 lds
    v_cvt_pk_bf16_f32 v112, v140, v140
    v_lshlrev_b32 v17, 16, v112
    v_sub_f32 v16, v140, v17
    v_mfma_f32_32x32x16_bf16 v[64:79], a[80:83], v[96:99], v[64:79]
    ds_read_b128 v[88:91], v13 offset:24576
    ds_read_b128 v[92:95], v14 offset:24576
    v_cvt_pk_bf16_f32 v113, v16, v16
    buffer_load_dwordx4 v6, s[8:11], s0 offen offset:3072 lds
    s_nop 0
    v_mfma_f32_32x32x16_bf16 v[48:63], v[112:115], v[120:123], v[48:63]
    s_nop 5
    v_mfma_f32_32x32x16_bf16 v[64:79], a[84:87], v[100:103], v[64:79]
    ds_read_b128 v[96:99], v11 offset:28672
    s_waitcnt vmcnt(8)
    v_xor_b32 v16, v8, v129
    v_xor_b32_e64 v17, v8, v131
    v_xor_b32_e64 v30, v8, v133
    v_xor_b32 v31, v8, v135
    v_or3_b32 v16, v16, v30, v31
    v_cmp_ne_u64_e64 vcc, 0, v[16:17]
    s_nop 1
    s_cbranch_vccnz L_retry_4
L_ok_6:
    s_waitcnt lgkmcnt(5)
    v_mfma_f32_32x32x16_bf16 v[64:79], a[88:91], v[104:107], v[64:79]
    ds_read_b128 v[100:103], v12 offset:28672
    v_min_u32 v30, 10, v0
    v_lshlrev_b32_e64 v30, 7, v30
    s_lshl2_add_u32 s1, s2, s3
    s_mul_i32 s0, s1, 1408
    buffer_load_dword v31, v30, s[20:23], s0 offen
    v_mfma_f32_32x32x16_bf16 v[64:79], a[92:95], v[108:111], v[64:79]
    ds_read_b128 v[104:107], v13 offset:28672
    v_lshlrev_b32_e64 v154, 16, v130
    v_and_b32 v156, 0xffff0000, v130
    v_add_f32_e64 v156, v156, v154
    v_rcp_f32_e64 v154, v156
    s_waitcnt lgkmcnt(5)
    v_mfma_f32_32x32x16_bf16 v[64:79], a[96:99], v[80:83], v[64:79]
    ds_read_b128 v[108:111], v14 offset:28672
    v_min_u32 v30, 384, v30
    s_lshl_b32 s0, s1, 9
    buffer_load_dword v31, v30, s[24:27], s0 offen
    v_mfma_f32_32x32x16_bf16 v[64:79], a[100:103], v[84:87], v[64:79]
    v_mov_b32 v129, v128
    v_mov_b32 v131, 0
    v_mul_f32 v155, 0x3fb8aa3b, v154
    v_lshlrev_b32 v157, 16, v134
    v_and_b32 v159, 0xffff0000, v134
    v_add_f32_e64 v159, v159, v157
    s_waitcnt lgkmcnt(4)
    v_mfma_f32_32x32x16_bf16 v[64:79], a[104:107], v[88:91], v[64:79]
    v_rcp_f32_e64 v157, v159
    v_mov_b32_e64 v133, v132
    v_mov_b32_e64 v135, 0
    v_mul_f32 v158, 0x3fb8aa3b, v157
    v_cndmask_b32 v136, v128, v132, s[98:99]
    v_mfma_f32_32x32x16_bf16 v[64:79], a[108:111], v[92:95], v[64:79]
    v_cndmask_b32 v137, v129, v133, s[98:99]
    v_cndmask_b32 v138, v130, v134, s[98:99]
    v_mov_b32 v139, 0
    s_and_b32 s70, s98, 0x100
    s_add_u32 s70, s70, 2097152
    v_and_b32 v29, 0xf0, v1
    s_waitcnt lgkmcnt(2)
    v_mfma_f32_32x32x16_bf16 v[64:79], a[112:115], v[96:99], v[64:79]
    v_and_b32 v16, 0x30, v0
    v_lshl_add_u32 v16, v16, 5, s70
    v_add_u32 v29, v29, v16
    v_cvt_pk_bf16_f32 v164, v48, v49
    v_cvt_pk_bf16_f32 v165, v50, v51
    v_cvt_pk_bf16_f32 v166, v52, v53
    v_mfma_f32_32x32x16_bf16 v[64:79], a[116:119], v[100:103], v[64:79]
    v_cvt_pk_bf16_f32 v167, v54, v55
    s_nop 1
    v_mfma_f32_32x32x16_bf16 v[176:191], v[212:215], v[164:167], 0
    v_mul_f32 v56, v56, v148
    v_mul_f32 v57, v57, v148
    v_mul_f32 v58, v58, v148
    v_mul_f32 v59, v59, v148
    v_mul_f32 v60, v60, v148
    v_mul_f32 v61, v61, v148
    s_waitcnt lgkmcnt(0)
    v_mfma_f32_32x32x16_bf16 v[64:79], a[120:123], v[104:107], v[64:79]
    v_mul_f32 v62, v62, v148
    v_mul_f32 v63, v63, v148
    v_cvt_pk_bf16_f32 v192, v56, v57
    v_cvt_pk_bf16_f32 v193, v58, v59
    v_cvt_pk_bf16_f32 v194, v60, v61
    v_cvt_pk_bf16_f32 v195, v62, v63
    v_mfma_f32_32x32x16_bf16 v[64:79], a[124:127], v[108:111], v[64:79]
    v_max3_f32 v18, v176, v177, v178
    v_max3_f32 v19, v179, v180, v181
    v_mfma_f32_32x32x16_bf16 v[232:247], v[192:195], v[196:199], 0
    v_max3_f32 v18, v18, v182, v183
    v_max3_f32 v19, v19, v184, v185
    v_max3_f32 v18, v18, v186, v187
    v_max3_f32 v19, v19, v188, v189
    v_max3_f32 v18, v18, v190, v191
    v_max_f32 v18, v18, v19
    v_mfma_f32_32x32x16_bf16 v[64:79], v[112:115], v[124:127], v[64:79]
    v_mul_f32 v18, v18, v149
    v_fma_f32 v176, v176, v149, -v18
    v_fma_f32 v177, v177, v149, -v18
    v_fma_f32 v178, v178, v149, -v18
    v_fma_f32 v179, v179, v149, -v18
    v_fma_f32 v180, v180, v149, -v18
    s_barrier
    v_add_u32 v11, s96, v11
    v_add_u32 v12, s96, v12
    v_add_u32 v13, s96, v13
    v_add_u32 v14, s96, v14
    ds_read_b128 v[80:83], v11 offset:0
    ds_read_b128 v[84:87], v12 offset:0
    ds_read_b128 v[88:91], v13 offset:0
    ds_read_b128 v[92:95], v14 offset:0
    ds_read_b128 v[96:99], v11 offset:4096
    ds_read_b128 v[100:103], v12 offset:4096
    ds_read_b128 v[104:107], v13 offset:4096
    s_add_u32 m0, s85, 131072
    s_nop 0
    buffer_load_dwordx4 v20, s[36:39], s84 offen offset:0 lds
    v_mfma_f32_32x32x16_bf16 v[48:63], v[112:115], v[128:131], 0
    v_fma_f32 v181, v181, v149, -v18
    v_fma_f32 v182, v182, v149, -v18
    v_fma_f32 v183, v183, v149, -v18
    v_fma_f32 v184, v184, v149, -v18
    v_fma_f32 v185, v185, v149, -v18
    v_fma_f32 v186, v186, v149, -v18
    v_fma_f32 v187, v187, v149, -v18
    v_fma_f32 v188, v188, v149, -v18
    v_fma_f32 v189, v189, v149, -v18
    v_fma_f32 v190, v190, v149, -v18
    v_fma_f32 v191, v191, v149, -v18
    v_exp_f32_e64 v176, v176
    buffer_load_dwordx4 v21, s[36:39], s84 offen offset:1024 lds
    v_exp_f32 v177, v177
    v_exp_f32 v178, v178
    v_exp_f32 v179, v179
    v_exp_f32 v180, v180
    v_exp_f32 v181, v181
    s_waitcnt lgkmcnt(3)
    v_mfma_f32_32x32x16_bf16 v[48:63], a[0:3], v[80:83], v[48:63]
    ds_read_b128 v[108:111], v14 offset:4096
    v_exp_f32 v182, v182
    v_exp_f32 v183, v183
    v_exp_f32_e64 v184, v184
    v_mfma_f32_32x32x16_bf16 v[48:63], a[4:7], v[84:87], v[48:63]
    ds_read_b128 v[80:83], v11 offset:8192
    v_exp_f32 v185, v185
    v_exp_f32 v186, v186
    v_exp_f32_e64 v187, v187
    v_mfma_f32_32x32x16_bf16 v[48:63], a[8:11], v[88:91], v[48:63]
    ds_read_b128 v[84:87], v12 offset:8192
    v_exp_f32 v188, v188
    v_exp_f32 v189, v189
    v_exp_f32_e64 v190, v190
    v_mfma_f32_32x32x16_bf16 v[48:63], a[12:15], v[92:95], v[48:63]
    ds_read_b128 v[88:91], v13 offset:8192
    v_exp_f32 v191, v191
    v_add_f32 v18, v176, v177
    v_add_f32_e64 v19, v178, v179
    v_add_f32 v18, v18, v180
    s_add_u32 m0, s85, 139264
    s_add_u32 s84, s84, 176128
    s_cmp_eq_u32 s84, 1409024
    s_cselect_b32 s84, 0, s84
    buffer_load_dwordx4 v20, s[36:39], s84 offen offset:0 lds
    v_add_f32 v19, v19, v181
    s_waitcnt lgkmcnt(3)
    v_mfma_f32_32x32x16_bf16 v[48:63], a[16:19], v[96:99], v[48:63]
    ds_read_b128 v[92:95], v14 offset:8192
    v_add_f32 v18, v18, v182
    v_add_f32 v19, v19, v183
    v_add_f32 v18, v18, v184
    v_add_f32 v19, v19, v185
    v_add_f32 v18, v18, v186
    v_add_f32 v19, v19, v187
    v_add_f32_e64 v18, v18, v188
    v_mfma_f32_32x32x16_bf16 v[48:63], a[20:23], v[100:103], v[48:63]
    ds_read_b128 v[96:99], v11 offset:12288
    buffer_load_dwordx4 v21, s[36:39], s84 offen offset:1024 lds
    v_add_f32 v19, v19, v189
    v_add_f32 v18, v18, v190
    v_add_f32 v19, v19, v191
    v_add_f32 v18, v18, v19
    v_mfma_f32_32x32x16_bf16 v[48:63], a[24:27], v[104:107], v[48:63]
    ds_read_b128 v[100:103], v12 offset:12288
    v_rcp_f32 v18, v18
    s_nop 0
    v_mul_f32 v176, v176, v18
    v_mul_f32 v177, v177, v18
    v_mfma_f32_32x32x16_bf16 v[48:63], a[28:31], v[108:111], v[48:63]
    ds_read_b128 v[104:107], v13 offset:12288
    s_add_u32 m0, s85, 147456
    s_add_u32 s84, s84, 176128
    s_cmp_eq_u32 s84, 1409024
    s_cselect_b32 s84, 0, s84
    buffer_load_dwordx4 v20, s[36:39], s84 offen offset:0 lds
    v_mul_f32 v178, v178, v18
    v_mul_f32 v179, v179, v18
    v_mul_f32 v180, v180, v18
    v_mul_f32 v181, v181, v18
    v_mul_f32 v182, v182, v18
    v_mul_f32 v183, v183, v18
    v_mul_f32_e64 v184, v184, v18
    s_waitcnt lgkmcnt(3)
    v_mfma_f32_32x32x16_bf16 v[48:63], a[32:35], v[80:83], v[48:63]
    ds_read_b128 v[108:111], v14 offset:12288
    v_mul_f32 v185, v185, v18
    v_mul_f32 v186, v186, v18
    v_mul_f32 v187, v187, v18
    v_mul_f32 v188, v188, v18
    v_mul_f32 v189, v189, v18
    v_mfma_f32_32x32x16_bf16 v[48:63], a[36:39], v[84:87], v[48:63]
    ds_read_b128 v[80:83], v11 offset:16384
    buffer_load_dwordx4 v21, s[36:39], s84 offen offset:1024 lds
    v_mul_f32 v190, v190, v18
    v_mul_f32 v191, v191, v18
    v_cvt_pk_bf16_f32 v168, v176, v177
    v_cvt_pk_bf16_f32 v169, v178, v179
    v_mfma_f32_32x32x16_bf16 v[48:63], a[40:43], v[88:91], v[48:63]
    ds_read_b128 v[84:87], v12 offset:16384
    v_cvt_pk_bf16_f32 v170, v180, v181
    v_cvt_pk_bf16_f32 v171, v182, v183
    v_cvt_pk_bf16_f32 v172, v184, v185
    v_cvt_pk_bf16_f32 v173, v186, v187
    v_cvt_pk_bf16_f32 v174, v188, v189
    v_mfma_f32_32x32x16_bf16 v[48:63], a[44:47], v[92:95], v[48:63]
    ds_read_b128 v[88:91], v13 offset:16384
    s_add_u32 m0, s85, 155648
    s_add_u32 s84, s84, 176128
    s_cmp_eq_u32 s84, 1409024
    s_cselect_b32 s84, 0, s84
    buffer_load_dwordx4 v20, s[36:39], s84 offen offset:0 lds
    v_cvt_pk_bf16_f32 v175, v190, v191
    s_mov_b64 exec, s[32:33]
    v_cvt_pk_bf16_f32 v204, v232, v233
    v_cvt_pk_bf16_f32 v205, v234, v235
    v_cvt_pk_bf16_f32 v206, v236, v237
    v_cvt_pk_bf16_f32 v207, v238, v239
    s_mov_b64 exec, -1
    v_mfma_f32_32x32x16_bf16 v[176:191], v[168:171], v[196:199], 0
    s_mov_b64 exec, s[32:33]
    v_cvt_pk_bf16_f32 v208, v240, v241
    v_cvt_pk_bf16_f32 v209, v242, v243
    v_cvt_pk_bf16_f32 v210, v244, v245
    v_cvt_pk_bf16_f32 v211, v246, v247
    s_mov_b64 exec, -1
    v_mfma_f32_32x32x16_bf16 v[176:191], v[172:175], v[200:203], v[176:191]
    buffer_load_dwordx4 v21, s[36:39], s84 offen offset:1024 lds
    s_nop 4
    s_waitcnt lgkmcnt(3)
    v_mfma_f32_32x32x16_bf16 v[48:63], a[48:51], v[96:99], v[48:63]
    ds_read_b128 v[92:95], v14 offset:16384
    s_add_u32 m0, s85, 0
    s_add_u32 s84, s84, 176128
    s_cmp_eq_u32 s84, 1409024
    s_cselect_b32 s84, 0, s84
    buffer_load_dwordx4 v20, s[36:39], s84 offen offset:0 lds
    v_mfma_f32_32x32x16_bf16 v[48:63], a[52:55], v[100:103], v[48:63]
    ds_read_b128 v[96:99], v11 offset:20480
    v_cvt_pk_bf16_f32 v168, v176, v177
    v_cvt_pk_bf16_f32 v169, v178, v179
    v_cvt_pk_bf16_f32 v170, v180, v181
    v_cvt_pk_bf16_f32 v171, v182, v183
    v_cvt_pk_bf16_f32 v172, v184, v185
    v_mfma_f32_32x32x16_bf16 v[48:63], a[56:59], v[104:107], v[48:63]
    ds_read_b128 v[100:103], v12 offset:20480
    v_cvt_pk_bf16_f32 v173, v186, v187
    v_cvt_pk_bf16_f32 v174, v188, v189
    v_cvt_pk_bf16_f32 v175, v190, v191
    v_mfma_f32_32x32x16_bf16 v[216:231], v[168:171], v[204:207], 0
    buffer_load_dwordx4 v21, s[36:39], s84 offen offset:1024 lds
    v_mfma_f32_32x32x16_bf16 v[216:231], v[172:175], v[208:211], v[216:231]
    v_cvt_pk_bf16_f32 v164, v64, v65
    v_cvt_pk_bf16_f32 v165, v66, v67
    v_cvt_pk_bf16_f32 v166, v68, v69
    v_cvt_pk_bf16_f32 v167, v70, v71
    s_nop 1
    v_mfma_f32_32x32x16_bf16 v[176:191], v[212:215], v[164:167], 0
    s_add_u32 m0, s85, 8192
    s_add_u32 s84, s84, 176128
    s_cmp_eq_u32 s84, 1409024
    s_cselect_b32 s84, 0, s84
    buffer_load_dwordx4 v20, s[36:39], s84 offen offset:0 lds
    v_mul_f32_e64 v72, v72, v151
    v_mfma_f32_32x32x16_bf16 v[48:63], a[60:63], v[108:111], v[48:63]
    ds_read_b128 v[104:107], v13 offset:20480
    v_mul_f32 v73, v73, v151
    v_mul_f32 v74, v74, v151
    v_mul_f32_e64 v75, v75, v151
    v_mul_f32_e64 v76, v76, v151
    v_mul_f32 v77, v77, v151
    s_waitcnt lgkmcnt(3)
    v_mfma_f32_32x32x16_bf16 v[48:63], a[64:67], v[80:83], v[48:63]
    ds_read_b128 v[108:111], v14 offset:20480
    buffer_load_dwordx4 v21, s[36:39], s84 offen offset:1024 lds
    v_mul_f32 v78, v78, v151
    v_mul_f32_e64 v79, v79, v151
    v_mfma_f32_32x32x16_bf16 v[48:63], a[68:71], v[84:87], v[48:63]
    ds_read_b128 v[80:83], v11 offset:24576
    v_cvt_pk_bf16_f32 v192, v72, v73
    v_cvt_pk_bf16_f32 v193, v74, v75
    v_cvt_pk_bf16_f32 v194, v76, v77
    v_cvt_pk_bf16_f32 v195, v78, v79
    v_max3_f32 v18, v176, v177, v178
    v_mfma_f32_32x32x16_bf16 v[48:63], a[72:75], v[88:91], v[48:63]
    ds_read_b128 v[84:87], v12 offset:24576
    s_add_u32 m0, s85, 16384
    s_add_u32 s84, s84, 176128
    s_cmp_eq_u32 s84, 1409024
    s_cselect_b32 s84, 0, s84
    buffer_load_dwordx4 v20, s[36:39], s84 offen offset:0 lds
    v_mfma_f32_32x32x16_bf16 v[48:63], a[76:79], v[92:95], v[48:63]
    ds_read_b128 v[88:91], v13 offset:24576
    v_max3_f32 v19, v179, v180, v181
    v_mfma_f32_32x32x16_bf16 v[232:247], v[192:195], v[196:199], 0
    v_max3_f32 v18, v18, v182, v183
    v_max3_f32 v19, v19, v184, v185
    v_max3_f32 v18, v18, v186, v187
    v_max3_f32 v19, v19, v188, v189
    v_max3_f32 v18, v18, v190, v191
    v_max_f32 v18, v18, v19
    s_waitcnt lgkmcnt(3)
    v_mfma_f32_32x32x16_bf16 v[48:63], a[80:83], v[96:99], v[48:63]
    ds_read_b128 v[92:95], v14 offset:24576
    buffer_load_dwordx4 v21, s[36:39], s84 offen offset:1024 lds
    v_mul_f32_e64 v18, v18, v152
    v_fma_f32 v176, v176, v152, -v18
    v_fma_f32 v177, v177, v152, -v18
    v_fma_f32 v178, v178, v152, -v18
    v_mfma_f32_32x32x16_bf16 v[48:63], a[84:87], v[100:103], v[48:63]
    ds_read_b128 v[96:99], v11 offset:28672
    v_fma_f32 v179, v179, v152, -v18
    v_fma_f32 v180, v180, v152, -v18
    v_fma_f32 v181, v181, v152, -v18
    v_fma_f32 v182, v182, v152, -v18
    v_fma_f32 v183, v183, v152, -v18
    v_mfma_f32_32x32x16_bf16 v[48:63], a[88:91], v[104:107], v[48:63]
    ds_read_b128 v[100:103], v12 offset:28672
    s_add_u32 m0, s85, 24576
    s_add_u32 s84, s84, 176128
    s_cmp_eq_u32 s84, 1409024
    s_cselect_b32 s84, 0, s84
    buffer_load_dwordx4 v20, s[36:39], s84 offen offset:0 lds
    v_mfma_f32_32x32x16_bf16 v[48:63], a[92:95], v[108:111], v[48:63]
    ds_read_b128 v[104:107], v13 offset:28672
    v_fma_f32 v184, v184, v152, -v18
    v_fma_f32 v185, v185, v152, -v18
    v_fma_f32 v186, v186, v152, -v18
    v_fma_f32 v187, v187, v152, -v18
    v_fma_f32 v188, v188, v152, -v18
    v_fma_f32 v189, v189, v152, -v18
    v_fma_f32 v190, v190, v152, -v18
    v_fma_f32 v191, v191, v152, -v18
    v_exp_f32 v176, v176
    s_waitcnt lgkmcnt(3)
    v_mfma_f32_32x32x16_bf16 v[48:63], a[96:99], v[80:83], v[48:63]
    ds_read_b128 v[108:111], v14 offset:28672
    buffer_load_dwordx4 v21, s[36:39], s84 offen offset:1024 lds
    v_exp_f32 v177, v177
    v_exp_f32 v178, v178
    s_waitcnt vmcnt(18)
    s_barrier
    v_mfma_f32_32x32x16_bf16 v[48:63], a[100:103], v[84:87], v[48:63]
    ds_read_b128 v[80:83], v11 offset:32768
    s_lshr_b32 s70, s3, 1
    s_lshl1_add_u32 s70, s66, s70
    s_xor_b32 s96, s70, 1
    s_mul_i32 s70, s70, 120832
    s_mul_i32 s96, s96, 120832
    v_add_u32 v3, s70, v29
    v_add_u32 v5, s96, v29
    v_xor_b32 v4, 0x100, v3
    v_xor_b32 v6, 0x100, v5
    v_exp_f32_e64 v179, v179
    v_mfma_f32_32x32x16_bf16 v[48:63], a[104:107], v[88:91], v[48:63]
    ds_read_b128 v[84:87], v12 offset:32768
    buffer_load_dwordx4 v[36:39], v7, s[8:11], s91 offen
    v_exp_f32 v180, v180
    v_exp_f32 v181, v181
    v_mfma_f32_32x32x16_bf16 v[48:63], a[108:111], v[92:95], v[48:63]
    ds_read_b128 v[88:91], v13 offset:32768
    v_exp_f32 v182, v182
    v_exp_f32 v183, v183
    v_exp_f32 v184, v184
    s_waitcnt lgkmcnt(3)
    v_mfma_f32_32x32x16_bf16 v[48:63], a[112:115], v[96:99], v[48:63]
    ds_read_b128 v[92:95], v14 offset:32768
    s_add_u32 s0, s91, 0x2000
    buffer_load_dwordx4 v[40:43], v7, s[8:11], s0 offen
    v_exp_f32 v185, v185
    v_exp_f32 v186, v186
    v_mfma_f32_32x32x16_bf16 v[48:63], a[116:119], v[100:103], v[48:63]
    ds_read_b128 v[96:99], v11 offset:36864
    v_exp_f32 v187, v187
    v_exp_f32 v188, v188
    v_exp_f32_e64 v189, v189
    v_mfma_f32_32x32x16_bf16 v[48:63], a[120:123], v[104:107], v[48:63]
    ds_read_b128 v[100:103], v12 offset:36864
    v_exp_f32_e64 v190, v190
    v_exp_f32_e64 v191, v191
    v_add_f32 v18, v176, v177
    v_mfma_f32_32x32x16_bf16 v[48:63], a[124:127], v[108:111], v[48:63]
    ds_read_b128 v[104:107], v13 offset:36864
    s_add_u32 m0, s92, 32768
    s_lshl4_add_u32 s1, s86, s67
    buffer_load_dwordx4 v24, s[20:23], s1 offen offset:0 lds
    v_add_f32 v19, v178, v179
    v_add_f32 v18, v18, v180
    v_mfma_f32_32x32x16_bf16 v[64:79], v[112:115], v[132:135], 0
    v_add_f32 v19, v19, v181
    v_add_f32 v18, v18, v182
    v_add_f32 v19, v19, v183
    v_add_f32 v18, v18, v184
    v_add_f32 v19, v19, v185
    v_add_f32_e64 v18, v18, v186
    s_waitcnt lgkmcnt(3)
    v_mfma_f32_32x32x16_bf16 v[64:79], a[0:3], v[80:83], v[64:79]
    ds_read_b128 v[108:111], v14 offset:36864
    v_add_f32 v19, v19, v187
    v_add_f32 v18, v18, v188
    v_add_f32 v19, v19, v189
    v_add_f32 v18, v18, v190
    v_add_f32_e64 v19, v19, v191
    v_mfma_f32_32x32x16_bf16 v[64:79], a[4:7], v[84:87], v[64:79]
    ds_read_b128 v[80:83], v11 offset:40960
    buffer_load_dwordx4 v25, s[20:23], s1 offen offset:1024 lds
    v_add_f32 v18, v18, v19
    v_rcp_f32 v18, v18
    s_nop 0
    v_mfma_f32_32x32x16_bf16 v[64:79], a[8:11], v[88:91], v[64:79]
    ds_read_b128 v[84:87], v12 offset:40960
    v_mul_f32 v176, v176, v18
    v_mul_f32 v177, v177, v18
    v_mul_f32 v178, v178, v18
    v_mul_f32 v179, v179, v18
    v_mul_f32 v180, v180, v18
    v_mfma_f32_32x32x16_bf16 v[64:79], a[12:15], v[92:95], v[64:79]
    ds_read_b128 v[88:91], v13 offset:40960
    v_mul_f32 v181, v181, v18
    v_mul_f32 v182, v182, v18
    v_mul_f32 v183, v183, v18
    v_mul_f32 v184, v184, v18
    v_mul_f32 v185, v185, v18
    buffer_load_dwordx4 v26, s[20:23], s1 offen offset:2048 lds
    v_mul_f32_e64 v186, v186, v18
    s_waitcnt lgkmcnt(3)
    v_mfma_f32_32x32x16_bf16 v[64:79], a[16:19], v[96:99], v[64:79]
    ds_read_b128 v[92:95], v14 offset:40960
    v_mul_f32 v187, v187, v18
    v_mul_f32 v188, v188, v18
    v_mul_f32 v189, v189, v18
    v_mul_f32 v190, v190, v18
    v_mul_f32_e64 v191, v191, v18
    v_mfma_f32_32x32x16_bf16 v[64:79], a[20:23], v[100:103], v[64:79]
    ds_read_b128 v[96:99], v11 offset:45056
    v_cvt_pk_bf16_f32 v168, v176, v177
    v_cvt_pk_bf16_f32 v169, v178, v179
    v_cvt_pk_bf16_f32 v170, v180, v181
    v_cvt_pk_bf16_f32 v171, v182, v183
    v_cvt_pk_bf16_f32 v172, v184, v185
    v_mfma_f32_32x32x16_bf16 v[64:79], a[24:27], v[104:107], v[64:79]
    ds_read_b128 v[100:103], v12 offset:45056
    buffer_load_dwordx4 v27, s[20:23], s1 offen offset:3072 lds
    v_cvt_pk_bf16_f32 v173, v186, v187
    v_cvt_pk_bf16_f32 v174, v188, v189
    v_cvt_pk_bf16_f32 v175, v190, v191
    s_mov_b64 exec, s[32:33]
    v_cvt_pk_bf16_f32 v204, v232, v233
    v_cvt_pk_bf16_f32 v205, v234, v235
    v_cvt_pk_bf16_f32 v206, v236, v237
    v_cvt_pk_bf16_f32 v207, v238, v239
    s_mov_b64 exec, -1
    v_mfma_f32_32x32x16_bf16 v[176:191], v[168:171], v[196:199], 0
    s_waitcnt vmcnt(6)
    s_barrier
    s_mov_b64 exec, s[32:33]
    v_cvt_pk_bf16_f32 v208, v240, v241
    v_cvt_pk_bf16_f32 v209, v242, v243
    v_cvt_pk_bf16_f32 v210, v244, v245
    v_cvt_pk_bf16_f32 v211, v246, v247
    s_mov_b64 exec, -1
    v_mfma_f32_32x32x16_bf16 v[176:191], v[172:175], v[200:203], v[176:191]
    ds_read_b64_tr_b16 a[0:1], v15 offset:0
    ds_read_b64_tr_b16 a[2:3], v15 offset:512
    ds_read_b64_tr_b16 a[4:5], v15 offset:2048
    s_add_u32 m0, s92, 36864
    s_add_u32 s1, s1, 0x8000
    buffer_load_dwordx4 v24, s[20:23], s1 offen offset:0 lds
    v_mfma_f32_32x32x16_bf16 v[64:79], a[28:31], v[108:111], v[64:79]
    ds_read_b128 v[104:107], v13 offset:45056
    ds_read_b64_tr_b16 a[6:7], v15 offset:2560
    ds_read_b64_tr_b16 a[8:9], v15 offset:4096
    ds_read_b64_tr_b16 a[10:11], v15 offset:4608
    s_nop 0
    v_cvt_pk_bf16_f32 v168, v176, v177
    s_waitcnt lgkmcnt(9)
    v_mfma_f32_32x32x16_bf16 v[64:79], a[32:35], v[80:83], v[64:79]
    ds_read_b128 v[108:111], v14 offset:45056
    ds_read_b64_tr_b16 a[12:13], v15 offset:6144
    ds_read_b64_tr_b16 a[14:15], v15 offset:6656
    ds_read_b64_tr_b16 a[16:17], v15 offset:8192
    v_cvt_pk_bf16_f32 v169, v178, v179
    v_cvt_pk_bf16_f32 v170, v180, v181
    v_mfma_f32_32x32x16_bf16 v[64:79], a[36:39], v[84:87], v[64:79]
    ds_read_b128 v[80:83], v11 offset:49152
    ds_read_b64_tr_b16 a[18:19], v15 offset:8704
    ds_read_b64_tr_b16 a[20:21], v15 offset:10240
    ds_read_b64_tr_b16 a[22:23], v15 offset:10752
    buffer_load_dwordx4 v25, s[20:23], s1 offen offset:1024 lds
    v_cvt_pk_bf16_f32 v171, v182, v183
    v_mfma_f32_32x32x16_bf16 v[64:79], a[40:43], v[88:91], v[64:79]
    ds_read_b128 v[84:87], v12 offset:49152
    ds_read_b64_tr_b16 a[24:25], v15 offset:12288
    ds_read_b64_tr_b16 a[26:27], v15 offset:12800
    ds_read_b64_tr_b16 a[28:29], v15 offset:14336
    v_cvt_pk_bf16_f32 v172, v184, v185
    v_cvt_pk_bf16_f32 v173, v186, v187
    v_mfma_f32_32x32x16_bf16 v[64:79], a[44:47], v[92:95], v[64:79]
    ds_read_b128 v[88:91], v13 offset:49152
    ds_read_b64_tr_b16 a[30:31], v15 offset:14848
    ds_read_b64_tr_b16 a[32:33], v15 offset:16384
    ds_read_b64_tr_b16 a[34:35], v15 offset:16896
    v_cvt_pk_bf16_f32 v174, v188, v189
    v_cvt_pk_bf16_f32 v175, v190, v191
    v_mfma_f32_32x32x16_bf16 v[216:231], v[168:171], v[204:207], v[216:231]
    ds_read_b64_tr_b16 a[36:37], v15 offset:18432
    ds_read_b64_tr_b16 a[38:39], v15 offset:18944
    ds_read_b64_tr_b16 a[40:41], v15 offset:20480
    buffer_load_dwordx4 v26, s[20:23], s1 offen offset:2048 lds
    s_waitcnt lgkmcnt(15)
    v_mfma_f32_32x32x16_bf16 v[216:231], v[172:175], v[208:211], v[216:231]
    ds_read_b64_tr_b16 a[42:43], v15 offset:20992
    ds_read_b64_tr_b16 a[44:45], v15 offset:22528
    ds_read_b64_tr_b16 a[46:47], v15 offset:23040
    v_cvt_pk_bf16_f32 v164, v48, v49
    v_cvt_pk_bf16_f32 v165, v50, v51
    v_cvt_pk_bf16_f32 v166, v52, v53
    v_mfma_f32_32x32x16_bf16 v[64:79], a[48:51], v[96:99], v[64:79]
    ds_read_b128 v[92:95], v14 offset:49152
    ds_read_b64_tr_b16 a[48:49], v15 offset:24576
    ds_read_b64_tr_b16 a[50:51], v15 offset:25088
    v_cvt_pk_bf16_f32 v167, v54, v55
    s_nop 1
    v_mfma_f32_32x32x16_bf16 v[176:191], v[212:215], v[164:167], 0
    buffer_load_dwordx4 v27, s[20:23], s1 offen offset:3072 lds
L_pad_att_1:
    s_cbranch_execz L_ret_att
    v_mul_f32 v56, v56, v154
    v_mul_f32 v57, v57, v154
    v_mul_f32 v58, v58, v154
    v_mul_f32 v59, v59, v154
    v_mul_f32 v60, v60, v154
    v_mfma_f32_32x32x16_bf16 v[64:79], a[52:55], v[100:103], v[64:79]
    ds_read_b128 v[96:99], v11 offset:53248
    ds_read_b64_tr_b16 a[52:53], v15 offset:26624
    ds_read_b64_tr_b16 a[54:55], v15 offset:27136
    v_mul_f32_e64 v61, v61, v154
    v_mul_f32_e64 v62, v62, v154
    v_mul_f32_e64 v63, v63, v154
    v_mfma_f32_32x32x16_bf16 v[64:79], a[56:59], v[104:107], v[64:79]
    ds_read_b128 v[100:103], v12 offset:53248
    ds_read_b64_tr_b16 a[56:57], v15 offset:28672
    ds_read_b64_tr_b16 a[58:59], v15 offset:29184
    v_cvt_pk_bf16_f32 v192, v56, v57
    v_cvt_pk_bf16_f32 v193, v58, v59
    v_cvt_pk_bf16_f32 v194, v60, v61
    v_mfma_f32_32x32x16_bf16 v[64:79], a[60:63], v[108:111], v[64:79]
    ds_read_b128 v[104:107], v13 offset:53248
    ds_read_b64_tr_b16 a[60:61], v15 offset:30720
    ds_read_b64_tr_b16 a[62:63], v15 offset:31232
    v_subrev_u32 v15, 131072, v15
    v_cvt_pk_bf16_f32 v195, v62, v63
    v_max3_f32 v18, v176, v177, v178
    s_waitcnt lgkmcnt(11)
    v_mfma_f32_32x32x16_bf16 v[64:79], a[64:67], v[80:83], v[64:79]
    ds_read_b128 v[108:111], v14 offset:53248
    ds_read_b64_tr_b16 a[64:65], v15 offset:0
    ds_read_b64_tr_b16 a[66:67], v15 offset:512
    v_max3_f32 v19, v179, v180, v181
    v_mfma_f32_32x32x16_bf16 v[232:247], v[192:195], v[196:199], 0
    v_max3_f32 v18, v18, v182, v183
    v_max3_f32 v19, v19, v184, v185
    v_max3_f32 v18, v18, v186, v187
    v_max3_f32 v19, v19, v188, v189
    v_max3_f32 v18, v18, v190, v191
    v_max_f32 v18, v18, v19
    v_mfma_f32_32x32x16_bf16 v[64:79], a[68:71], v[84:87], v[64:79]
    ds_read_b128 v[80:83], v11 offset:57344
    ds_read_b64_tr_b16 a[68:69], v15 offset:2048
    ds_read_b64_tr_b16 a[70:71], v15 offset:2560
    v_mul_f32 v18, v18, v155
    v_fma_f32 v176, v176, v155, -v18
    v_fma_f32 v177, v177, v155, -v18
    v_mfma_f32_32x32x16_bf16 v[64:79], a[72:75], v[88:91], v[64:79]
    ds_read_b128 v[84:87], v12 offset:57344
    ds_read_b64_tr_b16 a[72:73], v15 offset:4096
    ds_read_b64_tr_b16 a[74:75], v15 offset:4608
    v_fma_f32 v178, v178, v155, -v18
    v_fma_f32 v179, v179, v155, -v18
    v_fma_f32 v180, v180, v155, -v18
    v_mfma_f32_32x32x16_bf16 v[64:79], a[76:79], v[92:95], v[64:79]
    ds_read_b128 v[88:91], v13 offset:57344
    ds_read_b64_tr_b16 a[76:77], v15 offset:6144
    ds_read_b64_tr_b16 a[78:79], v15 offset:6656
    s_waitcnt lgkmcnt(12)
    s_barrier
    s_waitcnt lgkmcnt(11)
    v_mfma_f32_32x32x16_bf16 v[64:79], a[80:83], v[96:99], v[64:79]
    ds_read_b128 v[92:95], v14 offset:57344
    ds_read_b64_tr_b16 a[80:81], v15 offset:8192
    ds_read_b64_tr_b16 a[82:83], v15 offset:8704
    s_add_u32 m0, s92, 131072
    s_add_u32 s1, s1, 0x8000
    buffer_load_dwordx4 v24, s[20:23], s1 offen offset:0 lds
    v_mfma_f32_32x32x16_bf16 v[64:79], a[84:87], v[100:103], v[64:79]
    ds_read_b128 v[96:99], v11 offset:61440
    ds_read_b64_tr_b16 a[84:85], v15 offset:10240
    ds_read_b64_tr_b16 a[86:87], v15 offset:10752
    v_fma_f32 v181, v181, v155, -v18
    v_fma_f32 v182, v182, v155, -v18
    v_fma_f32 v183, v183, v155, -v18
    v_mfma_f32_32x32x16_bf16 v[64:79], a[88:91], v[104:107], v[64:79]
    ds_read_b128 v[100:103], v12 offset:61440
    ds_read_b64_tr_b16 a[88:89], v15 offset:12288
    ds_read_b64_tr_b16 a[90:91], v15 offset:12800
    v_fma_f32 v184, v184, v155, -v18
    v_fma_f32 v185, v185, v155, -v18
    v_fma_f32 v186, v186, v155, -v18
    v_mfma_f32_32x32x16_bf16 v[64:79], a[92:95], v[108:111], v[64:79]
    ds_read_b128 v[104:107], v13 offset:61440
    ds_read_b64_tr_b16 a[92:93], v15 offset:14336
    ds_read_b64_tr_b16 a[94:95], v15 offset:14848
    buffer_load_dwordx4 v25, s[20:23], s1 offen offset:1024 lds
    v_fma_f32 v187, v187, v155, -v18
    v_fma_f32 v188, v188, v155, -v18
    v_fma_f32 v189, v189, v155, -v18
    v_fma_f32 v190, v190, v155, -v18
    v_fma_f32 v191, v191, v155, -v18
    v_exp_f32 v176, v176
    s_waitcnt lgkmcnt(11)
    v_mfma_f32_32x32x16_bf16 v[64:79], a[96:99], v[80:83], v[64:79]
    ds_read_b128 v[108:111], v14 offset:61440
    ds_read_b64_tr_b16 a[96:97], v15 offset:16384
    ds_read_b64_tr_b16 a[98:99], v15 offset:16896
    v_exp_f32 v177, v177
    v_exp_f32 v178, v178
    v_exp_f32 v179, v179
    v_exp_f32 v180, v180
    v_exp_f32 v181, v181
    v_exp_f32 v182, v182
    v_mfma_f32_32x32x16_bf16 v[64:79], a[100:103], v[84:87], v[64:79]
    ds_read_b64_tr_b16 a[100:101], v15 offset:18432
    ds_read_b64_tr_b16 a[102:103], v15 offset:18944
    buffer_load_dwordx4 v26, s[20:23], s1 offen offset:2048 lds
    v_exp_f32 v183, v183
    v_exp_f32 v184, v184
    v_exp_f32 v185, v185
    v_exp_f32 v186, v186
    v_mfma_f32_32x32x16_bf16 v[64:79], a[104:107], v[88:91], v[64:79]
    ds_read_b64_tr_b16 a[104:105], v15 offset:20480
    ds_read_b64_tr_b16 a[106:107], v15 offset:20992
    v_exp_f32 v187, v187
    v_exp_f32 v188, v188
    v_mfma_f32_32x32x16_bf16 v[64:79], a[108:111], v[92:95], v[64:79]
    ds_read_b64_tr_b16 a[108:109], v15 offset:22528
    ds_read_b64_tr_b16 a[110:111], v15 offset:23040
    buffer_load_dwordx4 v27, s[20:23], s1 offen offset:3072 lds
    v_exp_f32 v189, v189
    v_exp_f32_e64 v190, v190
    s_waitcnt lgkmcnt(8)
    v_mfma_f32_32x32x16_bf16 v[64:79], a[112:115], v[96:99], v[64:79]
    ds_read_b64_tr_b16 a[112:113], v15 offset:24576
    ds_read_b64_tr_b16 a[114:115], v15 offset:25088
    v_exp_f32 v191, v191
    v_add_f32 v18, v176, v177
    v_add_f32 v19, v178, v179
    v_add_f32 v18, v18, v180
    v_add_f32_e64 v19, v19, v181
    v_mfma_f32_32x32x16_bf16 v[64:79], a[116:119], v[100:103], v[64:79]
    ds_read_b64_tr_b16 a[116:117], v15 offset:26624
    ds_read_b64_tr_b16 a[118:119], v15 offset:27136
    s_add_u32 m0, s92, 135168
    s_add_u32 s1, s1, 0x8000
    buffer_load_dwordx4 v24, s[20:23], s1 offen offset:0 lds
    v_add_f32_e64 v18, v18, v182
    v_mfma_f32_32x32x16_bf16 v[64:79], a[120:123], v[104:107], v[64:79]
    ds_read_b64_tr_b16 a[120:121], v15 offset:28672
    ds_read_b64_tr_b16 a[122:123], v15 offset:29184
    v_add_f32 v19, v19, v183
    v_add_f32 v18, v18, v184
    v_add_f32 v19, v19, v185
    v_add_f32 v18, v18, v186
    v_add_f32 v19, v19, v187
    v_add_f32 v18, v18, v188
    v_mfma_f32_32x32x16_bf16 v[64:79], a[124:127], v[108:111], v[64:79]
    ds_read_b64_tr_b16 a[124:125], v15 offset:30720
    ds_read_b64_tr_b16 a[126:127], v15 offset:31232
    v_add_u32 v20, s92, v28
    v_xor_b32 v21, 32, v20
    v_xor_b32_e64 v22, 64, v20
    v_xor_b32 v23, 96, v20
    v_mfma_f32_32x32x16_bf16 v[48:63], a[0:3], a[128:131], 0
    buffer_load_dwordx4 v25, s[20:23], s1 offen offset:1024 lds
    v_add_f32 v19, v19, v189
    v_add_f32 v18, v18, v190
    v_add_f32 v19, v19, v191
    v_add_f32 v18, v18, v19
    v_rcp_f32_e64 v18, v18
    v_mfma_f32_32x32x16_bf16 v[48:63], a[4:7], a[132:135], v[48:63]
    v_mul_f32 v176, v176, v18
    v_mul_f32 v177, v177, v18
    v_mul_f32 v178, v178, v18
    v_mul_f32 v179, v179, v18
    v_mul_f32 v180, v180, v18
    v_mul_f32 v181, v181, v18
    v_mfma_f32_32x32x16_bf16 v[48:63], a[8:11], a[136:139], v[48:63]
    v_mul_f32 v182, v182, v18
    v_mul_f32 v183, v183, v18
    v_mul_f32 v184, v184, v18
    v_mul_f32 v185, v185, v18
    v_mul_f32 v186, v186, v18
    v_mul_f32 v187, v187, v18
    v_mul_f32 v188, v188, v18
    v_mul_f32 v189, v189, v18
    buffer_load_dwordx4 v26, s[20:23], s1 offen offset:2048 lds
    s_waitcnt lgkmcnt(0)
    s_barrier
    v_mul_f32 v190, v190, v18
    v_mul_f32 v191, v191, v18
    v_cvt_pk_bf16_f32 v168, v176, v177
    v_cvt_pk_bf16_f32 v169, v178, v179
    v_cvt_pk_bf16_f32 v170, v180, v181
    v_cvt_pk_bf16_f32 v171, v182, v183
    v_cvt_pk_bf16_f32 v172, v184, v185
    v_cvt_pk_bf16_f32 v173, v186, v187
    v_cvt_pk_bf16_f32 v174, v188, v189
    v_mfma_f32_32x32x16_bf16 v[48:63], a[12:15], a[140:143], v[48:63]
    v_cvt_pk_bf16_f32 v175, v190, v191
    s_mov_b64 exec, s[32:33]
    v_cvt_pk_bf16_f32 v204, v232, v233
    v_cvt_pk_bf16_f32 v205, v234, v235
    v_cvt_pk_bf16_f32 v206, v236, v237
    v_cvt_pk_bf16_f32 v207, v238, v239
    s_mov_b64 exec, -1
    v_mfma_f32_32x32x16_bf16 v[176:191], v[168:171], v[196:199], 0
    buffer_load_dwordx4 v27, s[20:23], s1 offen offset:3072 lds
    s_mov_b64 exec, s[32:33]
    v_cvt_pk_bf16_f32 v208, v240, v241
    v_cvt_pk_bf16_f32 v209, v242, v243
    v_cvt_pk_bf16_f32 v210, v244, v245
    v_cvt_pk_bf16_f32 v211, v246, v247
    s_mov_b64 exec, -1
    v_mfma_f32_32x32x16_bf16 v[176:191], v[172:175], v[200:203], v[176:191]
    s_nop 5
    s_nop 5
    v_cvt_pk_bf16_f32 v168, v176, v177
    v_cvt_pk_bf16_f32 v169, v178, v179
    v_cvt_pk_bf16_f32 v170, v180, v181
    v_cvt_pk_bf16_f32 v171, v182, v183
    s_add_u32 m0, s92, 0
    s_lshl4_add_u32 s1, s87, s67
    buffer_load_dwordx4 v24, s[20:23], s1 offen offset:0 lds
    v_cvt_pk_bf16_f32 v172, v184, v185
    v_cvt_pk_bf16_f32 v173, v186, v187
    v_cvt_pk_bf16_f32 v174, v188, v189
    v_cvt_pk_bf16_f32 v175, v190, v191
    v_mfma_f32_32x32x16_bf16 v[216:231], v[168:171], v[204:207], v[216:231]
    s_nop 0
    v_mfma_f32_32x32x16_bf16 v[216:231], v[172:175], v[208:211], v[216:231]
    v_cvt_pk_bf16_f32 v164, v64, v65
    v_cvt_pk_bf16_f32 v165, v66, v67
    v_cvt_pk_bf16_f32 v166, v68, v69
    v_cvt_pk_bf16_f32 v167, v70, v71
    s_nop 1
    v_mfma_f32_32x32x16_bf16 v[176:191], v[212:215], v[164:167], 0
    buffer_load_dwordx4 v25, s[20:23], s1 offen offset:1024 lds
    v_mul_f32 v72, v72, v157
    v_mul_f32 v73, v73, v157
    v_mul_f32 v74, v74, v157
    v_mul_f32 v75, v75, v157
    v_mul_f32 v76, v76, v157
    v_mul_f32 v77, v77, v157
    v_mul_f32 v78, v78, v157
    v_mul_f32 v79, v79, v157
    v_cvt_pk_bf16_f32 v192, v72, v73
    v_cvt_pk_bf16_f32 v193, v74, v75
    v_cvt_pk_bf16_f32 v194, v76, v77
    v_mfma_f32_32x32x16_bf16 v[48:63], a[16:19], a[144:147], v[48:63]
    v_cvt_pk_bf16_f32 v195, v78, v79
    v_max3_f32 v18, v176, v177, v178
    v_max3_f32 v19, v179, v180, v181
    v_mfma_f32_32x32x16_bf16 v[232:247], v[192:195], v[196:199], 0
    buffer_load_dwordx4 v26, s[20:23], s1 offen offset:2048 lds
    v_max3_f32 v18, v18, v182, v183
    v_max3_f32 v19, v19, v184, v185
    v_max3_f32 v18, v18, v186, v187
    v_max3_f32 v19, v19, v188, v189
    v_max3_f32 v18, v18, v190, v191
    v_max_f32 v18, v18, v19
    v_mul_f32 v18, v18, v158
    v_fma_f32 v176, v176, v158, -v18
    v_fma_f32 v177, v177, v158, -v18
    v_fma_f32 v178, v178, v158, -v18
    v_fma_f32 v179, v179, v158, -v18
    v_fma_f32 v180, v180, v158, -v18
    v_fma_f32 v181, v181, v158, -v18
    v_fma_f32 v182, v182, v158, -v18
    v_fma_f32 v183, v183, v158, -v18
    v_fma_f32 v184, v184, v158, -v18
    v_fma_f32 v185, v185, v158, -v18
    v_fma_f32 v186, v186, v158, -v18
    v_fma_f32 v187, v187, v158, -v18
    v_fma_f32 v188, v188, v158, -v18
    v_fma_f32 v189, v189, v158, -v18
    v_fma_f32 v190, v190, v158, -v18
    v_fma_f32 v191, v191, v158, -v18
    v_exp_f32 v176, v176
    buffer_load_dwordx4 v27, s[20:23], s1 offen offset:3072 lds
    v_exp_f32 v177, v177
    v_exp_f32 v178, v178
    v_exp_f32 v179, v179
    v_exp_f32 v180, v180
    v_exp_f32 v181, v181
    v_exp_f32_e64 v182, v182
    v_mfma_f32_32x32x16_bf16 v[48:63], a[20:23], a[148:151], v[48:63]
    s_add_u32 m0, s92, 4096
    s_add_u32 s1, s1, 0x8000
    buffer_load_dwordx4 v24, s[20:23], s1 offen offset:0 lds
    v_exp_f32 v183, v183
    v_exp_f32 v184, v184
    v_exp_f32 v185, v185
    v_exp_f32 v186, v186
    v_exp_f32 v187, v187
    v_exp_f32 v188, v188
    v_exp_f32 v189, v189
    v_exp_f32 v190, v190
    v_exp_f32 v191, v191
    v_add_f32 v18, v176, v177
    v_add_f32 v19, v178, v179
    v_add_f32 v18, v18, v180
    v_add_f32 v19, v19, v181
    v_add_f32 v18, v18, v182
    v_add_f32 v19, v19, v183
    buffer_load_dwordx4 v25, s[20:23], s1 offen offset:1024 lds
    v_add_f32 v18, v18, v184
    v_add_f32 v19, v19, v185
    v_add_f32 v18, v18, v186
    v_add_f32 v19, v19, v187
    v_add_f32 v18, v18, v188
    v_add_f32 v19, v19, v189
    v_add_f32 v18, v18, v190
    v_add_f32 v19, v19, v191
    v_add_f32 v18, v18, v19
    v_rcp_f32 v18, v18
    s_nop 0
    v_mul_f32 v176, v176, v18
    v_mul_f32 v177, v177, v18
    v_mul_f32 v178, v178, v18
    v_mul_f32 v179, v179, v18
    v_mul_f32 v180, v180, v18
    v_mul_f32 v181, v181, v18
    v_mul_f32 v182, v182, v18
    v_mul_f32 v183, v183, v18
    v_mul_f32 v184, v184, v18
    v_mul_f32 v185, v185, v18
    v_mul_f32 v186, v186, v18
    v_mul_f32 v187, v187, v18
    buffer_load_dwordx4 v26, s[20:23], s1 offen offset:2048 lds
    v_mul_f32 v188, v188, v18
    v_mul_f32 v189, v189, v18
    v_mfma_f32_32x32x16_bf16 v[48:63], a[24:27], a[152:155], v[48:63]
    v_mul_f32 v190, v190, v18
    v_mul_f32 v191, v191, v18
    v_cvt_pk_bf16_f32 v168, v176, v177
    v_cvt_pk_bf16_f32 v169, v178, v179
    v_cvt_pk_bf16_f32 v170, v180, v181
    v_cvt_pk_bf16_f32 v171, v182, v183
    v_cvt_pk_bf16_f32 v172, v184, v185
    v_cvt_pk_bf16_f32 v173, v186, v187
    v_cvt_pk_bf16_f32 v174, v188, v189
    v_cvt_pk_bf16_f32 v175, v190, v191
    s_mov_b64 exec, s[32:33]
    v_cvt_pk_bf16_f32 v204, v232, v233
    v_cvt_pk_bf16_f32 v205, v234, v235
    v_cvt_pk_bf16_f32 v206, v236, v237
    v_cvt_pk_bf16_f32 v207, v238, v239
    s_mov_b64 exec, -1
    v_mfma_f32_32x32x16_bf16 v[176:191], v[168:171], v[196:199], 0
    buffer_load_dwordx4 v27, s[20:23], s1 offen offset:3072 lds
    s_mov_b64 exec, s[32:33]
    v_cvt_pk_bf16_f32 v208, v240, v241
    v_cvt_pk_bf16_f32 v209, v242, v243
    v_cvt_pk_bf16_f32 v210, v244, v245
    v_cvt_pk_bf16_f32 v211, v246, v247
    s_mov_b64 exec, -1
    v_mfma_f32_32x32x16_bf16 v[176:191], v[172:175], v[200:203], v[176:191]
    s_nop 5
    s_nop 5
    v_cvt_pk_bf16_f32 v168, v176, v177
    v_cvt_pk_bf16_f32 v169, v178, v179
    v_cvt_pk_bf16_f32 v170, v180, v181
    v_cvt_pk_bf16_f32 v171, v182, v183
    v_cvt_pk_bf16_f32 v172, v184, v185
    v_cvt_pk_bf16_f32 v173, v186, v187
    v_cvt_pk_bf16_f32 v174, v188, v189
    v_cvt_pk_bf16_f32 v175, v190, v191
    v_mfma_f32_32x32x16_bf16 v[216:231], v[168:171], v[204:207], v[216:231]
    s_nop 0
    v_mfma_f32_32x32x16_bf16 v[216:231], v[172:175], v[208:211], v[216:231]
    s_mul_i32 s71, s4, 960
    s_sub_u32 s71, 15360, s71
    v_lshrrev_b32 v19, 8, v10
    v_mad_u32_u24 v18, v19, s71, v34
    v_mad_u32_u24 v19, v19, s71, v35
    s_mul_i32 s71, s6, 17
    s_add_u32 s71, s71, s4
    s_lshl_b32 s71, s71, 10
    s_add_u32 s71, s71, 262144
    s_nop 2
    v_cvt_pk_bf16_f32 v168, v216, v217
    v_cvt_pk_bf16_f32 v169, v218, v219
    v_mfma_f32_32x32x16_bf16 v[48:63], a[28:31], a[156:159], v[48:63]
    v_cvt_pk_bf16_f32 v170, v220, v221
    v_cvt_pk_bf16_f32 v171, v222, v223
    buffer_store_dwordx4 v[168:171], v18, s[16:19], s71 offen sc1
    v_cvt_pk_bf16_f32 v172, v224, v225
    v_cvt_pk_bf16_f32 v173, v226, v227
    v_cvt_pk_bf16_f32 v174, v228, v229
    v_cvt_pk_bf16_f32 v175, v230, v231
    buffer_store_dwordx4 v[172:175], v19, s[16:19], s71 offen sc1
    v_mfma_f32_16x16x32_bf16 v[140:143], v[144:147], a[0:3], 0
    s_waitcnt vmcnt(22)
    ds_read_b64_tr_b16 a[128:129], v20 offset:32768
    v_mfma_f32_16x16x32_bf16 v[140:143], v[144:147], a[4:7], v[140:143]
    ds_read_b64_tr_b16 a[130:131], v20 offset:33280
    s_lshl4_add_u32 s73, s6, s4
    v_mfma_f32_16x16x32_bf16 v[140:143], v[144:147], a[8:11], v[140:143]
    ds_read_b64_tr_b16 a[132:133], v21 offset:32768
    s_lshl_b32 s73, s73, 3
    v_mfma_f32_16x16x32_bf16 v[140:143], v[144:147], a[12:15], v[140:143]
    ds_read_b64_tr_b16 a[134:135], v21 offset:33280
    s_add_u32 s73, s73, 4096
    v_mfma_f32_32x32x16_bf16 v[48:63], a[32:35], a[160:163], v[48:63]
    ds_read_b64_tr_b16 a[136:137], v22 offset:32768
    ds_read_b64_tr_b16 a[138:139], v22 offset:33280
    ds_read_b64_tr_b16 a[140:141], v23 offset:32768
    ds_read_b64_tr_b16 a[142:143], v23 offset:33280
    s_waitcnt vmcnt(18)
    ds_read_b64_tr_b16 a[144:145], v20 offset:36864
    v_mfma_f32_32x32x16_bf16 v[48:63], a[36:39], a[164:167], v[48:63]
    ds_read_b64_tr_b16 a[146:147], v20 offset:37376
    ds_read_b64_tr_b16 a[148:149], v21 offset:36864
    ds_read_b64_tr_b16 a[150:151], v21 offset:37376
    ds_read_b64_tr_b16 a[152:153], v22 offset:36864
    ds_read_b64_tr_b16 a[154:155], v22 offset:37376
    v_mfma_f32_16x16x32_bf16 v[140:143], v[144:147], a[16:19], v[140:143]
    ds_read_b64_tr_b16 a[156:157], v23 offset:36864
    s_cmp_lg_u32 s98, 0
    s_cselect_b32 s71, s81, s80
    s_cselect_b32 s81, s80, s81
    s_mov_b32 s80, s71
    v_mfma_f32_16x16x32_bf16 v[140:143], v[144:147], a[20:23], v[140:143]
    ds_read_b64_tr_b16 a[158:159], v23 offset:37376
    v_cndmask_b32 v160, v148, v148, s[98:99]
    v_mfma_f32_16x16x32_bf16 v[140:143], v[144:147], a[24:27], v[140:143]
    v_cndmask_b32 v162, v150, v150, s[98:99]
    v_mul_f32_e64 v161, v160, v160
    v_mfma_f32_16x16x32_bf16 v[140:143], v[144:147], a[28:31], v[140:143]
    v_mul_f32 v160, 0xc0135761, v160
    v_mfma_f32_16x16x32_bf16 v[140:143], v[144:147], a[32:35], v[140:143]
    v_mul_f32 v161, v161, v160
    v_mul_f32 v161, 0x3d372713, v161
    v_mfma_f32_16x16x32_bf16 v[140:143], v[144:147], a[36:39], v[140:143]
    s_waitcnt lgkmcnt(8)
    v_mfma_f32_16x16x32_bf16 v[140:143], v[144:147], a[40:43], v[140:143]
    s_add_u32 m0, s92, 32768
    s_add_u32 s1, s1, 0x8000
    buffer_load_dwordx4 v24, s[20:23], s1 offen offset:0 lds
    v_mfma_f32_16x16x32_bf16 v[140:143], v[144:147], a[44:47], v[140:143]
    v_mfma_f32_16x16x32_bf16 v[140:143], v[144:147], a[48:51], v[140:143]
    v_mfma_f32_16x16x32_bf16 v[140:143], v[144:147], a[52:55], v[140:143]
    v_mfma_f32_16x16x32_bf16 v[140:143], v[144:147], a[56:59], v[140:143]
    buffer_load_dwordx4 v25, s[20:23], s1 offen offset:1024 lds
    v_mfma_f32_16x16x32_bf16 v[140:143], v[144:147], a[60:63], v[140:143]
    v_mfma_f32_16x16x32_bf16 v[140:143], v[144:147], a[64:67], v[140:143]
    v_mfma_f32_16x16x32_bf16 v[140:143], v[144:147], a[68:71], v[140:143]
    v_mfma_f32_16x16x32_bf16 v[140:143], v[144:147], a[72:75], v[140:143]
    buffer_load_dwordx4 v26, s[20:23], s1 offen offset:2048 lds
    v_mfma_f32_16x16x32_bf16 v[140:143], v[144:147], a[76:79], v[140:143]
    v_mfma_f32_16x16x32_bf16 v[140:143], v[144:147], a[80:83], v[140:143]
    v_mfma_f32_16x16x32_bf16 v[140:143], v[144:147], a[84:87], v[140:143]
    v_mfma_f32_16x16x32_bf16 v[140:143], v[144:147], a[88:91], v[140:143]
    buffer_load_dwordx4 v27, s[20:23], s1 offen offset:3072 lds
    v_mfma_f32_16x16x32_bf16 v[140:143], v[144:147], a[92:95], v[140:143]
    v_mfma_f32_16x16x32_bf16 v[140:143], v[144:147], a[96:99], v[140:143]
    v_mfma_f32_16x16x32_bf16 v[140:143], v[144:147], a[100:103], v[140:143]
    v_mfma_f32_16x16x32_bf16 v[140:143], v[144:147], a[104:107], v[140:143]
    v_mfma_f32_16x16x32_bf16 v[140:143], v[144:147], a[108:111], v[140:143]
    v_mfma_f32_16x16x32_bf16 v[140:143], v[144:147], a[112:115], v[140:143]
    v_mfma_f32_16x16x32_bf16 v[140:143], v[144:147], a[116:119], v[140:143]
    v_mfma_f32_16x16x32_bf16 v[140:143], v[144:147], a[120:123], v[140:143]
    v_mfma_f32_16x16x32_bf16 v[140:143], v[144:147], a[124:127], v[140:143]
    s_nop 1
    v_mfma_f32_32x32x16_bf16 v[48:63], a[40:43], a[168:171], v[48:63]
    s_waitcnt vmcnt(4)
    s_mov_b64 exec, 1
    buffer_store_dwordx2 v[8:9], v33, s[16:19], s73 offen sc1
    s_mov_b64 exec, -1
    s_nop 1
    v_mfma_f32_32x32x16_bf16 v[48:63], a[44:47], a[172:175], v[48:63]
    v_cvt_pk_bf16_f32 v116, v140, v140
    v_lshlrev_b32 v17, 16, v116
    v_sub_f32_e64 v16, v140, v17
    v_cvt_pk_bf16_f32 v117, v16, v16
    v_add_u32 v20, 131072, v20
    v_add_u32 v21, 131072, v21
    v_mfma_f32_32x32x16_bf16 v[48:63], a[48:51], a[176:179], v[48:63]
    v_add_u32 v22, 131072, v22
    v_add_u32 v23, 131072, v23
    v_mfma_f32_32x32x16_bf16 v[48:63], a[52:55], a[180:183], v[48:63]
    ds_read_b64_tr_b16 a[160:161], v20 offset:0
    ds_read_b64_tr_b16 a[162:163], v20 offset:512
    ds_read_b64_tr_b16 a[164:165], v21 offset:0
    ds_read_b64_tr_b16 a[166:167], v21 offset:512
    ds_read_b64_tr_b16 a[168:169], v22 offset:0
    v_mfma_f32_32x32x16_bf16 v[48:63], a[56:59], a[184:187], v[48:63]
    ds_read_b64_tr_b16 a[170:171], v22 offset:512
    ds_read_b64_tr_b16 a[172:173], v23 offset:0
    ds_read_b64_tr_b16 a[174:175], v23 offset:512
    s_waitcnt lgkmcnt(8)
    v_mfma_f32_32x32x16_bf16 v[48:63], a[60:63], a[188:191], v[48:63]
    ds_read_b64_tr_b16 a[176:177], v20 offset:4096
    ds_read_b64_tr_b16 a[178:179], v20 offset:4608
    ds_read_b64_tr_b16 a[180:181], v21 offset:4096
    ds_read_b64_tr_b16 a[182:183], v21 offset:4608
    ds_read_b64_tr_b16 a[184:185], v22 offset:4096
    s_add_u32 m0, s92, 36864
    s_add_u32 s1, s1, 0x8000
    buffer_load_dwordx4 v24, s[20:23], s1 offen offset:0 lds
    v_mfma_f32_32x32x16_bf16 v[48:63], a[64:67], a[192:195], v[48:63]
    ds_read_b64_tr_b16 a[186:187], v22 offset:4608
    ds_read_b64_tr_b16 a[188:189], v23 offset:4096
    ds_read_b64_tr_b16 a[190:191], v23 offset:4608
    v_mfma_f32_32x32x16_bf16 v[48:63], a[68:71], a[196:199], v[48:63]
    v_mfma_f32_32x32x16_bf16 v[48:63], a[72:75], a[200:203], v[48:63]
    buffer_load_dwordx4 v25, s[20:23], s1 offen offset:1024 lds
    s_waitcnt lgkmcnt(8)
    v_mfma_f32_32x32x16_bf16 v[48:63], a[76:79], a[204:207], v[48:63]
    v_add_u32 v20, -131072, v20
    v_add_u32 v21, -131072, v21
    v_add_u32 v22, -131072, v22
    v_add_u32 v23, -131072, v23
    v_mfma_f32_32x32x16_bf16 v[48:63], a[80:83], a[208:211], v[48:63]
    ds_read_b64_tr_b16 a[192:193], v20 offset:0
    ds_read_b64_tr_b16 a[194:195], v20 offset:512
    ds_read_b64_tr_b16 a[196:197], v21 offset:0
    ds_read_b64_tr_b16 a[198:199], v21 offset:512
    ds_read_b64_tr_b16 a[200:201], v22 offset:0
    buffer_load_dwordx4 v26, s[20:23], s1 offen offset:2048 lds
    v_mfma_f32_32x32x16_bf16 v[48:63], a[84:87], a[212:215], v[48:63]
    ds_read_b64_tr_b16 a[202:203], v22 offset:512
    ds_read_b64_tr_b16 a[204:205], v23 offset:0
    ds_read_b64_tr_b16 a[206:207], v23 offset:512
    s_waitcnt lgkmcnt(8)
    v_mfma_f32_32x32x16_bf16 v[48:63], a[88:91], a[216:219], v[48:63]
    v_mfma_f32_32x32x16_bf16 v[48:63], a[92:95], a[220:223], v[48:63]
    ds_read_b64_tr_b16 a[208:209], v20 offset:4096
    ds_read_b64_tr_b16 a[210:211], v20 offset:4608
    ds_read_b64_tr_b16 a[212:213], v21 offset:4096
    ds_read_b64_tr_b16 a[214:215], v21 offset:4608
    ds_read_b64_tr_b16 a[216:217], v22 offset:4096
    buffer_load_dwordx4 v27, s[20:23], s1 offen offset:3072 lds
    v_mfma_f32_32x32x16_bf16 v[48:63], a[96:99], a[224:227], v[48:63]
    ds_read_b64_tr_b16 a[218:219], v22 offset:4608
    ds_read_b64_tr_b16 a[220:221], v23 offset:4096
    ds_read_b64_tr_b16 a[222:223], v23 offset:4608
    v_add_u32 v11, s97, v11
    v_add_u32_e64 v12, s97, v12
    v_add_u32_e64 v13, s97, v13
    v_add_u32 v14, s97, v14
    v_mfma_f32_32x32x16_bf16 v[48:63], a[100:103], a[228:231], v[48:63]
    ds_read_b128 v[80:83], v11 offset:0
    s_add_u32 m0, s92, 131072
    s_lshl3_add_u32 s1, s93, s67
    buffer_load_dwordx4 v24, s[24:27], s1 offen offset:0 lds
    s_waitcnt lgkmcnt(9)
    v_mfma_f32_32x32x16_bf16 v[48:63], a[104:107], a[232:235], v[48:63]
    ds_read_b128 v[84:87], v12 offset:0
    v_mfma_f32_32x32x16_bf16 v[48:63], a[108:111], a[236:239], v[48:63]
    ds_read_b128 v[88:91], v13 offset:0
    s_waitcnt vmcnt(6)
    ds_read_b64_tr_b16 a[224:225], v20 offset:32768
    ds_read_b64_tr_b16 a[226:227], v20 offset:33280
    ds_read_b64_tr_b16 a[228:229], v21 offset:32768
    buffer_load_dwordx4 v25, s[24:27], s1 offen offset:1024 lds
    v_mfma_f32_32x32x16_bf16 v[48:63], a[112:115], a[240:243], v[48:63]
    ds_read_b128 v[92:95], v14 offset:0
    ds_read_b64_tr_b16 a[230:231], v21 offset:33280
    ds_read_b64_tr_b16 a[232:233], v22 offset:32768
    ds_read_b64_tr_b16 a[234:235], v22 offset:33280
    v_mfma_f32_32x32x16_bf16 v[48:63], a[116:119], a[244:247], v[48:63]
    ds_read_b128 v[96:99], v11 offset:4096
    ds_read_b64_tr_b16 a[236:237], v23 offset:32768
    ds_read_b64_tr_b16 a[238:239], v23 offset:33280
    buffer_load_dwordx4 v26, s[24:27], s1 offen offset:2048 lds
    s_waitcnt lgkmcnt(13)
    v_mfma_f32_32x32x16_bf16 v[48:63], a[120:123], a[248:251], v[48:63]
    ds_read_b128 v[100:103], v12 offset:4096
    v_mfma_f32_32x32x16_bf16 v[48:63], a[124:127], a[252:255], v[48:63]
    ds_read_b128 v[104:107], v13 offset:4096
    v_mfma_f32_32x32x16_bf16 v[48:63], v[116:119], v[120:123], v[48:63]
    buffer_load_dwordx4 v27, s[24:27], s1 offen offset:3072 lds
    s_lshl_b32 s71, s95, 11
    s_add_u32 s71, s71, s78
    s_nop 2
    v_mfma_f32_32x32x16_bf16 v[64:79], v[116:119], v[136:139], 0
    s_nop 4
    v_mul_f32_e64 v164, v48, v48
    s_waitcnt lgkmcnt(8)
    v_mfma_f32_32x32x16_bf16 v[64:79], a[0:3], v[80:83], v[64:79]
    ds_read_b128 v[108:111], v14 offset:4096
    s_add_u32 m0, s92, 135168
    s_add_u32 s1, s1, 0x8000
    buffer_load_dwordx4 v24, s[24:27], s1 offen offset:0 lds
    v_mul_f32 v165, v49, v49
    v_mul_f32 v166, v50, v50
    v_mfma_f32_32x32x16_bf16 v[64:79], a[4:7], v[84:87], v[64:79]
    ds_read_b128 v[80:83], v11 offset:8192
    v_mul_f32_e64 v167, v51, v51
    v_fma_f32 v164, v164, v161, v160
    v_fma_f32 v165, v165, v161, v160
    v_fma_f32 v166, v166, v161, v160
    v_fma_f32 v167, v167, v161, v160
    v_mfma_f32_32x32x16_bf16 v[64:79], a[8:11], v[88:91], v[64:79]
    ds_read_b128 v[84:87], v12 offset:8192
    buffer_load_dwordx4 v25, s[24:27], s1 offen offset:1024 lds
    v_mul_f32 v164, v48, v164
    v_mul_f32 v165, v49, v165
    v_mfma_f32_32x32x16_bf16 v[64:79], a[12:15], v[92:95], v[64:79]
    ds_read_b128 v[88:91], v13 offset:8192
    v_mul_f32 v166, v50, v166
    v_mul_f32 v167, v51, v167
    v_exp_f32 v164, v164
    v_exp_f32 v165, v165
    v_exp_f32 v166, v166
    buffer_load_dwordx4 v26, s[24:27], s1 offen offset:2048 lds
    s_waitcnt lgkmcnt(3)
    v_mfma_f32_32x32x16_bf16 v[64:79], a[16:19], v[96:99], v[64:79]
    ds_read_b128 v[92:95], v14 offset:8192
L_pad_att_2:
    s_cbranch_execz L_ret_att
    v_exp_f32 v167, v167
    v_fma_f32 v164, v164, v162, v162
    v_fma_f32 v165, v165, v162, v162
    v_fma_f32 v166, v166, v162, v162
    v_mfma_f32_32x32x16_bf16 v[64:79], a[20:23], v[100:103], v[64:79]
    ds_read_b128 v[96:99], v11 offset:12288
    v_fma_f32 v167, v167, v162, v162
    v_rcp_f32 v164, v164
    v_rcp_f32 v165, v165
    v_mfma_f32_32x32x16_bf16 v[64:79], a[24:27], v[104:107], v[64:79]
    ds_read_b128 v[100:103], v12 offset:12288
    buffer_load_dwordx4 v27, s[24:27], s1 offen offset:3072 lds
    v_rcp_f32 v166, v166
    v_rcp_f32 v167, v167
    v_mfma_f32_32x32x16_bf16 v[64:79], a[28:31], v[108:111], v[64:79]
    ds_read_b128 v[104:107], v13 offset:12288
    v_mul_f32 v164, v48, v164
    v_mul_f32 v165, v49, v165
    v_mul_f32 v166, v50, v166
    v_mul_f32 v167, v51, v167
    v_cvt_pk_bf16_f32 v204, v164, v165
    s_add_u32 m0, s92, 0
    s_add_u32 s1, s1, 0x8000
    buffer_load_dwordx4 v24, s[24:27], s1 offen offset:0 lds
    s_waitcnt lgkmcnt(3)
    v_mfma_f32_32x32x16_bf16 v[64:79], a[32:35], v[80:83], v[64:79]
    ds_read_b128 v[108:111], v14 offset:12288
    v_cvt_pk_bf16_f32 v205, v166, v167
    v_mul_f32 v164, v52, v52
    v_mul_f32 v165, v53, v53
    v_mul_f32_e64 v166, v54, v54
    v_mul_f32_e64 v167, v55, v55
    v_mfma_f32_32x32x16_bf16 v[64:79], a[36:39], v[84:87], v[64:79]
    ds_read_b128 v[80:83], v11 offset:16384
    v_fma_f32 v164, v164, v161, v160
    v_fma_f32 v165, v165, v161, v160
    v_fma_f32 v166, v166, v161, v160
    v_fma_f32 v167, v167, v161, v160
    s_waitcnt vmcnt(9)
    v_mfma_f32_32x32x16_bf16 v[64:79], a[40:43], v[88:91], v[64:79]
    ds_read_b128 v[84:87], v12 offset:16384
    ds_read_b64_tr_b16 a[240:241], v20 offset:36864
    ds_read_b64_tr_b16 a[242:243], v20 offset:37376
    ds_read_b64_tr_b16 a[244:245], v21 offset:36864
    buffer_load_dwordx4 v25, s[24:27], s1 offen offset:1024 lds
    v_mul_f32 v164, v52, v164
    v_mfma_f32_32x32x16_bf16 v[64:79], a[44:47], v[92:95], v[64:79]
    ds_read_b128 v[88:91], v13 offset:16384
    ds_read_b64_tr_b16 a[246:247], v21 offset:37376
    ds_read_b64_tr_b16 a[248:249], v22 offset:36864
    ds_read_b64_tr_b16 a[250:251], v22 offset:37376
    v_mul_f32 v165, v53, v165
    v_mul_f32 v166, v54, v166
    v_mul_f32 v167, v55, v167
    v_exp_f32 v164, v164
    v_exp_f32 v165, v165
    s_waitcnt lgkmcnt(9)
    v_mfma_f32_32x32x16_bf16 v[64:79], a[48:51], v[96:99], v[64:79]
    ds_read_b128 v[92:95], v14 offset:16384
    ds_read_b64_tr_b16 a[252:253], v23 offset:36864
    ds_read_b64_tr_b16 a[254:255], v23 offset:37376
    buffer_load_dwordx4 v26, s[24:27], s1 offen offset:2048 lds
    v_exp_f32 v166, v166
    v_mfma_f32_32x32x16_bf16 v[64:79], a[52:55], v[100:103], v[64:79]
    ds_read_b128 v[96:99], v11 offset:20480
    v_exp_f32 v167, v167
    v_fma_f32 v164, v164, v162, v162
    v_fma_f32 v165, v165, v162, v162
    v_fma_f32 v166, v166, v162, v162
    v_mfma_f32_32x32x16_bf16 v[64:79], a[56:59], v[104:107], v[64:79]
    ds_read_b128 v[100:103], v12 offset:20480
    buffer_load_dwordx4 v27, s[24:27], s1 offen offset:3072 lds
    v_fma_f32 v167, v167, v162, v162
    v_rcp_f32 v164, v164
    v_rcp_f32 v165, v165
    v_rcp_f32 v166, v166
    v_rcp_f32 v167, v167
    v_mfma_f32_32x32x16_bf16 v[64:79], a[60:63], v[108:111], v[64:79]
    ds_read_b128 v[104:107], v13 offset:20480
    v_mul_f32 v164, v52, v164
    v_mul_f32 v165, v53, v165
    v_mul_f32_e64 v166, v54, v166
    v_mul_f32 v167, v55, v167
    s_waitcnt lgkmcnt(3)
    v_mfma_f32_32x32x16_bf16 v[64:79], a[64:67], v[80:83], v[64:79]
    ds_read_b128 v[108:111], v14 offset:20480
    v_cvt_pk_bf16_f32 v206, v164, v165
    v_cvt_pk_bf16_f32 v207, v166, v167
    v_mfma_f32_32x32x16_bf16 v[64:79], a[68:71], v[84:87], v[64:79]
    ds_read_b128 v[80:83], v11 offset:24576
    buffer_store_dwordx4 v[204:207], v1, s[16:19], s71 offen offset:0 sc1
    v_mul_f32 v164, v56, v56
    v_mul_f32 v165, v57, v57
    v_mul_f32 v166, v58, v58
    v_mul_f32 v167, v59, v59
    v_fma_f32 v164, v164, v161, v160
    v_fma_f32 v165, v165, v161, v160
    v_fma_f32 v166, v166, v161, v160
    v_mfma_f32_32x32x16_bf16 v[64:79], a[72:75], v[88:91], v[64:79]
    ds_read_b128 v[84:87], v12 offset:24576
    v_fma_f32 v167, v167, v161, v160
    v_mul_f32 v164, v56, v164
    v_mul_f32 v165, v57, v165
    v_mul_f32 v166, v58, v166
    v_mul_f32 v167, v59, v167
    v_exp_f32 v164, v164
    v_exp_f32 v165, v165
    v_mfma_f32_32x32x16_bf16 v[64:79], a[76:79], v[92:95], v[64:79]
    ds_read_b128 v[88:91], v13 offset:24576
    v_exp_f32 v166, v166
    v_exp_f32_e64 v167, v167
    v_fma_f32 v164, v164, v162, v162
    s_waitcnt lgkmcnt(3)
    v_mfma_f32_32x32x16_bf16 v[64:79], a[80:83], v[96:99], v[64:79]
    ds_read_b128 v[92:95], v14 offset:24576
    v_fma_f32 v165, v165, v162, v162
    v_fma_f32 v166, v166, v162, v162
    v_fma_f32 v167, v167, v162, v162
    v_rcp_f32 v164, v164
    v_mfma_f32_32x32x16_bf16 v[64:79], a[84:87], v[100:103], v[64:79]
    ds_read_b128 v[96:99], v11 offset:28672
    v_rcp_f32 v165, v165
    v_rcp_f32 v166, v166
    v_rcp_f32 v167, v167
    v_mfma_f32_32x32x16_bf16 v[64:79], a[88:91], v[104:107], v[64:79]
    ds_read_b128 v[100:103], v12 offset:28672
    v_mul_f32 v164, v56, v164
    v_mul_f32 v165, v57, v165
    v_mul_f32 v166, v58, v166
    v_mul_f32 v167, v59, v167
    v_cvt_pk_bf16_f32 v208, v164, v165
    v_mfma_f32_32x32x16_bf16 v[64:79], a[92:95], v[108:111], v[64:79]
    ds_read_b128 v[104:107], v13 offset:28672
    v_cvt_pk_bf16_f32 v209, v166, v167
    v_mul_f32_e64 v164, v60, v60
    v_mul_f32_e64 v165, v61, v61
    v_mul_f32_e64 v166, v62, v62
    v_mul_f32 v167, v63, v63
    v_fma_f32 v164, v164, v161, v160
    v_fma_f32 v165, v165, v161, v160
    v_fma_f32 v166, v166, v161, v160
    s_waitcnt lgkmcnt(3)
    v_mfma_f32_32x32x16_bf16 v[64:79], a[96:99], v[80:83], v[64:79]
    ds_read_b128 v[108:111], v14 offset:28672
    v_fma_f32 v167, v167, v161, v160
    v_mul_f32 v164, v60, v164
    v_mul_f32 v165, v61, v165
    v_mul_f32 v166, v62, v166
    v_mul_f32 v167, v63, v167
    v_mfma_f32_32x32x16_bf16 v[64:79], a[100:103], v[84:87], v[64:79]
    v_exp_f32 v164, v164
    v_exp_f32 v165, v165
    v_exp_f32_e64 v166, v166
    v_mfma_f32_32x32x16_bf16 v[64:79], a[104:107], v[88:91], v[64:79]
    v_exp_f32_e64 v167, v167
    v_fma_f32 v164, v164, v162, v162
    v_fma_f32 v165, v165, v162, v162
    v_fma_f32 v166, v166, v162, v162
    v_fma_f32 v167, v167, v162, v162
    v_mfma_f32_32x32x16_bf16 v[64:79], a[108:111], v[92:95], v[64:79]
    v_rcp_f32 v164, v164
    v_rcp_f32 v165, v165
    v_rcp_f32 v166, v166
    v_rcp_f32 v167, v167
    v_mul_f32 v164, v60, v164
    v_mul_f32 v165, v61, v165
    s_waitcnt lgkmcnt(0)
    s_barrier
    v_mfma_f32_32x32x16_bf16 v[64:79], a[112:115], v[96:99], v[64:79]
    buffer_load_dwordx2 v[30:31], v32, s[16:19], s68 offen offset:0 sc1
    v_mul_f32 v166, v62, v166
    v_mul_f32 v167, v63, v167
    v_cvt_pk_bf16_f32 v210, v164, v165
    v_cvt_pk_bf16_f32 v211, v166, v167
    v_mfma_f32_32x32x16_bf16 v[64:79], a[116:119], v[100:103], v[64:79]
    buffer_store_dwordx4 v[208:211], v1, s[16:19], s71 offen offset:1024 sc1
    v_cndmask_b32 v160, v154, v157, s[98:99]
    v_cndmask_b32 v162, v156, v159, s[98:99]
    v_mul_f32 v161, v160, v160
    v_mul_f32 v160, 0xc0135761, v160
    v_mul_f32 v161, v161, v160
    v_mfma_f32_32x32x16_bf16 v[64:79], a[120:123], v[104:107], v[64:79]
    v_mul_f32 v161, 0x3d372713, v161
    v_mfma_f32_32x32x16_bf16 v[64:79], a[124:127], v[108:111], v[64:79]
    s_add_u32 m0, s92, 4096
    s_add_u32 s1, s1, 0x8000
    buffer_load_dwordx4 v24, s[24:27], s1 offen offset:0 lds
    s_lshl_b32 s71, s95, 11
    s_add_u32 s71, s71, s80
    v_add_u32 v11, 131072, v28
    v_xor_b32 v12, 32, v11
    v_xor_b32 v13, 64, v11
    v_xor_b32 v14, 96, v11
    s_nop 2
    v_mul_f32 v164, v64, v64
    v_mul_f32 v165, v65, v65
    v_mul_f32 v166, v66, v66
    v_mul_f32_e64 v167, v67, v67
    buffer_load_dwordx4 v25, s[24:27], s1 offen offset:1024 lds
    v_fma_f32 v164, v164, v161, v160
    v_fma_f32 v165, v165, v161, v160
    v_fma_f32 v166, v166, v161, v160
    v_fma_f32 v167, v167, v161, v160
    v_mul_f32 v164, v64, v164
    v_mul_f32 v165, v65, v165
    v_mul_f32 v166, v66, v166
    v_mul_f32 v167, v67, v167
    v_exp_f32 v164, v164
    v_exp_f32 v165, v165
    v_exp_f32_e64 v166, v166
    buffer_load_dwordx4 v26, s[24:27], s1 offen offset:2048 lds
    v_exp_f32_e64 v167, v167
    v_fma_f32 v164, v164, v162, v162
    v_fma_f32 v165, v165, v162, v162
    v_fma_f32 v166, v166, v162, v162
    v_fma_f32 v167, v167, v162, v162
    v_rcp_f32 v164, v164
    v_rcp_f32 v165, v165
    v_rcp_f32 v166, v166
    v_rcp_f32 v167, v167
    buffer_load_dwordx4 v27, s[24:27], s1 offen offset:3072 lds
    v_mul_f32 v164, v64, v164
    v_mul_f32 v165, v65, v165
    v_mul_f32 v166, v66, v166
    v_mul_f32 v167, v67, v167
    v_cvt_pk_bf16_f32 v204, v164, v165
    v_cvt_pk_bf16_f32 v205, v166, v167
    v_mul_f32_e64 v164, v68, v68
    v_mul_f32_e64 v165, v69, v69
    v_mul_f32_e64 v166, v70, v70
    v_mul_f32 v167, v71, v71
    v_fma_f32 v164, v164, v161, v160
    s_add_u32 m0, s92, 32768
    s_lshl4_add_u32 s1, s88, s67
    buffer_load_dwordx4 v24, s[20:23], s1 offen offset:0 lds
    v_fma_f32 v165, v165, v161, v160
    v_fma_f32 v166, v166, v161, v160
    v_fma_f32 v167, v167, v161, v160
    v_mul_f32 v164, v68, v164
    v_mul_f32 v165, v69, v165
    v_mul_f32 v166, v70, v166
    v_mul_f32 v167, v71, v167
    v_exp_f32 v164, v164
    v_exp_f32 v165, v165
    v_exp_f32 v166, v166
    buffer_load_dwordx4 v25, s[20:23], s1 offen offset:1024 lds
    v_exp_f32 v167, v167
    v_fma_f32 v164, v164, v162, v162
    v_fma_f32 v165, v165, v162, v162
    v_fma_f32 v166, v166, v162, v162
    v_fma_f32 v167, v167, v162, v162
    v_rcp_f32 v164, v164
    v_rcp_f32 v165, v165
    v_rcp_f32 v166, v166
    v_rcp_f32 v167, v167
    buffer_load_dwordx4 v26, s[20:23], s1 offen offset:2048 lds
    v_mul_f32 v164, v68, v164
    v_mul_f32 v165, v69, v165
    v_mul_f32 v166, v70, v166
    v_mul_f32 v167, v71, v167
    v_cvt_pk_bf16_f32 v206, v164, v165
    v_cvt_pk_bf16_f32 v207, v166, v167
    buffer_store_dwordx4 v[204:207], v1, s[16:19], s71 offen offset:0 sc1
    v_mul_f32 v164, v72, v72
    v_mul_f32 v165, v73, v73
    v_mul_f32 v166, v74, v74
    v_mul_f32 v167, v75, v75
    v_fma_f32 v164, v164, v161, v160
    v_fma_f32 v165, v165, v161, v160
    v_fma_f32 v166, v166, v161, v160
    v_fma_f32 v167, v167, v161, v160
    v_mul_f32 v164, v72, v164
    v_mul_f32 v165, v73, v165
    v_mul_f32 v166, v74, v166
    s_waitcnt vmcnt(9)
    v_cmp_ne_u64 vcc, v[30:31], v[8:9]
    s_nop 1
    s_cbranch_vccnz L_retry_7
L_ok_9:
    buffer_load_dwordx4 v27, s[20:23], s1 offen offset:3072 lds
    v_mul_f32 v167, v75, v167
    v_exp_f32 v164, v164
    v_exp_f32 v165, v165
    v_exp_f32 v166, v166
    v_exp_f32 v167, v167
    v_fma_f32 v164, v164, v162, v162
    v_fma_f32 v165, v165, v162, v162
    s_add_u32 m0, s92, 36864
    s_lshl4_add_u32 s1, s89, s67
    buffer_load_dwordx4 v24, s[20:23], s1 offen offset:0 lds
    v_fma_f32 v166, v166, v162, v162
    v_fma_f32 v167, v167, v162, v162
    v_rcp_f32 v164, v164
    v_rcp_f32 v165, v165
    v_rcp_f32 v166, v166
    v_rcp_f32 v167, v167
    v_mul_f32 v164, v72, v164
    v_mul_f32 v165, v73, v165
    v_mul_f32 v166, v74, v166
    buffer_load_dwordx4 v25, s[20:23], s1 offen offset:1024 lds
    v_mul_f32 v167, v75, v167
    v_cvt_pk_bf16_f32 v208, v164, v165
    v_cvt_pk_bf16_f32 v209, v166, v167
    v_mul_f32 v164, v76, v76
    v_mul_f32 v165, v77, v77
    v_mul_f32 v166, v78, v78
    v_mul_f32_e64 v167, v79, v79
    v_fma_f32 v164, v164, v161, v160
    v_fma_f32 v165, v165, v161, v160
    v_fma_f32 v166, v166, v161, v160
    v_fma_f32 v167, v167, v161, v160
    v_mul_f32 v164, v76, v164
    v_mul_f32 v165, v77, v165
    buffer_load_dwordx4 v26, s[20:23], s1 offen offset:2048 lds
    v_mul_f32 v166, v78, v166
    v_mul_f32 v167, v79, v167
    v_exp_f32 v164, v164
    v_exp_f32 v165, v165
    v_exp_f32 v166, v166
    v_exp_f32 v167, v167
    v_fma_f32 v164, v164, v162, v162
    v_fma_f32 v165, v165, v162, v162
    v_fma_f32 v166, v166, v162, v162
    buffer_load_dwordx4 v27, s[20:23], s1 offen offset:3072 lds
    v_fma_f32 v167, v167, v162, v162
    v_rcp_f32_e64 v164, v164
    v_rcp_f32_e64 v165, v165
    v_rcp_f32_e64 v166, v166
    v_rcp_f32_e64 v167, v167
    v_mul_f32_e64 v164, v76, v164
    v_mul_f32 v165, v77, v165
    s_add_u32 m0, s93, 65536
    s_lshl4_add_u32 s1, s90, s67
    buffer_load_dwordx4 v24, s[20:23], s1 offen offset:0 lds
    v_mul_f32_e64 v166, v78, v166
    v_mul_f32 v167, v79, v167
    v_cvt_pk_bf16_f32 v210, v164, v165
    v_cvt_pk_bf16_f32 v211, v166, v167
    buffer_store_dwordx4 v[208:211], v1, s[16:19], s71 offen offset:1024 sc1
    s_lshl2_add_u32 s73, s5, s3
    s_lshl_b32 s72, s4, 10
    s_lshl3_add_u32 s73, s73, s72
    s_add_u32 s73, s73, 12544
    s_waitcnt vmcnt(11)
    s_barrier
    ds_read_b64_tr_b16 v[96:97], v11 offset:0
    ds_read_b64_tr_b16 v[98:99], v11 offset:512
    ds_read_b64_tr_b16 v[100:101], v12 offset:0
    ds_read_b64_tr_b16 v[102:103], v12 offset:512
    buffer_load_dwordx4 v25, s[20:23], s1 offen offset:1024 lds
    ds_read_b64_tr_b16 v[104:105], v13 offset:0
    ds_read_b64_tr_b16 v[106:107], v13 offset:512
    ds_read_b64_tr_b16 v[108:109], v14 offset:0
    ds_read_b64_tr_b16 v[110:111], v14 offset:512
    ds_read_b64_tr_b16 v[112:113], v11 offset:4096
    ds_read_b64_tr_b16 v[114:115], v11 offset:4608
    ds_read_b64_tr_b16 v[116:117], v12 offset:4096
    ds_read_b64_tr_b16 v[118:119], v12 offset:4608
    ds_read_b64_tr_b16 v[120:121], v13 offset:4096
    ds_read_b64_tr_b16 v[122:123], v13 offset:4608
    ds_read_b64_tr_b16 v[124:125], v14 offset:4096
    ds_read_b64_tr_b16 v[126:127], v14 offset:4608
    ds_read_b64_tr_b16 v[128:129], v11 offset:8192
    buffer_load_dwordx4 v26, s[20:23], s1 offen offset:2048 lds
    ds_read_b64_tr_b16 v[130:131], v11 offset:8704
    ds_read_b64_tr_b16 v[132:133], v12 offset:8192
    ds_read_b64_tr_b16 v[134:135], v12 offset:8704
    ds_read_b64_tr_b16 v[136:137], v13 offset:8192
    ds_read_b64_tr_b16 v[138:139], v13 offset:8704
    ds_read_b64_tr_b16 v[140:141], v14 offset:8192
    ds_read_b64_tr_b16 v[142:143], v14 offset:8704
    ds_read_b64_tr_b16 v[144:145], v11 offset:12288
    ds_read_b64_tr_b16 v[146:147], v11 offset:12800
    ds_read_b64_tr_b16 v[148:149], v12 offset:12288
    ds_read_b64_tr_b16 v[150:151], v12 offset:12800
    ds_read_b64_tr_b16 v[152:153], v13 offset:12288
    ds_read_b64_tr_b16 v[154:155], v13 offset:12800
    buffer_load_dwordx4 v27, s[20:23], s1 offen offset:3072 lds
    ds_read_b64_tr_b16 v[156:157], v14 offset:12288
    ds_read_b64_tr_b16 v[158:159], v14 offset:12800
    ds_read_b64_tr_b16 v[160:161], v11 offset:16384
    ds_read_b64_tr_b16 v[162:163], v11 offset:16896
    ds_read_b64_tr_b16 v[164:165], v12 offset:16384
    ds_read_b64_tr_b16 v[166:167], v12 offset:16896
    ds_read_b64_tr_b16 v[168:169], v13 offset:16384
    ds_read_b64_tr_b16 v[170:171], v13 offset:16896
    ds_read_b64_tr_b16 v[172:173], v14 offset:16384
    ds_read_b64_tr_b16 v[174:175], v14 offset:16896
    ds_read_b64_tr_b16 v[176:177], v11 offset:20480
    ds_read_b64_tr_b16 v[178:179], v11 offset:20992
    ds_read_b64_tr_b16 v[180:181], v12 offset:20480
    ds_read_b64_tr_b16 v[182:183], v12 offset:20992
    ds_read_b64_tr_b16 v[184:185], v13 offset:20480
    ds_read_b64_tr_b16 v[186:187], v13 offset:20992
    ds_read_b64_tr_b16 v[188:189], v14 offset:20480
    buffer_load_dwordx4 a[64:67], v3, s[16:19], s86 offen offset:0 sc1
    ds_read_b64_tr_b16 v[190:191], v14 offset:20992
    ds_read_b64_tr_b16 v[192:193], v11 offset:24576
    ds_read_b64_tr_b16 v[194:195], v11 offset:25088
    ds_read_b64_tr_b16 v[196:197], v12 offset:24576
    ds_read_b64_tr_b16 v[198:199], v12 offset:25088
    ds_read_b64_tr_b16 v[200:201], v13 offset:24576
    ds_read_b64_tr_b16 v[202:203], v13 offset:25088
    ds_read_b64_tr_b16 v[204:205], v14 offset:24576
    ds_read_b64_tr_b16 v[206:207], v14 offset:25088
    ds_read_b64_tr_b16 v[208:209], v11 offset:28672
    ds_read_b64_tr_b16 v[210:211], v11 offset:29184
    ds_read_b64_tr_b16 v[212:213], v12 offset:28672
    ds_read_b64_tr_b16 v[214:215], v12 offset:29184
    ds_read_b64_tr_b16 v[216:217], v13 offset:28672
    ds_read_b64_tr_b16 v[218:219], v13 offset:29184
    ds_read_b64_tr_b16 v[220:221], v14 offset:28672
    ds_read_b64_tr_b16 v[222:223], v14 offset:29184
    buffer_load_dwordx4 a[68:71], v4, s[16:19], s86 offen offset:0 sc1
    v_add_u32 v11, -131072, v11
    v_add_u32 v12, -131072, v12
    v_add_u32 v13, -131072, v13
    v_add_u32 v14, -131072, v14
    ds_read_b64_tr_b16 v[224:225], v11 offset:0
    ds_read_b64_tr_b16 v[226:227], v11 offset:512
    ds_read_b64_tr_b16 v[228:229], v12 offset:0
    ds_read_b64_tr_b16 v[230:231], v12 offset:512
    ds_read_b64_tr_b16 v[232:233], v13 offset:0
    ds_read_b64_tr_b16 v[234:235], v13 offset:512
    ds_read_b64_tr_b16 v[236:237], v14 offset:0
    ds_read_b64_tr_b16 v[238:239], v14 offset:512
    ds_read_b64_tr_b16 v[240:241], v11 offset:4096
    ds_read_b64_tr_b16 v[242:243], v11 offset:4608
    ds_read_b64_tr_b16 v[244:245], v12 offset:4096
    ds_read_b64_tr_b16 v[246:247], v12 offset:4608
    buffer_load_dwordx4 a[72:75], v5, s[16:19], s86 offen offset:0 sc1
    ds_read_b64_tr_b16 v[248:249], v13 offset:4096
    ds_read_b64_tr_b16 v[250:251], v13 offset:4608
    ds_read_b64_tr_b16 v[252:253], v14 offset:4096
    ds_read_b64_tr_b16 v[254:255], v14 offset:4608
    buffer_load_dwordx4 a[76:79], v6, s[16:19], s86 offen offset:0 sc1
    buffer_load_dwordx4 a[80:83], v3, s[16:19], s86 offen offset:2048 sc1
    buffer_load_dwordx4 a[84:87], v4, s[16:19], s86 offen offset:2048 sc1
    s_waitcnt vmcnt(9)
    s_mov_b64 exec, 1
    buffer_store_dwordx2 v[8:9], v33, s[16:19], s73 offen sc1
    s_mov_b64 exec, -1
    buffer_load_dwordx4 a[88:91], v5, s[16:19], s86 offen offset:2048 sc1
    buffer_load_dwordx4 a[92:95], v6, s[16:19], s86 offen offset:2048 sc1
    s_add_u32 s86, s86, 4096
    buffer_load_dwordx4 a[96:99], v3, s[16:19], s86 offen offset:0 sc1
    buffer_load_dwordx4 a[100:103], v4, s[16:19], s86 offen offset:0 sc1
    buffer_load_dwordx4 a[104:107], v5, s[16:19], s86 offen offset:0 sc1
    s_waitcnt vmcnt(10)
    v_mfma_f32_16x16x32_bf16 a[0:3], a[128:131], a[64:67], 0
    v_mfma_f32_16x16x32_bf16 a[4:7], a[132:135], a[64:67], 0
    v_mfma_f32_16x16x32_bf16 a[8:11], a[136:139], a[64:67], 0
    v_mfma_f32_16x16x32_bf16 a[12:15], a[140:143], a[64:67], 0
    v_mfma_f32_16x16x32_bf16 a[28:31], a[140:143], a[68:71], 0
    buffer_load_dwordx4 a[108:111], v6, s[16:19], s86 offen offset:0 sc1
    v_mfma_f32_16x16x32_bf16 a[24:27], a[136:139], a[68:71], 0
    v_mfma_f32_16x16x32_bf16 a[20:23], a[132:135], a[68:71], 0
    v_mfma_f32_16x16x32_bf16 a[16:19], a[128:131], a[68:71], 0
    buffer_load_dwordx4 a[112:115], v3, s[16:19], s86 offen offset:2048 sc1
    s_waitcnt vmcnt(10)
    v_mfma_f32_16x16x32_bf16 a[32:35], a[128:131], a[72:75], 0
    v_mfma_f32_16x16x32_bf16 a[36:39], a[132:135], a[72:75], 0
    v_mfma_f32_16x16x32_bf16 a[40:43], a[136:139], a[72:75], 0
    v_mfma_f32_16x16x32_bf16 a[44:47], a[140:143], a[72:75], 0
    v_mfma_f32_16x16x32_bf16 a[60:63], a[140:143], a[76:79], 0
    buffer_load_dwordx4 a[116:119], v4, s[16:19], s86 offen offset:2048 sc1
    v_mfma_f32_16x16x32_bf16 a[56:59], a[136:139], a[76:79], 0
    v_mfma_f32_16x16x32_bf16 a[52:55], a[132:135], a[76:79], 0
    v_mfma_f32_16x16x32_bf16 a[48:51], a[128:131], a[76:79], 0
    ds_read_b64_tr_b16 a[128:129], v20 offset:32768
    s_waitcnt vmcnt(9)
    v_mfma_f32_16x16x32_bf16 a[0:3], a[144:147], a[80:83], a[0:3]
    ds_read_b64_tr_b16 a[130:131], v20 offset:33280
    buffer_load_dwordx4 a[120:123], v5, s[16:19], s86 offen offset:2048 sc1
    v_mfma_f32_16x16x32_bf16 a[4:7], a[148:151], a[80:83], a[4:7]
    ds_read_b64_tr_b16 a[132:133], v21 offset:32768
    v_mfma_f32_16x16x32_bf16 a[8:11], a[152:155], a[80:83], a[8:11]
    ds_read_b64_tr_b16 a[134:135], v21 offset:33280
    v_mfma_f32_16x16x32_bf16 a[12:15], a[156:159], a[80:83], a[12:15]
    ds_read_b64_tr_b16 a[136:137], v22 offset:32768
    v_mfma_f32_16x16x32_bf16 a[28:31], a[156:159], a[84:87], a[28:31]
    ds_read_b64_tr_b16 a[138:139], v22 offset:33280
    v_mfma_f32_16x16x32_bf16 a[24:27], a[152:155], a[84:87], a[24:27]
    buffer_load_dwordx4 a[124:127], v6, s[16:19], s86 offen offset:2048 sc1
    v_mfma_f32_16x16x32_bf16 a[20:23], a[148:151], a[84:87], a[20:23]
    ds_read_b64_tr_b16 a[140:141], v23 offset:32768
    v_mfma_f32_16x16x32_bf16 a[16:19], a[144:147], a[84:87], a[16:19]
    ds_read_b64_tr_b16 a[142:143], v23 offset:33280
    buffer_load_dwordx4 a[64:67], v3, s[16:19], s87 offen offset:0 sc1
    s_waitcnt vmcnt(9)
    v_mfma_f32_16x16x32_bf16 a[32:35], a[144:147], a[88:91], a[32:35]
    v_mfma_f32_16x16x32_bf16 a[36:39], a[148:151], a[88:91], a[36:39]
    v_mfma_f32_16x16x32_bf16 a[40:43], a[152:155], a[88:91], a[40:43]
    v_mfma_f32_16x16x32_bf16 a[44:47], a[156:159], a[88:91], a[44:47]
    v_mfma_f32_16x16x32_bf16 a[60:63], a[156:159], a[92:95], a[60:63]
    buffer_load_dwordx4 a[68:71], v4, s[16:19], s87 offen offset:0 sc1
    v_mfma_f32_16x16x32_bf16 a[56:59], a[152:155], a[92:95], a[56:59]
    v_mfma_f32_16x16x32_bf16 a[52:55], a[148:151], a[92:95], a[52:55]
    v_mfma_f32_16x16x32_bf16 a[48:51], a[144:147], a[92:95], a[48:51]
    ds_read_b64_tr_b16 a[144:145], v20 offset:36864
    s_waitcnt vmcnt(8)
    v_mfma_f32_16x16x32_bf16 a[0:3], a[160:163], a[96:99], a[0:3]
    ds_read_b64_tr_b16 a[146:147], v20 offset:37376
    buffer_load_dwordx4 a[72:75], v5, s[16:19], s87 offen offset:0 sc1
    v_mfma_f32_16x16x32_bf16 a[4:7], a[164:167], a[96:99], a[4:7]
    ds_read_b64_tr_b16 a[148:149], v21 offset:36864
    v_mfma_f32_16x16x32_bf16 a[8:11], a[168:171], a[96:99], a[8:11]
    ds_read_b64_tr_b16 a[150:151], v21 offset:37376
    v_mfma_f32_16x16x32_bf16 a[12:15], a[172:175], a[96:99], a[12:15]
    ds_read_b64_tr_b16 a[152:153], v22 offset:36864
    v_mfma_f32_16x16x32_bf16 a[28:31], a[172:175], a[100:103], a[28:31]
    ds_read_b64_tr_b16 a[154:155], v22 offset:37376
    v_mfma_f32_16x16x32_bf16 a[24:27], a[168:171], a[100:103], a[24:27]
    buffer_load_dwordx4 a[76:79], v6, s[16:19], s87 offen offset:0 sc1
    v_mfma_f32_16x16x32_bf16 a[20:23], a[164:167], a[100:103], a[20:23]
    ds_read_b64_tr_b16 a[156:157], v23 offset:36864
    v_mfma_f32_16x16x32_bf16 a[16:19], a[160:163], a[100:103], a[16:19]
    ds_read_b64_tr_b16 a[158:159], v23 offset:37376
    s_waitcnt vmcnt(8)
    v_mfma_f32_16x16x32_bf16 a[32:35], a[160:163], a[104:107], a[32:35]
    v_mfma_f32_16x16x32_bf16 a[36:39], a[164:167], a[104:107], a[36:39]
    v_mfma_f32_16x16x32_bf16 a[40:43], a[168:171], a[104:107], a[40:43]
    buffer_load_dwordx4 a[80:83], v3, s[16:19], s87 offen offset:2048 sc1
    v_mfma_f32_16x16x32_bf16 a[44:47], a[172:175], a[104:107], a[44:47]
    v_mfma_f32_16x16x32_bf16 a[60:63], a[172:175], a[108:111], a[60:63]
    v_mfma_f32_16x16x32_bf16 a[56:59], a[168:171], a[108:111], a[56:59]
    v_mfma_f32_16x16x32_bf16 a[52:55], a[164:167], a[108:111], a[52:55]
    v_mfma_f32_16x16x32_bf16 a[48:51], a[160:163], a[108:111], a[48:51]
    buffer_load_dwordx4 a[84:87], v4, s[16:19], s87 offen offset:2048 sc1
    s_add_u32 s97, s92, 65536
    s_waitcnt vmcnt(8)
    v_mfma_f32_16x16x32_bf16 a[0:3], a[176:179], a[112:115], a[0:3]
    v_add_u32 v20, s97, v20
    v_add_u32 v21, s97, v21
    v_mfma_f32_16x16x32_bf16 a[4:7], a[180:183], a[112:115], a[4:7]
    v_add_u32 v22, s97, v22
    v_add_u32 v23, s97, v23
    v_mfma_f32_16x16x32_bf16 a[8:11], a[184:187], a[112:115], a[8:11]
    ds_read_b64_tr_b16 a[160:161], v20 offset:0
    v_mfma_f32_16x16x32_bf16 a[12:15], a[188:191], a[112:115], a[12:15]
    ds_read_b64_tr_b16 a[162:163], v20 offset:512
    buffer_load_dwordx4 a[88:91], v5, s[16:19], s87 offen offset:2048 sc1
    v_mfma_f32_16x16x32_bf16 a[28:31], a[188:191], a[116:119], a[28:31]
    ds_read_b64_tr_b16 a[164:165], v21 offset:0
    v_mfma_f32_16x16x32_bf16 a[24:27], a[184:187], a[116:119], a[24:27]
    ds_read_b64_tr_b16 a[166:167], v21 offset:512
    v_mfma_f32_16x16x32_bf16 a[20:23], a[180:183], a[116:119], a[20:23]
    ds_read_b64_tr_b16 a[168:169], v22 offset:0
    v_mfma_f32_16x16x32_bf16 a[16:19], a[176:179], a[116:119], a[16:19]
    ds_read_b64_tr_b16 a[170:171], v22 offset:512
    s_waitcnt vmcnt(7)
    v_mfma_f32_16x16x32_bf16 a[32:35], a[176:179], a[120:123], a[32:35]
    buffer_load_dwordx4 a[92:95], v6, s[16:19], s87 offen offset:2048 sc1
    v_mfma_f32_16x16x32_bf16 a[36:39], a[180:183], a[120:123], a[36:39]
    buffer_load_dwordx2 v[30:31], v32, s[16:19], s68 offen offset:256 sc1
    v_mfma_f32_16x16x32_bf16 a[40:43], a[184:187], a[120:123], a[40:43]
    ds_read_b64_tr_b16 a[172:173], v23 offset:0
    v_mfma_f32_16x16x32_bf16 a[44:47], a[188:191], a[120:123], a[44:47]
    ds_read_b64_tr_b16 a[174:175], v23 offset:512
    v_lshrrev_b32 v16, 4, v0
    v_mfma_f32_16x16x32_bf16 a[60:63], a[188:191], a[124:127], a[60:63]
    v_and_b32 v17, 7, v0
    v_xor_b32 v16, v16, v17
    v_mfma_f32_16x16x32_bf16 a[56:59], a[184:187], a[124:127], a[56:59]
    v_and_b32 v34, 0xf0, v1
    v_add_lshl_u32 v16, v34, v16, 4
    v_mfma_f32_16x16x32_bf16 a[52:55], a[180:183], a[124:127], a[52:55]
    s_add_u32 s87, s87, 4096
    buffer_load_dwordx4 a[96:99], v3, s[16:19], s87 offen offset:0 sc1
    v_mfma_f32_16x16x32_bf16 a[48:51], a[176:179], a[124:127], a[48:51]
    ds_read_b64_tr_b16 a[176:177], v11 offset:8192
    s_add_u32 s70, s93, 65536
    s_waitcnt vmcnt(8)
    v_mfma_f32_16x16x32_bf16 a[0:3], a[192:195], a[64:67], a[0:3]
    ds_read_b64_tr_b16 a[178:179], v11 offset:8704
    v_add_u32 v34, s70, v16
    v_mfma_f32_16x16x32_bf16 a[4:7], a[196:199], a[64:67], a[4:7]
    ds_read_b64_tr_b16 a[180:181], v12 offset:8192
    v_xor_b32_e64 v35, 64, v34
    v_mfma_f32_16x16x32_bf16 a[8:11], a[200:203], a[64:67], a[8:11]
    ds_read_b64_tr_b16 a[182:183], v12 offset:8704
    v_lshrrev_b32 v16, 3, v0
    v_mfma_f32_16x16x32_bf16 a[12:15], a[204:207], a[64:67], a[12:15]
    buffer_load_dwordx4 a[100:103], v4, s[16:19], s87 offen offset:0 sc1
    v_lshlrev_b32 v17, 1, v17
    v_mfma_f32_16x16x32_bf16 a[28:31], a[204:207], a[68:71], a[28:31]
    ds_read_b64_tr_b16 a[184:185], v13 offset:8192
    v_xor_b32_e64 v17, v17, v16
    v_mfma_f32_16x16x32_bf16 a[24:27], a[200:203], a[68:71], a[24:27]
    ds_read_b64_tr_b16 a[186:187], v13 offset:8704
    v_lshlrev_b32_e64 v17, 4, v17
    v_mfma_f32_16x16x32_bf16 a[20:23], a[196:199], a[68:71], a[20:23]
    ds_read_b64_tr_b16 a[188:189], v14 offset:8192
    v_lshl_add_u32 v16, v16, 8, v17
    v_mfma_f32_16x16x32_bf16 a[16:19], a[192:195], a[68:71], a[16:19]
    ds_read_b64_tr_b16 a[190:191], v14 offset:8704
    v_add_u32 v16, s70, v16
    s_waitcnt vmcnt(7)
    v_mfma_f32_16x16x32_bf16 a[32:35], a[192:195], a[72:75], a[32:35]
    buffer_load_dwordx4 a[104:107], v5, s[16:19], s87 offen offset:0 sc1
    v_xor_b32 v24, 16384, v16
    v_mfma_f32_16x16x32_bf16 a[36:39], a[196:199], a[72:75], a[36:39]
L_pad_att_3:
    s_cbranch_execz L_ret_att
    v_xor_b32 v25, 16400, v16
    v_xor_b32 v26, 36864, v16
    v_mfma_f32_16x16x32_bf16 a[40:43], a[200:203], a[72:75], a[40:43]
    v_xor_b32 v27, 36880, v16
    v_xor_b32 v18, 57344, v16
    v_mfma_f32_16x16x32_bf16 a[44:47], a[204:207], a[72:75], a[44:47]
    v_xor_b32 v19, 57360, v16
    v_xor_b32 v15, 12288, v16
    v_mfma_f32_16x16x32_bf16 a[60:63], a[204:207], a[76:79], a[60:63]
    v_xor_b32 v2, 12304, v16
    v_lshlrev_b32 v48, 16, v36
    v_mfma_f32_16x16x32_bf16 a[56:59], a[200:203], a[76:79], a[56:59]
    buffer_load_dwordx4 a[108:111], v6, s[16:19], s87 offen offset:0 sc1
    v_and_b32 v49, 0xffff0000, v36
    v_mfma_f32_16x16x32_bf16 a[52:55], a[196:199], a[76:79], a[52:55]
    v_lshlrev_b32_e64 v50, 16, v37
    v_and_b32 v51, 0xffff0000, v37
    v_mfma_f32_16x16x32_bf16 a[48:51], a[192:195], a[76:79], a[48:51]
    ds_read_b64_tr_b16 a[192:193], v11 offset:12288
    v_lshlrev_b32 v52, 16, v38
    s_waitcnt vmcnt(7)
    v_mfma_f32_16x16x32_bf16 a[0:3], a[208:211], a[80:83], a[0:3]
    ds_read_b64_tr_b16 a[194:195], v11 offset:12800
    v_and_b32 v53, 0xffff0000, v38
    v_mfma_f32_16x16x32_bf16 a[4:7], a[212:215], a[80:83], a[4:7]
    ds_read_b64_tr_b16 a[196:197], v12 offset:12288
    buffer_load_dwordx4 a[112:115], v3, s[16:19], s87 offen offset:2048 sc1
    v_mfma_f32_16x16x32_bf16 a[8:11], a[216:219], a[80:83], a[8:11]
    ds_read_b64_tr_b16 a[198:199], v12 offset:12800
    v_lshlrev_b32_e64 v54, 16, v39
    v_mfma_f32_16x16x32_bf16 a[12:15], a[220:223], a[80:83], a[12:15]
    ds_read_b64_tr_b16 a[200:201], v13 offset:12288
    v_and_b32 v55, 0xffff0000, v39
    v_mfma_f32_16x16x32_bf16 a[28:31], a[220:223], a[84:87], a[28:31]
    ds_read_b64_tr_b16 a[202:203], v13 offset:12800
    v_lshlrev_b32_e64 v56, 16, v40
    v_mfma_f32_16x16x32_bf16 a[24:27], a[216:219], a[84:87], a[24:27]
    ds_read_b64_tr_b16 a[204:205], v14 offset:12288
    v_and_b32 v57, 0xffff0000, v40
    v_mfma_f32_16x16x32_bf16 a[20:23], a[212:215], a[84:87], a[20:23]
    buffer_load_dwordx4 a[116:119], v4, s[16:19], s87 offen offset:2048 sc1
    v_lshlrev_b32 v58, 16, v41
    v_mfma_f32_16x16x32_bf16 a[16:19], a[208:211], a[84:87], a[16:19]
    ds_read_b64_tr_b16 a[206:207], v14 offset:12800
    v_and_b32 v59, 0xffff0000, v41
    s_waitcnt vmcnt(7)
    v_mfma_f32_16x16x32_bf16 a[32:35], a[208:211], a[88:91], a[32:35]
    v_lshlrev_b32 v60, 16, v42
    v_and_b32 v61, 0xffff0000, v42
    v_mfma_f32_16x16x32_bf16 a[36:39], a[212:215], a[88:91], a[36:39]
    v_lshlrev_b32 v62, 16, v43
    v_and_b32 v63, 0xffff0000, v43
    v_mfma_f32_16x16x32_bf16 a[40:43], a[216:219], a[88:91], a[40:43]
    v_lshlrev_b32_e64 v16, 16, v44
    v_and_b32 v17, 0xffff0000, v44
    v_mfma_f32_16x16x32_bf16 a[44:47], a[220:223], a[88:91], a[44:47]
    buffer_load_dwordx4 a[120:123], v5, s[16:19], s87 offen offset:2048 sc1
    v_add_f32 v48, v48, v16
    v_mfma_f32_16x16x32_bf16 a[60:63], a[220:223], a[92:95], a[60:63]
    v_add_f32 v49, v49, v17
    v_add_f32 v56, v56, v16
    v_mfma_f32_16x16x32_bf16 a[56:59], a[216:219], a[92:95], a[56:59]
    v_add_f32 v57, v57, v17
    v_lshlrev_b32_e64 v16, 16, v45
    v_mfma_f32_16x16x32_bf16 a[52:55], a[212:215], a[92:95], a[52:55]
    v_and_b32 v17, 0xffff0000, v45
    v_add_f32 v50, v50, v16
    v_mfma_f32_16x16x32_bf16 a[48:51], a[208:211], a[92:95], a[48:51]
    ds_read_b64_tr_b16 a[208:209], v11 offset:16384
    v_add_f32 v51, v51, v17
    s_waitcnt vmcnt(7)
    v_cmp_ne_u64 vcc, v[30:31], v[8:9]
    s_nop 1
    s_cbranch_vccnz L_retry_10
L_ok_12:
    v_lshrrev_b32 v32, 1, v10
    s_and_b32 s68, s68, 0xffffff3f
    s_waitcnt vmcnt(5)
    v_mfma_f32_16x16x32_bf16 a[0:3], a[224:227], a[96:99], a[0:3]
    buffer_load_dwordx4 a[124:127], v6, s[16:19], s87 offen offset:2048 sc1
    v_add_f32_e64 v58, v58, v16
    v_mfma_f32_16x16x32_bf16 a[4:7], a[228:231], a[96:99], a[4:7]
    ds_read_b64_tr_b16 a[210:211], v11 offset:16896
    v_add_f32 v59, v59, v17
    v_mfma_f32_16x16x32_bf16 a[8:11], a[232:235], a[96:99], a[8:11]
    ds_read_b64_tr_b16 a[212:213], v12 offset:16384
    v_lshlrev_b32 v16, 16, v46
    v_mfma_f32_16x16x32_bf16 a[12:15], a[236:239], a[96:99], a[12:15]
    ds_read_b64_tr_b16 a[214:215], v12 offset:16896
    v_and_b32 v17, 0xffff0000, v46
    v_mfma_f32_16x16x32_bf16 a[28:31], a[236:239], a[100:103], a[28:31]
    ds_read_b64_tr_b16 a[216:217], v13 offset:16384
    v_add_f32 v52, v52, v16
    v_mfma_f32_16x16x32_bf16 a[24:27], a[232:235], a[100:103], a[24:27]
    buffer_load_dwordx4 a[64:67], v3, s[16:19], s88 offen offset:0 sc1
    v_add_f32 v53, v53, v17
    v_mfma_f32_16x16x32_bf16 a[20:23], a[228:231], a[100:103], a[20:23]
    ds_read_b64_tr_b16 a[218:219], v13 offset:16896
    v_add_f32_e64 v60, v60, v16
    v_mfma_f32_16x16x32_bf16 a[16:19], a[224:227], a[100:103], a[16:19]
    ds_read_b64_tr_b16 a[220:221], v14 offset:16384
    v_add_f32 v61, v61, v17
    s_waitcnt vmcnt(5)
    v_mfma_f32_16x16x32_bf16 a[32:35], a[224:227], a[104:107], a[32:35]
    buffer_load_dwordx4 a[68:71], v4, s[16:19], s88 offen offset:0 sc1
    v_lshlrev_b32_e64 v16, 16, v47
    v_mfma_f32_16x16x32_bf16 a[36:39], a[228:231], a[104:107], a[36:39]
    ds_read_b64_tr_b16 a[222:223], v14 offset:16896
    v_and_b32 v17, 0xffff0000, v47
    v_mfma_f32_16x16x32_bf16 a[40:43], a[232:235], a[104:107], a[40:43]
    v_add_f32 v54, v54, v16
    v_add_f32 v55, v55, v17
    v_mfma_f32_16x16x32_bf16 a[44:47], a[236:239], a[104:107], a[44:47]
    v_add_f32 v62, v62, v16
    v_add_f32 v63, v63, v17
    v_mfma_f32_16x16x32_bf16 a[60:63], a[236:239], a[108:111], a[60:63]
    s_add_u32 s71, s91, 0x2000
    v_mfma_f32_16x16x32_bf16 a[56:59], a[232:235], a[108:111], a[56:59]
    buffer_load_dwordx4 a[72:75], v5, s[16:19], s88 offen offset:0 sc1
    v_mfma_f32_16x16x32_bf16 a[52:55], a[228:231], a[108:111], a[52:55]
    v_mfma_f32_16x16x32_bf16 a[48:51], a[224:227], a[108:111], a[48:51]
    ds_read_b64_tr_b16 a[224:225], v11 offset:20480
    s_waitcnt vmcnt(5)
    v_mfma_f32_16x16x32_bf16 a[0:3], a[240:243], a[112:115], a[0:3]
    ds_read_b64_tr_b16 a[226:227], v11 offset:20992
    buffer_load_dwordx4 a[76:79], v6, s[16:19], s88 offen offset:0 sc1
    v_mfma_f32_16x16x32_bf16 a[4:7], a[244:247], a[112:115], a[4:7]
    ds_read_b64_tr_b16 a[228:229], v12 offset:20480
    v_mfma_f32_16x16x32_bf16 a[8:11], a[248:251], a[112:115], a[8:11]
    ds_read_b64_tr_b16 a[230:231], v12 offset:20992
    v_mfma_f32_16x16x32_bf16 a[12:15], a[252:255], a[112:115], a[12:15]
    ds_read_b64_tr_b16 a[232:233], v13 offset:20480
    v_mfma_f32_16x16x32_bf16 a[28:31], a[252:255], a[116:119], a[28:31]
    ds_read_b64_tr_b16 a[234:235], v13 offset:20992
    v_mfma_f32_16x16x32_bf16 a[24:27], a[248:251], a[116:119], a[24:27]
    buffer_load_dwordx4 a[80:83], v3, s[16:19], s89 offen offset:0 sc1
    v_mfma_f32_16x16x32_bf16 a[20:23], a[244:247], a[116:119], a[20:23]
    ds_read_b64_tr_b16 a[236:237], v14 offset:20480
    v_mfma_f32_16x16x32_bf16 a[16:19], a[240:243], a[116:119], a[16:19]
    ds_read_b64_tr_b16 a[238:239], v14 offset:20992
    s_waitcnt vmcnt(5)
    v_mfma_f32_16x16x32_bf16 a[32:35], a[240:243], a[120:123], a[32:35]
    buffer_load_dwordx4 a[84:87], v4, s[16:19], s89 offen offset:0 sc1
    v_mfma_f32_16x16x32_bf16 a[36:39], a[244:247], a[120:123], a[36:39]
    v_mfma_f32_16x16x32_bf16 a[40:43], a[248:251], a[120:123], a[40:43]
    v_mfma_f32_16x16x32_bf16 a[44:47], a[252:255], a[120:123], a[44:47]
    v_mfma_f32_16x16x32_bf16 a[60:63], a[252:255], a[124:127], a[60:63]
    v_mfma_f32_16x16x32_bf16 a[56:59], a[248:251], a[124:127], a[56:59]
    buffer_load_dwordx4 a[88:91], v5, s[16:19], s89 offen offset:0 sc1
    v_mfma_f32_16x16x32_bf16 a[52:55], a[244:247], a[124:127], a[52:55]
    v_mfma_f32_16x16x32_bf16 a[48:51], a[240:243], a[124:127], a[48:51]
    ds_read_b64_tr_b16 a[240:241], v11 offset:24576
    s_waitcnt lgkmcnt(15)
    s_waitcnt vmcnt(5)
    v_mfma_f32_16x16x32_bf16 a[0:3], a[128:131], a[64:67], a[0:3]
    buffer_load_dwordx4 a[92:95], v6, s[16:19], s89 offen offset:0 sc1
    v_mfma_f32_16x16x32_bf16 a[4:7], a[132:135], a[64:67], a[4:7]
    buffer_load_dwordx2 v[30:31], v32, s[16:19], s68 offen offset:512 sc1
    v_mfma_f32_16x16x32_bf16 a[8:11], a[136:139], a[64:67], a[8:11]
    ds_read_b64_tr_b16 a[242:243], v11 offset:25088
    v_mfma_f32_16x16x32_bf16 a[12:15], a[140:143], a[64:67], a[12:15]
    ds_read_b64_tr_b16 a[244:245], v12 offset:24576
    v_mfma_f32_16x16x32_bf16 a[28:31], a[140:143], a[68:71], a[28:31]
    ds_read_b64_tr_b16 a[246:247], v12 offset:25088
    v_mfma_f32_16x16x32_bf16 a[24:27], a[136:139], a[68:71], a[24:27]
    ds_read_b64_tr_b16 a[248:249], v13 offset:24576
    s_cmp_eq_u32 s90, 88064
    s_cselect_b32 s90, 0x20000000, s90
    buffer_load_dwordx4 a[96:99], v3, s[16:19], s90 offen offset:0 sc1
    v_mfma_f32_16x16x32_bf16 a[20:23], a[132:135], a[68:71], a[20:23]
    ds_read_b64_tr_b16 a[250:251], v13 offset:25088
    v_mfma_f32_16x16x32_bf16 a[16:19], a[128:131], a[68:71], a[16:19]
    ds_read_b64_tr_b16 a[252:253], v14 offset:24576
    s_waitcnt vmcnt(6)
    v_mfma_f32_16x16x32_bf16 a[32:35], a[128:131], a[72:75], a[32:35]
    ds_read_b64_tr_b16 a[254:255], v14 offset:25088
    v_mfma_f32_16x16x32_bf16 a[36:39], a[132:135], a[72:75], a[36:39]
    v_mfma_f32_16x16x32_bf16 a[40:43], a[136:139], a[72:75], a[40:43]
    buffer_load_dwordx4 a[100:103], v4, s[16:19], s90 offen offset:0 sc1
    v_mfma_f32_16x16x32_bf16 a[44:47], a[140:143], a[72:75], a[44:47]
    v_mfma_f32_16x16x32_bf16 a[60:63], a[140:143], a[76:79], a[60:63]
    v_mfma_f32_16x16x32_bf16 a[56:59], a[136:139], a[76:79], a[56:59]
    v_mfma_f32_16x16x32_bf16 a[52:55], a[132:135], a[76:79], a[52:55]
    v_mfma_f32_16x16x32_bf16 a[48:51], a[128:131], a[76:79], a[48:51]
    buffer_load_dwordx4 a[104:107], v5, s[16:19], s90 offen offset:0 sc1
    s_waitcnt vmcnt(6)
    v_mfma_f32_16x16x32_bf16 a[0:3], a[144:147], a[80:83], a[0:3]
    ds_read_b64_tr_b16 a[128:129], v11 offset:28672
    v_mfma_f32_16x16x32_bf16 a[4:7], a[148:151], a[80:83], a[4:7]
    buffer_load_dwordx4 a[108:111], v6, s[16:19], s90 offen offset:0 sc1
    v_mfma_f32_16x16x32_bf16 a[8:11], a[152:155], a[80:83], a[8:11]
    ds_read_b64_tr_b16 a[130:131], v11 offset:29184
    v_mfma_f32_16x16x32_bf16 a[12:15], a[156:159], a[80:83], a[12:15]
    ds_read_b64_tr_b16 a[132:133], v12 offset:28672
    v_mfma_f32_16x16x32_bf16 a[28:31], a[156:159], a[84:87], a[28:31]
    ds_read_b64_tr_b16 a[134:135], v12 offset:29184
    v_mfma_f32_16x16x32_bf16 a[24:27], a[152:155], a[84:87], a[24:27]
    ds_read_b64_tr_b16 a[136:137], v13 offset:28672
    v_mfma_f32_16x16x32_bf16 a[20:23], a[148:151], a[84:87], a[20:23]
    ds_read_b64_tr_b16 a[138:139], v13 offset:29184
    v_mfma_f32_16x16x32_bf16 a[16:19], a[144:147], a[84:87], a[16:19]
    ds_read_b64_tr_b16 a[140:141], v14 offset:28672
    s_waitcnt vmcnt(5)
    v_mfma_f32_16x16x32_bf16 a[32:35], a[144:147], a[88:91], a[32:35]
    ds_read_b64_tr_b16 a[142:143], v14 offset:29184
    v_mfma_f32_16x16x32_bf16 a[36:39], a[148:151], a[88:91], a[36:39]
    v_mfma_f32_16x16x32_bf16 a[40:43], a[152:155], a[88:91], a[40:43]
    v_mfma_f32_16x16x32_bf16 a[44:47], a[156:159], a[88:91], a[44:47]
    v_mfma_f32_16x16x32_bf16 a[60:63], a[156:159], a[92:95], a[60:63]
    v_mfma_f32_16x16x32_bf16 a[56:59], a[152:155], a[92:95], a[56:59]
    v_mfma_f32_16x16x32_bf16 a[52:55], a[148:151], a[92:95], a[52:55]
    v_mfma_f32_16x16x32_bf16 a[48:51], a[144:147], a[92:95], a[48:51]
    s_waitcnt vmcnt(4)
    v_cmp_ne_u64 vcc, v[30:31], v[8:9]
    s_nop 1
    s_cbranch_vccnz L_retry_13
L_ok_15:
    s_mov_b32 s0, 88064
    buffer_load_dwordx4 a[112:115], v3, s[16:19], s0 offen offset:0 sc1
    s_waitcnt vmcnt(2)
    v_mfma_f32_16x16x32_bf16 a[16:19], a[160:163], a[100:103], a[16:19]
    buffer_load_dwordx4 a[116:119], v3, s[16:19], s0 offen offset:2048 sc1
    v_mfma_f32_16x16x32_bf16 a[20:23], a[164:167], a[100:103], a[20:23]
    v_mfma_f32_16x16x32_bf16 a[24:27], a[168:171], a[100:103], a[24:27]
    v_mfma_f32_16x16x32_bf16 a[28:31], a[172:175], a[100:103], a[28:31]
    s_mov_b32 s0, 96256
    buffer_load_dwordx4 a[120:123], v3, s[16:19], s0 offen offset:0 sc1
    v_mfma_f32_16x16x32_bf16 a[44:47], a[172:175], a[104:107], a[44:47]
    s_nop 0
    v_mfma_f32_16x16x32_bf16 a[40:43], a[168:171], a[104:107], a[40:43]
    ds_write_b128 v34, a[16:19] offset:0
    v_mfma_f32_16x16x32_bf16 a[36:39], a[164:167], a[104:107], a[36:39]
    v_mfma_f32_16x16x32_bf16 a[32:35], a[160:163], a[104:107], a[32:35]
    buffer_load_dwordx4 a[124:127], v3, s[16:19], s0 offen offset:2048 sc1
    s_waitcnt vmcnt(4)
    v_mfma_f32_16x16x32_bf16 a[48:51], a[160:163], a[108:111], a[48:51]
    ds_write_b128 v35, a[20:23] offset:0
    v_mfma_f32_16x16x32_bf16 a[52:55], a[164:167], a[108:111], a[52:55]
    v_mfma_f32_16x16x32_bf16 a[56:59], a[168:171], a[108:111], a[56:59]
    s_mov_b32 s0, 104448
    buffer_load_dwordx4 a[64:67], v3, s[16:19], s0 offen offset:0 sc1
    v_mfma_f32_16x16x32_bf16 a[60:63], a[172:175], a[108:111], a[60:63]
    ds_write_b128 v34, a[24:27] offset:128
    v_mfma_f32_16x16x32_bf16 a[12:15], a[172:175], a[96:99], a[12:15]
    v_mfma_f32_16x16x32_bf16 a[8:11], a[168:171], a[96:99], a[8:11]
    v_mfma_f32_16x16x32_bf16 a[4:7], a[164:167], a[96:99], a[4:7]
    buffer_load_dwordx4 a[68:71], v3, s[16:19], s0 offen offset:2048 sc1
    v_mfma_f32_16x16x32_bf16 a[0:3], a[160:163], a[96:99], a[0:3]
    ds_write_b128 v35, a[28:31] offset:128
    s_mov_b32 s0, 112640
    buffer_load_dwordx4 a[72:75], v3, s[16:19], s0 offen offset:0 sc1
    buffer_load_dwordx4 a[76:79], v3, s[16:19], s0 offen offset:2048 sc1
    s_mov_b32 s0, 92160
    buffer_load_dwordx4 a[80:83], v3, s[16:19], s0 offen offset:0 sc1
    buffer_load_dwordx4 a[84:87], v3, s[16:19], s0 offen offset:2048 sc1
    s_waitcnt vmcnt(8)
    v_mfma_f32_16x16x32_bf16 a[0:3], v[96:99], a[112:115], a[0:3]
    ds_write_b128 v34, a[32:35] offset:4096
    v_mfma_f32_16x16x32_bf16 a[4:7], v[100:103], a[112:115], a[4:7]
    v_mfma_f32_16x16x32_bf16 a[8:11], v[104:107], a[112:115], a[8:11]
    s_mov_b32 s0, 100352
    buffer_load_dwordx4 a[88:91], v3, s[16:19], s0 offen offset:0 sc1
    v_mfma_f32_16x16x32_bf16 a[12:15], v[108:111], a[112:115], a[12:15]
    ds_write_b128 v35, a[36:39] offset:4096
    v_mfma_f32_16x16x32_bf16 a[0:3], v[112:115], a[116:119], a[0:3]
    v_mfma_f32_16x16x32_bf16 a[4:7], v[116:119], a[116:119], a[4:7]
    v_mfma_f32_16x16x32_bf16 a[8:11], v[120:123], a[116:119], a[8:11]
    buffer_load_dwordx4 a[92:95], v3, s[16:19], s0 offen offset:2048 sc1
    v_mfma_f32_16x16x32_bf16 a[12:15], v[124:127], a[116:119], a[12:15]
    ds_write_b128 v34, a[40:43] offset:4224
    s_waitcnt vmcnt(8)
    v_mfma_f32_16x16x32_bf16 a[0:3], v[128:131], a[120:123], a[0:3]
    v_mfma_f32_16x16x32_bf16 a[4:7], v[132:135], a[120:123], a[4:7]
    s_mov_b32 s0, 108544
    buffer_load_dwordx4 a[96:99], v3, s[16:19], s0 offen offset:0 sc1
    v_mfma_f32_16x16x32_bf16 a[8:11], v[136:139], a[120:123], a[8:11]
    ds_write_b128 v35, a[44:47] offset:4224
    v_mfma_f32_16x16x32_bf16 a[12:15], v[140:143], a[120:123], a[12:15]
    v_mfma_f32_16x16x32_bf16 a[0:3], v[144:147], a[124:127], a[0:3]
    v_mfma_f32_16x16x32_bf16 a[4:7], v[148:151], a[124:127], a[4:7]
    buffer_load_dwordx4 a[100:103], v3, s[16:19], s0 offen offset:2048 sc1
    v_mfma_f32_16x16x32_bf16 a[8:11], v[152:155], a[124:127], a[8:11]
    ds_write_b128 v34, a[48:51] offset:8192
    v_mfma_f32_16x16x32_bf16 a[12:15], v[156:159], a[124:127], a[12:15]
    s_waitcnt vmcnt(8)
    v_mfma_f32_16x16x32_bf16 a[0:3], v[160:163], a[64:67], a[0:3]
    s_mov_b32 s0, 116736
    buffer_load_dwordx4 a[104:107], v3, s[16:19], s0 offen offset:0 sc1
    v_mfma_f32_16x16x32_bf16 a[4:7], v[164:167], a[64:67], a[4:7]
    ds_write_b128 v35, a[52:55] offset:8192
    v_mfma_f32_16x16x32_bf16 a[8:11], v[168:171], a[64:67], a[8:11]
    v_mfma_f32_16x16x32_bf16 a[12:15], v[172:175], a[64:67], a[12:15]
    v_mfma_f32_16x16x32_bf16 a[0:3], v[176:179], a[68:71], a[0:3]
    buffer_load_dwordx4 a[108:111], v3, s[16:19], s0 offen offset:2048 sc1
    v_mfma_f32_16x16x32_bf16 a[4:7], v[180:183], a[68:71], a[4:7]
    ds_write_b128 v34, a[56:59] offset:8320
    v_mfma_f32_16x16x32_bf16 a[8:11], v[184:187], a[68:71], a[8:11]
    v_mfma_f32_16x16x32_bf16 a[12:15], v[188:191], a[68:71], a[12:15]
    s_waitcnt vmcnt(8)
    v_mfma_f32_16x16x32_bf16 a[0:3], v[192:195], a[72:75], a[0:3]
    ds_write_b128 v35, a[60:63] offset:8320
    v_mfma_f32_16x16x32_bf16 a[4:7], v[196:199], a[72:75], a[4:7]
    v_mfma_f32_16x16x32_bf16 a[8:11], v[200:203], a[72:75], a[8:11]
    v_mfma_f32_16x16x32_bf16 a[12:15], v[204:207], a[72:75], a[12:15]
    v_mfma_f32_16x16x32_bf16 a[0:3], v[208:211], a[76:79], a[0:3]
    v_mfma_f32_16x16x32_bf16 a[4:7], v[212:215], a[76:79], a[4:7]
    v_mfma_f32_16x16x32_bf16 a[8:11], v[216:219], a[76:79], a[8:11]
    s_waitcnt lgkmcnt(0)
    v_mfma_f32_16x16x32_bf16 a[12:15], v[220:223], a[76:79], a[12:15]
    s_barrier
    s_waitcnt vmcnt(6)
    v_mfma_f32_16x16x32_bf16 a[0:3], v[224:227], a[80:83], a[0:3]
    ds_read_b128 v[64:67], v24 offset:0
    v_mfma_f32_16x16x32_bf16 a[4:7], v[228:231], a[80:83], a[4:7]
    ds_read_b128 v[68:71], v25 offset:0
    v_mfma_f32_16x16x32_bf16 a[8:11], v[232:235], a[80:83], a[8:11]
    ds_read_b128 v[72:75], v24 offset:2048
    v_mfma_f32_16x16x32_bf16 a[12:15], v[236:239], a[80:83], a[12:15]
    ds_read_b128 v[76:79], v25 offset:2048
    v_mfma_f32_16x16x32_bf16 a[0:3], v[240:243], a[84:87], a[0:3]
    ds_read_b128 v[80:83], v26 offset:0
    v_mfma_f32_16x16x32_bf16 a[4:7], v[244:247], a[84:87], a[4:7]
    ds_read_b128 v[84:87], v27 offset:0
    v_mfma_f32_16x16x32_bf16 a[8:11], v[248:251], a[84:87], a[8:11]
    ds_read_b128 v[88:91], v26 offset:2048
    v_mfma_f32_16x16x32_bf16 a[12:15], v[252:255], a[84:87], a[12:15]
    ds_read_b128 v[92:95], v27 offset:2048
    s_waitcnt vmcnt(4)
    v_mfma_f32_16x16x32_bf16 a[0:3], a[176:179], a[88:91], a[0:3]
    v_mfma_f32_16x16x32_bf16 a[4:7], a[180:183], a[88:91], a[4:7]
    v_mfma_f32_16x16x32_bf16 a[8:11], a[184:187], a[88:91], a[8:11]
    v_mfma_f32_16x16x32_bf16 a[12:15], a[188:191], a[88:91], a[12:15]
    v_mfma_f32_16x16x32_bf16 a[0:3], a[192:195], a[92:95], a[0:3]
    s_waitcnt lgkmcnt(4)
    v_add_f32 v48, v48, v64
    v_mfma_f32_16x16x32_bf16 a[4:7], a[196:199], a[92:95], a[4:7]
    v_add_f32 v49, v49, v65
    v_add_f32 v50, v50, v66
    v_mfma_f32_16x16x32_bf16 a[8:11], a[200:203], a[92:95], a[8:11]
    v_add_f32 v51, v51, v67
    v_add_f32 v52, v52, v68
    v_mfma_f32_16x16x32_bf16 a[12:15], a[204:207], a[92:95], a[12:15]
    v_add_f32 v53, v53, v69
    v_add_f32 v54, v54, v70
    s_waitcnt vmcnt(3)
    v_mfma_f32_16x16x32_bf16 a[0:3], a[208:211], a[96:99], a[0:3]
    v_add_f32 v55, v55, v71
    v_add_f32_e64 v56, v56, v72
    v_mfma_f32_16x16x32_bf16 a[4:7], a[212:215], a[96:99], a[4:7]
    v_add_f32 v57, v57, v73
    v_add_f32 v58, v58, v74
    v_mfma_f32_16x16x32_bf16 a[8:11], a[216:219], a[96:99], a[8:11]
    v_add_f32 v59, v59, v75
    v_add_f32 v60, v60, v76
    v_mfma_f32_16x16x32_bf16 a[12:15], a[220:223], a[96:99], a[12:15]
    v_add_f32 v61, v61, v77
    v_add_f32 v62, v62, v78
    s_waitcnt vmcnt(2)
    v_mfma_f32_16x16x32_bf16 a[0:3], a[224:227], a[100:103], a[0:3]
    v_add_f32 v63, v63, v79
    s_waitcnt lgkmcnt(0)
    v_mfma_f32_16x16x32_bf16 a[4:7], a[228:231], a[100:103], a[4:7]
    ds_read_b128 v[64:67], v18 offset:0
    v_add_f32 v48, v48, v80
    v_mfma_f32_16x16x32_bf16 a[8:11], a[232:235], a[100:103], a[8:11]
    ds_read_b128 v[68:71], v19 offset:0
    v_add_f32 v49, v49, v81
    v_mfma_f32_16x16x32_bf16 a[12:15], a[236:239], a[100:103], a[12:15]
    ds_read_b128 v[72:75], v18 offset:2048
    v_add_f32 v50, v50, v82
    s_waitcnt vmcnt(1)
    v_mfma_f32_16x16x32_bf16 a[0:3], a[240:243], a[104:107], a[0:3]
    ds_read_b128 v[76:79], v19 offset:2048
    v_add_f32 v51, v51, v83
    v_mfma_f32_16x16x32_bf16 a[4:7], a[244:247], a[104:107], a[4:7]
    v_add_f32 v52, v52, v84
    v_add_f32 v53, v53, v85
    v_mfma_f32_16x16x32_bf16 a[8:11], a[248:251], a[104:107], a[8:11]
    v_add_f32 v54, v54, v86
    v_add_f32 v55, v55, v87
    v_mfma_f32_16x16x32_bf16 a[12:15], a[252:255], a[104:107], a[12:15]
    v_add_f32 v56, v56, v88
    v_add_f32 v57, v57, v89
    s_waitcnt vmcnt(0)
    v_mfma_f32_16x16x32_bf16 a[0:3], a[128:131], a[108:111], a[0:3]
    v_add_f32 v58, v58, v90
    v_add_f32_e64 v59, v59, v91
    v_mfma_f32_16x16x32_bf16 a[4:7], a[132:135], a[108:111], a[4:7]
    v_add_f32 v60, v60, v92
    v_add_f32 v61, v61, v93
    v_mfma_f32_16x16x32_bf16 a[8:11], a[136:139], a[108:111], a[8:11]
    v_add_f32 v62, v62, v94
    v_add_f32 v63, v63, v95
    v_mfma_f32_16x16x32_bf16 a[12:15], a[140:143], a[108:111], a[12:15]
    ds_write_b128 v34, a[0:3] offset:12288
    s_nop 0
    ds_write_b128 v35, a[4:7] offset:12288
    s_waitcnt lgkmcnt(2)
    v_add_f32 v48, v48, v64
    v_add_f32 v49, v49, v65
    v_add_f32 v50, v50, v66
    v_add_f32 v51, v51, v67
    v_add_f32 v52, v52, v68
    v_add_f32 v53, v53, v69
    v_add_f32 v54, v54, v70
    v_add_f32 v55, v55, v71
    v_add_f32 v56, v56, v72
    v_add_f32 v57, v57, v73
    ds_write_b128 v34, a[8:11] offset:12416
    v_add_f32 v58, v58, v74
    v_add_f32 v59, v59, v75
    v_add_f32 v60, v60, v76
    v_add_f32 v61, v61, v77
    v_add_f32 v62, v62, v78
    v_add_f32 v63, v63, v79
    ds_write_b128 v35, a[12:15] offset:12416
    ds_read_b128 v[80:83], v15 offset:0
    ds_read_b128 v[84:87], v2 offset:0
    ds_read_b128 v[88:91], v15 offset:2048
    ds_read_b128 v[92:95], v2 offset:2048
    s_waitcnt lgkmcnt(2)
    v_pk_add_f32 v[48:49], v[48:49], v[80:81]
    v_pk_add_f32 v[50:51], v[50:51], v[82:83]
    v_pk_add_f32 v[52:53], v[52:53], v[84:85]
    v_pk_add_f32 v[54:55], v[54:55], v[86:87]
    v_cvt_pk_bf16_f32 v36, v48, v49
    v_cvt_pk_bf16_f32 v37, v50, v51
    v_cvt_pk_bf16_f32 v38, v52, v53
    v_cvt_pk_bf16_f32 v39, v54, v55
    buffer_store_dwordx4 v[36:39], v7, s[28:31], s91 offen sc1
    s_waitcnt lgkmcnt(0)
    v_pk_add_f32 v[56:57], v[56:57], v[88:89]
    v_pk_add_f32 v[58:59], v[58:59], v[90:91]
    v_pk_add_f32 v[60:61], v[60:61], v[92:93]
    v_pk_add_f32 v[62:63], v[62:63], v[94:95]
    v_cvt_pk_bf16_f32 v40, v56, v57
    v_cvt_pk_bf16_f32 v41, v58, v59
    v_cvt_pk_bf16_f32 v42, v60, v61
    v_cvt_pk_bf16_f32 v43, v62, v63
    buffer_store_dwordx4 v[40:43], v7, s[28:31], s71 offen sc1
    s_or_b32 s70, s2, s3
    s_cmp_lg_u32 s70, 0
    s_cbranch_scc1 L_noe_16
    s_mov_b64 exec, 1
    buffer_store_dword v8, v33, s[16:19], 0 offen sc1
    s_mov_b64 exec, -1
L_noe_16:
    s_endpgm
L_retry_1:
    s_mov_b32 s72, 0
L_poll_2:
    s_and_b32 s70, s3, 1
    s_xor_b32 s70, s70, 0
    s_add_u32 s70, s70, s65
    s_and_b32 s70, s70, 3
    s_lshl_b32 s70, s70, 9
    s_add_u32 s70, s70, s69
    buffer_load_dwordx4 v[120:123], v10, s[16:19], s70 offen sc1
    s_and_b32 s70, s3, 1
    s_xor_b32 s70, s70, 1
    s_add_u32 s70, s70, s65
    s_and_b32 s70, s70, 3
    s_lshl_b32 s70, s70, 9
    s_add_u32 s70, s70, s69
    buffer_load_dwordx4 v[124:127], v10, s[16:19], s70 offen sc1
    s_add_u32 s72, s72, 1
    s_cmp_gt_u32 s72, 2000000
    s_cbranch_scc1 L_ok_3
    s_waitcnt vmcnt(0)
    v_xor_b32 v16, v8, v121
    v_xor_b32 v17, v8, v123
    v_xor_b32 v30, v8, v125
    v_xor_b32 v31, v8, v127
    v_or3_b32 v16, v16, v30, v31
    v_cmp_ne_u64_e64 vcc, 0, v[16:17]
    s_nop 4
    s_cbranch_vccnz L_poll_2
    s_branch L_ok_3
L_retry_4:
    s_mov_b32 s72, 0
L_poll_5:
    s_add_u32 s70, s65, 2
    s_and_b32 s70, s70, 3
    s_lshl_b32 s70, s70, 9
    s_add_u32 s70, s70, s69
    buffer_load_dwordx4 v[128:131], v10, s[16:19], s70 offen sc1
    s_add_u32 s70, s65, 3
    s_and_b32 s70, s70, 3
    s_lshl_b32 s70, s70, 9
    s_add_u32 s70, s70, s69
    buffer_load_dwordx4 v[132:135], v10, s[16:19], s70 offen sc1
    s_add_u32 s72, s72, 1
    s_cmp_gt_u32 s72, 2000000
    s_cbranch_scc1 L_ok_6
    s_waitcnt vmcnt(0)
    v_xor_b32 v16, v8, v129
    v_xor_b32 v17, v8, v131
    v_xor_b32 v30, v8, v133
    v_xor_b32 v31, v8, v135
    v_or3_b32 v16, v16, v30, v31
    v_cmp_ne_u64_e64 vcc, 0, v[16:17]
    s_nop 4
    s_cbranch_vccnz L_poll_5
    s_branch L_ok_6
L_retry_7:
    s_mov_b32 s72, 0
L_poll_8:
    buffer_load_dwordx2 v[30:31], v32, s[16:19], s68 offen offset:0 sc1
    s_add_u32 s72, s72, 1
    s_cmp_gt_u32 s72, 2000000
    s_cbranch_scc1 L_ok_9
    s_waitcnt vmcnt(0)
    v_cmp_ne_u64 vcc, v[30:31], v[8:9]
    s_nop 4
    s_cbranch_vccnz L_poll_8
    s_branch L_ok_9
L_retry_10:
    s_mov_b32 s72, 0
L_poll_11:
    buffer_load_dwordx2 v[30:31], v32, s[16:19], s68 offen offset:256 sc1
    s_add_u32 s72, s72, 1
    s_cmp_gt_u32 s72, 2000000
    s_cbranch_scc1 L_ok_12
    s_waitcnt vmcnt(0)
    v_cmp_ne_u64 vcc, v[30:31], v[8:9]
    s_nop 4
    s_cbranch_vccnz L_poll_11
    s_branch L_ok_12
L_retry_13:
    s_mov_b32 s72, 0
L_poll_14:
    buffer_load_dwordx2 v[30:31], v32, s[16:19], s68 offen offset:512 sc1
    s_add_u32 s72, s72, 1
    s_cmp_gt_u32 s72, 2000000
    s_cbranch_scc1 L_ok_15
    s_waitcnt vmcnt(0)
    v_cmp_ne_u64 vcc, v[30:31], v[8:9]
    s_nop 4
    s_cbranch_vccnz L_poll_14
    s_branch L_ok_15
    .p2align 12
L_ffn:
    s_add_u32 s70, s5, 4
    s_and_b32 s70, s70, 7
    s_lshl_b32 s73, s70, 7
    s_lshl2_add_u32 s6, s70, s3
    s_add_u32 s94, s94, s3
    s_mov_b32 s32, s44
    s_mov_b32 s33, s45
    s_mov_b32 s34, 16384
    s_mov_b32 s35, 0x20000
    v_and_b32 v164, 0x13, v0
    v_and_b32_e64 v165, 4, v0
    v_lshl_add_u32 v164, v165, 1, v164
    v_bfe_u32 v165, v0, 3, 1
    v_lshl_add_u32 v164, v165, 2, v164
    v_and_b32 v165, 32, v0
    v_lshl_add_u32 v164, v165, 8, v164
    v_lshlrev_b32 v164, 1, v164
    v_bfe_u32 v68, v0, 1, 1
    buffer_load_dwordx4 v[44:47], v7, s[36:39], s67 offen
    v_lshl_add_u32 v68, v65, 1, v68
    s_mov_b64 s[36:37], s[52:53]
    s_movk_i32 s38, 2752
    s_lshl_b32 s0, s94, 6
    buffer_load_ushort v163, v164, s[36:39], s0 offen
    v_lshlrev_b32_e64 v68, 3, v68
    s_mov_b64 s[36:37], s[42:43]
    s_mov_b32 s38, 1572864
    s_lshr_b32 s0, s6, 1
    s_add_u32 m0, s97, 114688
    s_lshl_b32 s0, s0, 10
    buffer_load_dwordx4 v1, s[32:35], s0 offen lds
    v_lshl_add_u32 v68, v67, 5, v68
    s_and_b32 s72, s98, 0x200
    s_add_u32 s70, s97, s72
    s_add_u32 s70, s70, 114688
    v_add_u32 v176, s70, v68
    v_xor_b32 v177, 0x200, v176
    s_movk_i32 s71, 3072
    s_mul_i32 s84, s64, 196608
    s_lshl_b32 s85, s3, 11
    s_mul_i32 s70, s3, 49152
    s_add_u32 s73, s73, s70
    v_lshrrev_b32 v16, 3, v0
    v_lshlrev_b32 v17, 2, v0
    v_and_b32 v17, 64, v17
    v_xor_b32 v17, v17, v7
    v_mad_u32_u24 v20, v16, s71, v17
    v_add_u32 v20, s73, v20
    v_add_u32 v21, 23552, v20
    v_lshl_add_u32 v27, v16, 10, v17
    v_lshrrev_b32_e64 v68, 1, v64
    v_lshl_add_u32 v68, v68, 6, v66
    v_lshl_add_u32 v68, v65, 5, v68
    v_lshl_add_u32 v68, v67, 7, v68
    v_lshrrev_b32 v28, 4, v0
    v_lshl_add_u32 v28, v28, 3, v64
    v_and_b32 v69, 2, v64
    v_or_b32_e64 v69, v69, v65
    v_lshl_add_u32 v28, v28, 2, v69
    v_and_b32 v69, 3, v0
    v_lshl_add_u32 v28, v28, 2, v69
    v_lshlrev_b32 v28, 3, v28
    s_lshl_b32 s70, s3, 5
    v_xor_b32 v68, s70, v68
    v_add_u32 v15, 131072, v68
    v_and_b32 v32, 15, v0
    v_lshlrev_b32 v32, 3, v32
    v_bfe_u32 v16, v0, 2, 1
    v_lshrrev_b32 v18, 5, v0
    v_cmp_eq_u32 vcc, v16, v18
    v_and_b32 v16, 16, v1
    v_mov_b32 v18, 0x3f80
    v_lshlrev_b32 v18, v16, v18
    v_cndmask_b32_e64 v18, 0, v18, vcc
    v_bfe_u32 v16, v0, 1, 1
    v_bfe_u32 v19, v0, 3, 2
    v_lshl_add_u32 v16, v19, 1, v16
    v_cmp_eq_u32 vcc, 0, v16
    v_cmp_eq_u32 s[70:71], 1, v16
    s_nop 0
    v_cndmask_b32 v192, 0, v18, vcc
    v_cndmask_b32 v193, 0, v18, s[70:71]
    v_cmp_eq_u32_e64 vcc, 2, v16
    v_cmp_eq_u32 s[70:71], 3, v16
    s_nop 0
    v_cndmask_b32 v194, 0, v18, vcc
    v_cndmask_b32 v195, 0, v18, s[70:71]
    s_lshl_b32 s95, s6, 7
    s_add_u32 s95, s95, 4096
    s_waitcnt vmcnt(11)
    s_add_u32 s0, s64, 1
    s_and_b32 s0, s0, 7
    s_mul_i32 s0, s0, 176128
    s_add_u32 m0, s97, 147456
    s_add_u32 s0, s0, s91
    buffer_load_dwordx4 v136, s[12:15], s0 offen offset:0 lds
    v_mov_b32 v17, 0x3f803f80
    v_mov_b32 v120, 0
    v_mov_b32 v121, 0
    v_mov_b32 v122, 0
    v_mov_b32 v123, 0
    v_dot2c_f32_bf16 v120, v48, v17
    v_dot2c_f32_bf16 v122, v48, v48
    v_dot2c_f32_bf16 v121, v52, v17
    v_dot2c_f32_bf16 v123, v52, v52
    v_dot2c_f32_bf16 v120, v49, v17
    v_dot2c_f32_bf16 v122, v49, v49
    buffer_load_dwordx4 v137, s[12:15], s0 offen offset:1024 lds
    v_dot2c_f32_bf16 v121, v53, v17
    v_dot2c_f32_bf16 v123, v53, v53
    v_dot2c_f32_bf16 v120, v50, v17
    v_dot2c_f32_bf16 v122, v50, v50
    v_dot2c_f32_bf16 v121, v54, v17
    v_dot2c_f32_bf16 v123, v54, v54
    v_dot2c_f32_bf16 v120, v51, v17
    v_dot2c_f32_bf16 v122, v51, v51
    v_dot2c_f32_bf16 v121, v55, v17
    v_dot2c_f32_bf16 v123, v55, v55
    s_waitcnt lgkmcnt(0)
    s_mov_b32 s70, s86
    buffer_load_dwordx4 v138, s[12:15], s0 offen offset:2048 lds
    v_lshrrev_b32 v16, 1, v0
    v_permlane32_swap_b32 v120, v121
    v_permlane32_swap_b32 v122, v123
    v_add_f32 v120, v120, v121
    v_add_f32 v122, v122, v123
    s_add_u32 s70, s70, 0x9e3779b9
    v_mov_b32 v8, s70
    v_permlane16_swap_b32 v120, v122
    v_add_f32 v120, v120, v122
    v_mov_b32 v9, s70
    v_mov_b32 v121, s70
    buffer_load_dwordx4 v139, s[12:15], s0 offen offset:3072 lds
    v_add_f32_dpp v120, v120, v120 quad_perm:[1,0,3,2] row_mask:0xf bank_mask:0xf
    s_nop 1
    v_add_f32_dpp v120, v120, v120 quad_perm:[2,3,0,1] row_mask:0xf bank_mask:0xf
    s_nop 1
    v_add_f32_dpp v120, v120, v120 row_half_mirror row_mask:0xf bank_mask:0xf
    s_add_u32 s83, s83, 256
    s_and_b32 s83, s83, 0x380
    s_add_u32 m0, s82, 8192
    s_add_u32 s0, s75, s83
    buffer_load_dwordx4 v3, s[8:11], s0 offen offset:0 lds
    v_add_f32_dpp v120, v120, v120 row_mirror row_mask:0xf bank_mask:0xf
    v_mul_f32 v120, 0x3b000000, v120
    v_mov_b32 v122, v120
    v_mov_b32 v123, v120
    v_and_b32_e64 v17, 16, v0
    s_nop 0
    v_permlane16_swap_b32_e64 v122, v123
    v_cmp_ne_u32_e64 vcc, 0, v17
    v_fma_f32 v123, -v122, v122, v123
    v_max_f32_e64 v123, 0, v123
    v_add_f32 v123, 0x3727c5ac, v123
    buffer_load_dwordx4 v4, s[8:11], s0 offen offset:1024 lds
    v_sqrt_f32 v123, v123
    s_nop 0
    v_cndmask_b32 v122, -v122, v123, vcc
    v_cvt_pk_bf16_f32 v120, v122, v122
    v_lshlrev_b32_e64 v123, 16, v120
    v_sub_f32_e64 v122, v122, v123
    v_cvt_pk_bf16_f32 v120, v123, v122
    s_mov_b32 exec_lo, 0x00010001
    s_mov_b32 exec_hi, 0x00010001
    buffer_store_dwordx2 v[120:121], v16, s[16:19], s68 offen sc1
    s_mov_b64 exec, -1
    s_mov_b64 exec, 0
    s_cmp_eq_u32 s3, 0
    s_cbranch_scc1 L_pad_ffn_0
    s_cmp_eq_u32 s3, 1
    s_cbranch_scc1 L_pad_ffn_1
    s_cmp_eq_u32 s3, 2
    s_cbranch_scc1 L_pad_ffn_2
    s_branch L_pad_ffn_3
L_ret_ffn:
    s_mov_b64 exec, -1
    s_lshr_b32 s68, s66, 1
    buffer_load_dwordx4 v5, s[8:11], s0 offen offset:2048 lds
    s_lshl4_add_u32 s68, s68, s3
    s_lshl_b32 s68, s68, 6
    s_add_u32 s68, s68, 12288
    s_lshl_b32 s72, s3, 3
    s_lshr_b32 s86, 0x20160b00, s72
    s_and_b32 s86, s86, 0xff
    s_lshl_b32 s86, s86, 11
    s_lshr_b32 s87, 0x261b1006, s72
    s_and_b32 s87, s87, 0xff
    s_lshl_b32 s87, s87, 11
    s_lshr_b32 s88, 0x241a0f04, s72
    buffer_load_dwordx4 v6, s[8:11], s0 offen offset:3072 lds
    s_and_b32 s88, s88, 0xff
    s_lshl_b32 s88, s88, 11
    s_lshr_b32 s89, 0x251f1405, s72
    s_and_b32 s89, s89, 0xff
    s_lshl_b32 s89, s89, 11
    s_lshr_b32 s90, 0x2a2b150a, s72
    s_add_u32 s0, s64, 2
    s_and_b32 s0, s0, 7
    s_mul_i32 s0, s0, 176128
    s_add_u32 m0, s97, 65536
    s_add_u32 s0, s0, s91
    buffer_load_dwordx4 v136, s[12:15], s0 offen offset:0 lds
    s_and_b32 s90, s90, 0xff
    s_lshl_b32 s90, s90, 11
    s_and_b32 s70, s98, 0x8000
    s_xor_b32 s71, s70, 0x8000
    v_add_u32 v240, s70, v11
    v_add_u32 v11, s71, v11
    v_add_u32 v241, s70, v12
    v_add_u32 v12, s71, v12
    v_add_u32 v242, s70, v13
    v_add_u32 v13, s71, v13
    v_add_u32 v243, s70, v14
    buffer_load_dwordx4 v137, s[12:15], s0 offen offset:1024 lds
    v_add_u32 v14, s71, v14
    v_lshrrev_b32_e64 v16, 3, v0
    v_lshl_add_u32 v7, v16, 10, v7
    v_and_b32 v18, 4, v0
    v_cmp_ne_u32 vcc, 0, v18
    v_mov_b32 v19, 0x80008000
    s_nop 0
    v_cndmask_b32 v19, 0, v19, vcc
    s_waitcnt vmcnt(14)
    s_barrier
    ds_read_b64_tr_b16 a[0:1], v26 offset:0
    ds_read_b64_tr_b16 a[2:3], v26 offset:1024
    ds_read_b128 a[128:131], v240 offset:0
    s_waitcnt vmcnt(11)
    ds_read_b64_tr_b16 v[200:201], v176 offset:0
    ds_read_b64_tr_b16 v[202:203], v176 offset:128
    buffer_load_dwordx4 v138, s[12:15], s0 offen offset:2048 lds
    ds_read_b64_tr_b16 a[4:5], v26 offset:4096
    ds_read_b64_tr_b16 a[6:7], v26 offset:5120
    ds_read_b128 a[132:135], v241 offset:0
    ds_read_b128 v[80:83], v11 offset:0
    ds_read_b64_tr_b16 v[204:205], v177 offset:0
    ds_read_b64_tr_b16 v[206:207], v177 offset:128
    s_waitcnt lgkmcnt(8)
    v_mfma_f32_32x32x16_bf16 v[48:63], a[0:3], a[128:131], 0
    ds_read_b64_tr_b16 a[8:9], v26 offset:8192
    ds_read_b64_tr_b16 a[10:11], v26 offset:9216
    ds_read_b128 a[136:139], v242 offset:0
    buffer_load_dwordx4 v139, s[12:15], s0 offen offset:3072 lds
    v_mfma_f32_16x16x32_bf16 v[140:143], v[144:147], a[0:3], 0
    s_waitcnt lgkmcnt(5)
    v_mfma_f32_32x32x16_bf16 v[48:63], a[4:7], a[132:135], v[48:63]
    ds_read_b64_tr_b16 a[12:13], v26 offset:12288
    ds_read_b64_tr_b16 a[14:15], v26 offset:13312
    s_add_u32 s0, s64, 3
    s_and_b32 s0, s0, 7
    s_mul_i32 s0, s0, 176128
    s_add_u32 m0, s97, 81920
    s_add_u32 s0, s0, s91
    buffer_load_dwordx4 v136, s[12:15], s0 offen offset:0 lds
    v_mfma_f32_32x32x16_bf16 v[64:79], a[0:3], v[80:83], 0
    ds_read_b128 a[140:143], v243 offset:0
    ds_read_b128 v[84:87], v12 offset:0
    s_waitcnt lgkmcnt(7)
    v_xor_b32 v200, v19, v200
    v_xor_b32_e64 v201, v19, v201
    v_xor_b32_e64 v202, v19, v202
    v_mfma_f32_16x16x32_bf16 v[140:143], v[144:147], a[4:7], v[140:143]
    v_xor_b32_e64 v203, v19, v203
    v_xor_b32 v204, v19, v204
    buffer_load_dwordx4 v137, s[12:15], s0 offen offset:1024 lds
    s_waitcnt vmcnt(11)
    s_barrier
    s_waitcnt lgkmcnt(4)
    v_mfma_f32_32x32x16_bf16 v[48:63], a[8:11], a[136:139], v[48:63]
    ds_read_b64_tr_b16 a[16:17], v26 offset:16384
    ds_read_b64_tr_b16 a[18:19], v26 offset:17408
    ds_read_b128 a[144:147], v240 offset:4096
    buffer_load_dwordx4 v138, s[12:15], s0 offen offset:2048 lds
    v_mfma_f32_16x16x32_bf16 v[140:143], v[144:147], a[8:11], v[140:143]
    v_xor_b32 v205, v19, v205
    v_xor_b32_e64 v206, v19, v206
    s_waitcnt lgkmcnt(3)
    v_mfma_f32_32x32x16_bf16 v[48:63], a[12:15], a[140:143], v[48:63]
    ds_read_b64_tr_b16 a[20:21], v26 offset:20480
    ds_read_b64_tr_b16 a[22:23], v26 offset:21504
    v_xor_b32 v207, v19, v207
    v_mov_b32 v115, 0
    v_lshl_or_b32 v114, v163, 16, v163
    v_mov_b32_e64 v119, 0
    v_mfma_f32_32x32x16_bf16 v[64:79], a[4:7], v[84:87], v[64:79]
    ds_read_b128 a[148:151], v241 offset:4096
    ds_read_b128 v[88:91], v13 offset:0
    buffer_load_dwordx4 v139, s[12:15], s0 offen offset:3072 lds
    v_mov_b32 v118, 0
    v_mfma_f32_16x16x32_bf16 v[140:143], v[144:147], a[12:15], v[140:143]
    s_waitcnt lgkmcnt(4)
    v_mfma_f32_32x32x16_bf16 v[48:63], a[16:19], a[144:147], v[48:63]
    ds_read_b64_tr_b16 a[24:25], v26 offset:24576
    ds_read_b64_tr_b16 a[26:27], v26 offset:25600
    ds_read_b128 a[152:155], v242 offset:4096
    s_add_u32 s83, s83, 256
    s_and_b32 s83, s83, 0x380
    s_add_u32 m0, s82, 16384
    s_add_u32 s0, s75, s83
    buffer_load_dwordx4 v3, s[8:11], s0 offen offset:0 lds
    v_mfma_f32_16x16x32_bf16 v[140:143], v[144:147], a[16:19], v[140:143]
    s_waitcnt lgkmcnt(3)
    v_mfma_f32_32x32x16_bf16 v[48:63], a[20:23], a[148:151], v[48:63]
    ds_read_b64_tr_b16 a[28:29], v26 offset:28672
    ds_read_b64_tr_b16 a[30:31], v26 offset:29696
    buffer_load_dwordx4 v4, s[8:11], s0 offen offset:1024 lds
    v_mfma_f32_32x32x16_bf16 v[64:79], a[8:11], v[88:91], v[64:79]
    ds_read_b128 a[156:159], v243 offset:4096
    ds_read_b128 v[92:95], v14 offset:0
    v_mfma_f32_16x16x32_bf16 v[140:143], v[144:147], a[20:23], v[140:143]
    buffer_load_dwordx4 v5, s[8:11], s0 offen offset:2048 lds
    buffer_load_dwordx4 v6, s[8:11], s0 offen offset:3072 lds
    s_add_u32 s0, s64, 4
    s_and_b32 s0, s0, 7
    s_mul_i32 s0, s0, 176128
    s_add_u32 m0, s97, 98304
    s_add_u32 s0, s0, s91
    buffer_load_dwordx4 v136, s[12:15], s0 offen offset:0 lds
    buffer_load_dwordx4 v137, s[12:15], s0 offen offset:1024 lds
    s_waitcnt vmcnt(10)
    s_barrier
    s_waitcnt lgkmcnt(4)
    v_mfma_f32_32x32x16_bf16 v[48:63], a[24:27], a[152:155], v[48:63]
    ds_read_b64_tr_b16 a[32:33], v25 offset:0
    ds_read_b64_tr_b16 a[34:35], v25 offset:1024
    ds_read_b128 a[160:163], v240 offset:8192
    buffer_load_dwordx4 v138, s[12:15], s0 offen offset:2048 lds
    v_mfma_f32_16x16x32_bf16 v[140:143], v[144:147], a[24:27], v[140:143]
    s_waitcnt lgkmcnt(3)
    v_mfma_f32_32x32x16_bf16 v[48:63], a[28:31], a[156:159], v[48:63]
    ds_read_b64_tr_b16 a[36:37], v25 offset:4096
    ds_read_b64_tr_b16 a[38:39], v25 offset:5120
    v_mfma_f32_32x32x16_bf16 v[64:79], a[12:15], v[92:95], v[64:79]
    ds_read_b128 a[164:167], v241 offset:8192
    ds_read_b128 v[96:99], v11 offset:4096
    buffer_load_dwordx4 v139, s[12:15], s0 offen offset:3072 lds
    v_mfma_f32_16x16x32_bf16 v[140:143], v[144:147], a[28:31], v[140:143]
    s_waitcnt lgkmcnt(4)
    v_mfma_f32_32x32x16_bf16 v[48:63], a[32:35], a[160:163], v[48:63]
    ds_read_b64_tr_b16 a[40:41], v25 offset:8192
    ds_read_b64_tr_b16 a[42:43], v25 offset:9216
    ds_read_b128 a[168:171], v242 offset:8192
    s_add_u32 s0, s64, 5
    s_and_b32 s0, s0, 7
    s_mul_i32 s0, s0, 176128
    s_add_u32 m0, s97, 114688
    s_add_u32 s0, s0, s91
    buffer_load_dwordx4 v136, s[12:15], s0 offen offset:0 lds
    v_mfma_f32_16x16x32_bf16 v[140:143], v[144:147], a[32:35], v[140:143]
    s_waitcnt lgkmcnt(3)
    v_mfma_f32_32x32x16_bf16 v[48:63], a[36:39], a[164:167], v[48:63]
    ds_read_b64_tr_b16 a[44:45], v25 offset:12288
    ds_read_b64_tr_b16 a[46:47], v25 offset:13312
    buffer_load_dwordx4 v137, s[12:15], s0 offen offset:1024 lds
    v_mfma_f32_32x32x16_bf16 v[64:79], a[16:19], v[96:99], v[64:79]
    ds_read_b128 a[172:175], v243 offset:8192
    ds_read_b128 v[100:103], v12 offset:4096
    v_mfma_f32_16x16x32_bf16 v[140:143], v[144:147], a[36:39], v[140:143]
    s_waitcnt vmcnt(10)
    s_barrier
    s_waitcnt lgkmcnt(4)
    v_mfma_f32_32x32x16_bf16 v[48:63], a[40:43], a[168:171], v[48:63]
    ds_read_b64_tr_b16 a[48:49], v25 offset:16384
    ds_read_b64_tr_b16 a[50:51], v25 offset:17408
    ds_read_b128 a[176:179], v240 offset:12288
    buffer_load_dwordx4 v138, s[12:15], s0 offen offset:2048 lds
    v_mfma_f32_16x16x32_bf16 v[140:143], v[144:147], a[40:43], v[140:143]
    s_waitcnt lgkmcnt(3)
    v_mfma_f32_32x32x16_bf16 v[48:63], a[44:47], a[172:175], v[48:63]
    ds_read_b64_tr_b16 a[52:53], v25 offset:20480
    ds_read_b64_tr_b16 a[54:55], v25 offset:21504
    buffer_load_dwordx4 v139, s[12:15], s0 offen offset:3072 lds
    v_mfma_f32_32x32x16_bf16 v[64:79], a[20:23], v[100:103], v[64:79]
    ds_read_b128 a[180:183], v241 offset:12288
    ds_read_b128 v[104:107], v13 offset:4096
    v_mfma_f32_16x16x32_bf16 v[140:143], v[144:147], a[44:47], v[140:143]
    s_add_u32 s83, s83, 256
    s_and_b32 s83, s83, 0x380
    s_add_u32 m0, s82, 24576
    s_add_u32 s0, s75, s83
    buffer_load_dwordx4 v3, s[8:11], s0 offen offset:0 lds
    s_waitcnt lgkmcnt(4)
    v_mfma_f32_32x32x16_bf16 v[48:63], a[48:51], a[176:179], v[48:63]
    ds_read_b64_tr_b16 a[56:57], v25 offset:24576
    ds_read_b64_tr_b16 a[58:59], v25 offset:25600
    ds_read_b128 a[184:187], v242 offset:12288
    v_mfma_f32_16x16x32_bf16 v[140:143], v[144:147], a[48:51], v[140:143]
    buffer_load_dwordx4 v4, s[8:11], s0 offen offset:1024 lds
    s_waitcnt lgkmcnt(3)
    v_mfma_f32_32x32x16_bf16 v[48:63], a[52:55], a[180:183], v[48:63]
    ds_read_b64_tr_b16 a[60:61], v25 offset:28672
    ds_read_b64_tr_b16 a[62:63], v25 offset:29696
    v_mfma_f32_32x32x16_bf16 v[64:79], a[24:27], v[104:107], v[64:79]
    ds_read_b128 a[188:191], v243 offset:12288
    ds_read_b128 v[108:111], v14 offset:4096
    buffer_load_dwordx4 v5, s[8:11], s0 offen offset:2048 lds
    v_mfma_f32_16x16x32_bf16 v[140:143], v[144:147], a[52:55], v[140:143]
    buffer_load_dwordx4 v6, s[8:11], s0 offen offset:3072 lds
    s_add_u32 s0, s64, 6
    s_and_b32 s0, s0, 7
    s_mul_i32 s0, s0, 176128
    s_add_u32 m0, s97, 131072
    s_add_u32 s0, s0, s91
    buffer_load_dwordx4 v136, s[12:15], s0 offen offset:0 lds
    buffer_load_dwordx4 v137, s[12:15], s0 offen offset:1024 lds
    s_waitcnt vmcnt(10)
    s_barrier
    s_waitcnt lgkmcnt(4)
    v_mfma_f32_32x32x16_bf16 v[48:63], a[56:59], a[184:187], v[48:63]
    ds_read_b64_tr_b16 a[64:65], v25 offset:32768
    ds_read_b64_tr_b16 a[66:67], v25 offset:33792
    ds_read_b128 a[192:195], v240 offset:16384
    buffer_load_dwordx4 v138, s[12:15], s0 offen offset:2048 lds
    v_mfma_f32_16x16x32_bf16 v[140:143], v[144:147], a[56:59], v[140:143]
    s_waitcnt lgkmcnt(3)
    v_mfma_f32_32x32x16_bf16 v[48:63], a[60:63], a[188:191], v[48:63]
    ds_read_b64_tr_b16 a[68:69], v25 offset:36864
    ds_read_b64_tr_b16 a[70:71], v25 offset:37888
    v_mfma_f32_32x32x16_bf16 v[64:79], a[28:31], v[108:111], v[64:79]
    ds_read_b128 a[196:199], v241 offset:16384
    ds_read_b128 v[80:83], v11 offset:8192
    buffer_load_dwordx4 v139, s[12:15], s0 offen offset:3072 lds
    v_mfma_f32_16x16x32_bf16 v[140:143], v[144:147], a[60:63], v[140:143]
    s_and_b32 s0, s3, 1
    s_xor_b32 s0, s0, 0
    s_add_u32 s0, s0, s65
    s_and_b32 s0, s0, 3
    s_lshl_b32 s0, s0, 9
    s_add_u32 s0, s0, s69
    buffer_load_dwordx4 v[120:123], v10, s[16:19], s0 offen sc1
    s_waitcnt lgkmcnt(4)
    v_mfma_f32_32x32x16_bf16 v[48:63], a[64:67], a[192:195], v[48:63]
    ds_read_b64_tr_b16 a[72:73], v25 offset:40960
    ds_read_b64_tr_b16 a[74:75], v25 offset:41984
    ds_read_b128 a[200:203], v242 offset:16384
    s_and_b32 s0, s3, 1
    s_xor_b32 s0, s0, 1
    s_add_u32 s0, s0, s65
    s_and_b32 s0, s0, 3
    s_lshl_b32 s0, s0, 9
    s_add_u32 s0, s0, s69
    buffer_load_dwordx4 v[124:127], v10, s[16:19], s0 offen sc1
    v_mfma_f32_16x16x32_bf16 v[140:143], v[144:147], a[64:67], v[140:143]
    s_waitcnt lgkmcnt(3)
    v_mfma_f32_32x32x16_bf16 v[48:63], a[68:71], a[196:199], v[48:63]
    ds_read_b64_tr_b16 a[76:77], v25 offset:45056
    ds_read_b64_tr_b16 a[78:79], v25 offset:46080
    s_add_u32 s0, s64, 7
    s_and_b32 s0, s0, 7
    s_mul_i32 s0, s0, 176128
    s_add_u32 m0, s97, 147456
    s_add_u32 s0, s0, s91
    buffer_load_dwordx4 v136, s[12:15], s0 offen offset:0 lds
    v_mfma_f32_32x32x16_bf16 v[64:79], a[32:35], v[80:83], v[64:79]
    ds_read_b128 a[204:207], v243 offset:16384
    ds_read_b128 v[84:87], v12 offset:8192
    v_mfma_f32_16x16x32_bf16 v[140:143], v[144:147], a[68:71], v[140:143]
    s_waitcnt vmcnt(11)
    s_barrier
    s_waitcnt lgkmcnt(4)
    v_mfma_f32_32x32x16_bf16 v[48:63], a[72:75], a[200:203], v[48:63]
    ds_read_b64_tr_b16 a[80:81], v25 offset:49152
    ds_read_b64_tr_b16 a[82:83], v25 offset:50176
    ds_read_b128 a[208:211], v240 offset:20480
    ds_read_b128 v[88:91], v13 offset:8192
    buffer_load_dwordx4 v137, s[12:15], s0 offen offset:1024 lds
    v_mfma_f32_16x16x32_bf16 v[140:143], v[144:147], a[72:75], v[140:143]
    s_waitcnt lgkmcnt(4)
    v_mfma_f32_32x32x16_bf16 v[48:63], a[76:79], a[204:207], v[48:63]
    ds_read_b64_tr_b16 a[84:85], v25 offset:53248
    ds_read_b64_tr_b16 a[86:87], v25 offset:54272
    buffer_load_dwordx4 v138, s[12:15], s0 offen offset:2048 lds
    v_mfma_f32_32x32x16_bf16 v[64:79], a[36:39], v[84:87], v[64:79]
    ds_read_b128 a[212:215], v241 offset:20480
    ds_read_b128 v[92:95], v14 offset:8192
    v_mfma_f32_16x16x32_bf16 v[140:143], v[144:147], a[76:79], v[140:143]
    s_waitcnt lgkmcnt(4)
    v_mfma_f32_32x32x16_bf16 v[48:63], a[80:83], a[208:211], v[48:63]
    ds_read_b64_tr_b16 a[88:89], v25 offset:57344
    ds_read_b64_tr_b16 a[90:91], v25 offset:58368
    buffer_load_dwordx4 v139, s[12:15], s0 offen offset:3072 lds
    v_mfma_f32_32x32x16_bf16 v[64:79], a[40:43], v[88:91], v[64:79]
    ds_read_b128 a[216:219], v242 offset:20480
    ds_read_b128 v[96:99], v11 offset:12288
    s_lshl1_add_u32 s0, s3, s64
    s_lshl_b32 s0, s0, 7
    s_and_b32 s82, s0, 0x380
    s_add_u32 s0, s0, 128
    s_and_b32 s83, s0, 0x380
    s_bitcmp1_b32 s7, 0
    s_cselect_b32 s0, s83, s82
    s_cselect_b32 s83, s82, s83
    s_cselect_b32 s74, 0x1000, 0
    s_mov_b32 s82, s0
    s_or_b32 s74, s74, s92
    s_xor_b32 m0, s74, 65536
    s_add_u32 s0, s76, s82
    buffer_load_dwordx4 v3, s[8:11], s0 offen offset:0 lds
    v_mfma_f32_16x16x32_bf16 v[140:143], v[144:147], a[80:83], v[140:143]
    s_waitcnt lgkmcnt(4)
    v_mfma_f32_32x32x16_bf16 v[48:63], a[84:87], a[212:215], v[48:63]
    ds_read_b64_tr_b16 a[92:93], v25 offset:61440
    ds_read_b64_tr_b16 a[94:95], v25 offset:62464
    v_mfma_f32_32x32x16_bf16 v[64:79], a[44:47], v[92:95], v[64:79]
    ds_read_b128 a[220:223], v243 offset:20480
    ds_read_b128 v[100:103], v12 offset:12288
    buffer_load_dwordx4 v4, s[8:11], s0 offen offset:1024 lds
    v_mfma_f32_16x16x32_bf16 v[140:143], v[144:147], a[84:87], v[140:143]
    buffer_load_dwordx4 v5, s[8:11], s0 offen offset:2048 lds
    buffer_load_dwordx4 v6, s[8:11], s0 offen offset:3072 lds
    s_waitcnt vmcnt(10)
    s_barrier
    s_waitcnt lgkmcnt(4)
    v_mfma_f32_32x32x16_bf16 v[48:63], a[88:91], a[216:219], v[48:63]
    ds_read_b64_tr_b16 a[96:97], v26 offset:0
    ds_read_b64_tr_b16 a[98:99], v26 offset:1024
    s_waitcnt vmcnt(8)
    v_xor_b32 v16, v8, v121
    v_xor_b32_e64 v17, v8, v123
    v_xor_b32_e64 v30, v8, v125
    v_xor_b32_e64 v31, v8, v127
    v_or3_b32 v16, v16, v30, v31
    v_cmp_ne_u64_e64 vcc, 0, v[16:17]
    s_nop 1
    s_cbranch_vccnz L_retry_17
L_ok_19:
    v_mfma_f32_32x32x16_bf16 v[64:79], a[48:51], v[96:99], v[64:79]
    ds_read_b128 a[224:227], v240 offset:24576
    ds_read_b128 v[104:107], v13 offset:12288
    s_xor_b32 m0, s74, 69632
    s_add_u32 s0, s76, s83
    buffer_load_dwordx4 v3, s[8:11], s0 offen offset:0 lds
    v_lshlrev_b32 v148, 16, v122
    v_mfma_f32_16x16x32_bf16 v[140:143], v[144:147], a[88:91], v[140:143]
    v_and_b32 v150, 0xffff0000, v122
    v_add_f32 v150, v150, v148
    s_waitcnt lgkmcnt(4)
    v_mfma_f32_32x32x16_bf16 v[48:63], a[92:95], a[220:223], v[48:63]
    ds_read_b64_tr_b16 a[100:101], v26 offset:4096
    ds_read_b64_tr_b16 a[102:103], v26 offset:5120
    v_rcp_f32 v148, v150
    v_mov_b32 v121, v120
    v_mov_b32_e64 v123, 0
    v_mfma_f32_32x32x16_bf16 v[64:79], a[52:55], v[100:103], v[64:79]
    ds_read_b128 a[228:231], v241 offset:24576
    ds_read_b128 v[108:111], v14 offset:12288
    buffer_load_dwordx4 v4, s[8:11], s0 offen offset:1024 lds
    v_mul_f32 v149, v148, v148
    v_mul_f32 v148, 0xc0135761, v148
    v_mul_f32 v149, v149, v148
    v_mfma_f32_16x16x32_bf16 v[140:143], v[144:147], a[92:95], v[140:143]
    v_mul_f32 v149, 0x3d372713, v149
    v_lshlrev_b32 v151, 16, v126
    s_waitcnt lgkmcnt(4)
    v_mfma_f32_32x32x16_bf16 v[48:63], a[96:99], a[224:227], v[48:63]
    ds_read_b64_tr_b16 a[104:105], v26 offset:8192
    ds_read_b64_tr_b16 a[106:107], v26 offset:9216
    v_and_b32 v153, 0xffff0000, v126
    v_add_f32 v153, v153, v151
    v_rcp_f32 v151, v153
    v_mfma_f32_32x32x16_bf16 v[64:79], a[56:59], v[104:107], v[64:79]
    ds_read_b128 a[232:235], v242 offset:24576
    ds_read_b128 v[80:83], v11 offset:16384
    buffer_load_dwordx4 v5, s[8:11], s0 offen offset:2048 lds
    v_mov_b32_e64 v125, v124
    v_mov_b32_e64 v127, 0
    v_mul_f32_e64 v152, v151, v151
    v_mfma_f32_16x16x32_bf16 v[140:143], v[144:147], a[96:99], v[140:143]
    v_mul_f32 v151, 0xc0135761, v151
    v_mul_f32 v152, v152, v151
    s_waitcnt lgkmcnt(4)
    v_mfma_f32_32x32x16_bf16 v[48:63], a[100:103], a[228:231], v[48:63]
    ds_read_b64_tr_b16 a[108:109], v26 offset:12288
    ds_read_b64_tr_b16 a[110:111], v26 offset:13312
    v_mul_f32 v152, 0x3d372713, v152
    s_cmp_lg_u32 s98, 0
    s_cselect_b32 s71, s79, s78
    s_cselect_b32 s79, s78, s79
    s_mov_b32 s78, s71
    v_mfma_f32_32x32x16_bf16 v[64:79], a[60:63], v[108:111], v[64:79]
    ds_read_b128 a[236:239], v243 offset:24576
    ds_read_b128 v[84:87], v12 offset:16384
    buffer_load_dwordx4 v6, s[8:11], s0 offen offset:3072 lds
    v_mfma_f32_16x16x32_bf16 v[140:143], v[144:147], a[100:103], v[140:143]
    s_add_u32 s0, s65, 2
    s_and_b32 s0, s0, 3
    s_lshl_b32 s0, s0, 9
    s_add_u32 s0, s0, s69
    buffer_load_dwordx4 v[128:131], v10, s[16:19], s0 offen sc1
    s_add_u32 s0, s65, 3
    s_and_b32 s0, s0, 3
    s_lshl_b32 s0, s0, 9
    s_add_u32 s0, s0, s69
    buffer_load_dwordx4 v[132:135], v10, s[16:19], s0 offen sc1
    s_waitcnt vmcnt(10)
    s_barrier
    s_waitcnt lgkmcnt(4)
    v_mfma_f32_32x32x16_bf16 v[48:63], a[104:107], a[232:235], v[48:63]
    ds_read_b64_tr_b16 a[112:113], v26 offset:16384
    ds_read_b64_tr_b16 a[114:115], v26 offset:17408
    v_mfma_f32_32x32x16_bf16 v[64:79], a[64:67], v[80:83], v[64:79]
    ds_read_b128 a[240:243], v240 offset:28672
    ds_read_b128 v[88:91], v13 offset:16384
    s_xor_b32 m0, s74, 98304
    s_add_u32 s0, s77, s82
    buffer_load_dwordx4 v3, s[8:11], s0 offen offset:0 lds
    v_mfma_f32_16x16x32_bf16 v[140:143], v[144:147], a[104:107], v[140:143]
    s_waitcnt lgkmcnt(4)
    v_mfma_f32_32x32x16_bf16 v[48:63], a[108:111], a[236:239], v[48:63]
    ds_read_b64_tr_b16 a[116:117], v26 offset:20480
    ds_read_b64_tr_b16 a[118:119], v26 offset:21504
    v_mfma_f32_32x32x16_bf16 v[64:79], a[68:71], v[84:87], v[64:79]
    ds_read_b128 a[244:247], v241 offset:28672
    ds_read_b128 v[92:95], v14 offset:16384
    buffer_load_dwordx4 v4, s[8:11], s0 offen offset:1024 lds
    v_mfma_f32_16x16x32_bf16 v[140:143], v[144:147], a[108:111], v[140:143]
    s_waitcnt lgkmcnt(4)
    v_mfma_f32_32x32x16_bf16 v[48:63], a[112:115], a[240:243], v[48:63]
    ds_read_b64_tr_b16 a[120:121], v26 offset:24576
    ds_read_b64_tr_b16 a[122:123], v26 offset:25600
    v_mfma_f32_32x32x16_bf16 v[64:79], a[72:75], v[88:91], v[64:79]
    ds_read_b128 a[248:251], v242 offset:28672
    ds_read_b128 v[96:99], v11 offset:20480
    buffer_load_dwordx4 v5, s[8:11], s0 offen offset:2048 lds
    v_mfma_f32_16x16x32_bf16 v[140:143], v[144:147], a[112:115], v[140:143]
    s_waitcnt lgkmcnt(4)
    v_mfma_f32_32x32x16_bf16 v[48:63], a[116:119], a[244:247], v[48:63]
    ds_read_b64_tr_b16 a[124:125], v26 offset:28672
    ds_read_b64_tr_b16 a[126:127], v26 offset:29696
    v_mfma_f32_32x32x16_bf16 v[64:79], a[76:79], v[92:95], v[64:79]
    ds_read_b128 a[252:255], v243 offset:28672
    ds_read_b128 v[100:103], v12 offset:20480
    buffer_load_dwordx4 v6, s[8:11], s0 offen offset:3072 lds
    v_mov_b32 v24, v27
    v_add_u32 v25, 7168, v24
L_pad_ffn_0:
    s_cbranch_execz L_pad_ffn_4
    v_add_u32 v26, 14336, v24
    v_mfma_f32_16x16x32_bf16 v[140:143], v[144:147], a[116:119], v[140:143]
    v_add_u32 v27, 21504, v24
    v_xor_b32 v25, 32, v25
    s_waitcnt lgkmcnt(0)
    v_mfma_f32_16x16x32_bf16 v[140:143], v[144:147], a[120:123], v[140:143]
    s_xor_b32 m0, s74, 102400
    s_add_u32 s0, s77, s83
    buffer_load_dwordx4 v3, s[8:11], s0 offen offset:0 lds
    v_mfma_f32_16x16x32_bf16 v[140:143], v[144:147], a[124:127], v[140:143]
    v_xor_b32 v27, 32, v27
    s_lshl_b32 s91, s66, 16
    v_mfma_f32_32x32x16_bf16 v[48:63], a[120:123], a[248:251], v[48:63]
    ds_read_b128 v[104:107], v13 offset:20480
    ds_read_b128 v[108:111], v14 offset:20480
    s_add_u32 s91, s91, s93
    s_add_u32 s91, s91, s67
    s_and_b32 s97, s98, 0x8000
    s_add_u32 s96, s97, 0x8000
    v_mfma_f32_32x32x16_bf16 v[48:63], a[124:127], a[252:255], v[48:63]
    ds_read_b128 v[80:83], v11 offset:24576
    ds_read_b128 v[84:87], v12 offset:24576
    buffer_load_dwordx4 v4, s[8:11], s0 offen offset:1024 lds
    v_cvt_pk_bf16_f32 v112, v140, v140
    v_lshlrev_b32 v17, 16, v112
    v_sub_f32 v16, v140, v17
    v_mfma_f32_32x32x16_bf16 v[64:79], a[80:83], v[96:99], v[64:79]
    ds_read_b128 v[88:91], v13 offset:24576
    ds_read_b128 v[92:95], v14 offset:24576
    v_cvt_pk_bf16_f32 v113, v16, v16
    buffer_load_dwordx4 v5, s[8:11], s0 offen offset:2048 lds
    buffer_load_dwordx4 v6, s[8:11], s0 offen offset:3072 lds
    v_mfma_f32_32x32x16_bf16 v[48:63], v[112:115], v[120:123], v[48:63]
    s_waitcnt vmcnt(8)
    v_xor_b32 v16, v8, v129
    v_xor_b32 v17, v8, v131
    v_xor_b32 v30, v8, v133
    v_xor_b32_e64 v31, v8, v135
    v_or3_b32 v16, v16, v30, v31
    v_cmp_ne_u64_e64 vcc, 0, v[16:17]
    s_nop 1
    s_cbranch_vccnz L_retry_20
L_ok_22:
    v_mfma_f32_32x32x16_bf16 v[64:79], a[84:87], v[100:103], v[64:79]
    ds_read_b128 v[96:99], v11 offset:28672
    v_min_u32 v30, 10, v0
    v_lshlrev_b32_e64 v30, 7, v30
    s_lshl2_add_u32 s1, s2, s3
    s_mul_i32 s0, s1, 1408
    buffer_load_dword v31, v30, s[20:23], s0 offen
    s_waitcnt lgkmcnt(5)
    v_mfma_f32_32x32x16_bf16 v[64:79], a[88:91], v[104:107], v[64:79]
    ds_read_b128 v[100:103], v12 offset:28672
    v_lshlrev_b32 v154, 16, v130
    v_and_b32 v156, 0xffff0000, v130
    v_add_f32 v156, v156, v154
    v_rcp_f32 v154, v156
    v_mfma_f32_32x32x16_bf16 v[64:79], a[92:95], v[108:111], v[64:79]
    ds_read_b128 v[104:107], v13 offset:28672
    v_min_u32 v30, 384, v30
    s_lshl_b32 s0, s1, 9
    buffer_load_dword v31, v30, s[24:27], s0 offen
    s_waitcnt lgkmcnt(5)
    v_mfma_f32_32x32x16_bf16 v[64:79], a[96:99], v[80:83], v[64:79]
    ds_read_b128 v[108:111], v14 offset:28672
    v_mov_b32 v129, v128
    v_mov_b32 v131, 0
    v_mul_f32 v155, v154, v154
    v_mul_f32 v154, 0xc0135761, v154
    v_mul_f32 v155, v155, v154
    v_mfma_f32_32x32x16_bf16 v[64:79], a[100:103], v[84:87], v[64:79]
    v_mul_f32 v155, 0x3d372713, v155
    v_lshlrev_b32 v157, 16, v134
    v_and_b32 v159, 0xffff0000, v134
    v_add_f32 v159, v159, v157
    v_rcp_f32 v157, v159
    s_waitcnt lgkmcnt(4)
    v_mfma_f32_32x32x16_bf16 v[64:79], a[104:107], v[88:91], v[64:79]
    v_mov_b32_e64 v133, v132
    v_mov_b32_e64 v135, 0
    v_mul_f32_e64 v158, v157, v157
    v_mul_f32 v157, 0xc0135761, v157
    v_mul_f32_e64 v158, v158, v157
    v_mul_f32 v158, 0x3d372713, v158
    v_mfma_f32_32x32x16_bf16 v[64:79], a[108:111], v[92:95], v[64:79]
    v_cndmask_b32 v136, v128, v132, s[98:99]
    v_cndmask_b32 v137, v129, v133, s[98:99]
    v_cndmask_b32 v138, v130, v134, s[98:99]
    v_mov_b32 v139, 0
    s_and_b32 s70, s98, 0x100
    s_add_u32 s70, s70, 2097152
    s_waitcnt lgkmcnt(2)
    v_mfma_f32_32x32x16_bf16 v[64:79], a[112:115], v[96:99], v[64:79]
    v_and_b32 v29, 0xf0, v1
    v_and_b32 v16, 0x30, v0
    v_lshl_add_u32 v16, v16, 5, s70
    v_add_u32 v29, v29, v16
    s_lshl_b32 s71, s94, 11
    s_add_u32 s71, s71, s78
    v_mfma_f32_32x32x16_bf16 v[64:79], a[116:119], v[100:103], v[64:79]
    v_mul_f32_e64 v164, v48, v48
    v_mul_f32_e64 v165, v49, v49
    v_mul_f32_e64 v166, v50, v50
    v_mul_f32 v167, v51, v51
    v_fma_f32 v164, v164, v149, v148
    v_fma_f32 v165, v165, v149, v148
    s_waitcnt lgkmcnt(0)
    v_mfma_f32_32x32x16_bf16 v[64:79], a[120:123], v[104:107], v[64:79]
    v_fma_f32 v166, v166, v149, v148
    v_fma_f32 v167, v167, v149, v148
    v_mul_f32 v164, v48, v164
    v_mul_f32 v165, v49, v165
    v_mul_f32 v166, v50, v166
    v_mul_f32 v167, v51, v167
    v_mfma_f32_32x32x16_bf16 v[64:79], a[124:127], v[108:111], v[64:79]
    v_exp_f32 v164, v164
    v_exp_f32 v165, v165
    v_exp_f32 v166, v166
    v_mfma_f32_32x32x16_bf16 v[64:79], v[112:115], v[124:127], v[64:79]
    v_exp_f32 v167, v167
    v_fma_f32 v164, v164, v150, v150
    v_fma_f32 v165, v165, v150, v150
    v_fma_f32 v166, v166, v150, v150
    v_fma_f32 v167, v167, v150, v150
    s_barrier
    v_add_u32 v11, s96, v11
    v_add_u32_e64 v12, s96, v12
    v_add_u32_e64 v13, s96, v13
    v_add_u32_e64 v14, s96, v14
    ds_read_b128 v[80:83], v11 offset:0
    ds_read_b128 v[84:87], v12 offset:0
    ds_read_b128 v[88:91], v13 offset:0
    ds_read_b128 v[92:95], v14 offset:0
    ds_read_b128 v[96:99], v11 offset:4096
    ds_read_b128 v[100:103], v12 offset:4096
    ds_read_b128 v[104:107], v13 offset:4096
    s_add_u32 m0, s85, 131072
    s_nop 0
    buffer_load_dwordx4 v20, s[36:39], s84 offen offset:0 lds
    v_mfma_f32_32x32x16_bf16 v[224:239], v[112:115], v[128:131], 0
    v_rcp_f32 v164, v164
    v_rcp_f32 v165, v165
    v_rcp_f32 v166, v166
    v_rcp_f32 v167, v167
    v_mul_f32 v164, v48, v164
    v_mul_f32 v165, v49, v165
    v_mul_f32 v166, v50, v166
    v_mul_f32_e64 v167, v51, v167
    v_cvt_pk_bf16_f32 v168, v164, v165
    buffer_load_dwordx4 v21, s[36:39], s84 offen offset:1024 lds
    v_cvt_pk_bf16_f32 v169, v166, v167
    v_mul_f32 v164, v52, v52
    v_mul_f32 v165, v53, v53
    v_mul_f32 v166, v54, v54
    v_mul_f32 v167, v55, v55
    v_fma_f32 v164, v164, v149, v148
    v_fma_f32 v165, v165, v149, v148
    v_fma_f32 v166, v166, v149, v148
    v_fma_f32 v167, v167, v149, v148
    s_waitcnt lgkmcnt(3)
    v_mfma_f32_32x32x16_bf16 v[224:239], a[0:3], v[80:83], v[224:239]
    ds_read_b128 v[108:111], v14 offset:4096
    v_mul_f32 v164, v52, v164
    v_mul_f32 v165, v53, v165
    v_mul_f32 v166, v54, v166
    v_mul_f32 v167, v55, v167
    v_exp_f32 v164, v164
    v_mfma_f32_32x32x16_bf16 v[224:239], a[4:7], v[84:87], v[224:239]
    ds_read_b128 v[80:83], v11 offset:8192
    v_exp_f32 v165, v165
    v_exp_f32 v166, v166
    v_exp_f32_e64 v167, v167
    v_mfma_f32_32x32x16_bf16 v[224:239], a[8:11], v[88:91], v[224:239]
    ds_read_b128 v[84:87], v12 offset:8192
    v_fma_f32 v164, v164, v150, v150
    v_fma_f32 v165, v165, v150, v150
    v_fma_f32 v166, v166, v150, v150
    v_fma_f32 v167, v167, v150, v150
    v_rcp_f32_e64 v164, v164
    v_mfma_f32_32x32x16_bf16 v[224:239], a[12:15], v[92:95], v[224:239]
    ds_read_b128 v[88:91], v13 offset:8192
    v_rcp_f32_e64 v165, v165
    v_rcp_f32_e64 v166, v166
    v_rcp_f32 v167, v167
    s_add_u32 m0, s85, 139264
    s_add_u32 s84, s84, 196608
    s_cmp_eq_u32 s84, 1572864
    s_cselect_b32 s84, 0, s84
    buffer_load_dwordx4 v20, s[36:39], s84 offen offset:0 lds
    v_mul_f32 v164, v52, v164
    v_mul_f32 v165, v53, v165
    v_mul_f32 v166, v54, v166
    v_mul_f32 v167, v55, v167
    v_cvt_pk_bf16_f32 v170, v164, v165
    v_cvt_pk_bf16_f32 v171, v166, v167
    buffer_store_dwordx4 v[168:171], v1, s[16:19], s71 offen offset:0 sc1
    v_mul_f32 v164, v56, v56
    v_mul_f32 v165, v57, v57
    v_mul_f32_e64 v166, v58, v58
    v_mul_f32 v167, v59, v59
    v_fma_f32 v164, v164, v149, v148
    v_fma_f32 v165, v165, v149, v148
    v_fma_f32 v166, v166, v149, v148
    s_waitcnt lgkmcnt(3)
    v_mfma_f32_32x32x16_bf16 v[224:239], a[16:19], v[96:99], v[224:239]
    ds_read_b128 v[92:95], v14 offset:8192
    v_fma_f32 v167, v167, v149, v148
    v_mul_f32 v164, v56, v164
    v_mul_f32 v165, v57, v165
    v_mul_f32 v166, v58, v166
    v_mul_f32 v167, v59, v167
    v_exp_f32 v164, v164
    v_exp_f32 v165, v165
    v_mfma_f32_32x32x16_bf16 v[224:239], a[20:23], v[100:103], v[224:239]
    ds_read_b128 v[96:99], v11 offset:12288
    buffer_load_dwordx4 v21, s[36:39], s84 offen offset:1024 lds
    v_exp_f32 v166, v166
    v_exp_f32 v167, v167
    v_mfma_f32_32x32x16_bf16 v[224:239], a[24:27], v[104:107], v[224:239]
    ds_read_b128 v[100:103], v12 offset:12288
    v_fma_f32 v164, v164, v150, v150
    v_fma_f32 v165, v165, v150, v150
    v_fma_f32 v166, v166, v150, v150
    v_fma_f32 v167, v167, v150, v150
    v_rcp_f32 v164, v164
    v_rcp_f32 v165, v165
    v_rcp_f32_e64 v166, v166
    v_rcp_f32_e64 v167, v167
    v_mfma_f32_32x32x16_bf16 v[224:239], a[28:31], v[108:111], v[224:239]
    ds_read_b128 v[104:107], v13 offset:12288
    s_add_u32 m0, s85, 147456
    s_add_u32 s84, s84, 196608
    s_cmp_eq_u32 s84, 1572864
    s_cselect_b32 s84, 0, s84
    buffer_load_dwordx4 v20, s[36:39], s84 offen offset:0 lds
    v_mul_f32 v164, v56, v164
    v_mul_f32_e64 v165, v57, v165
    v_mul_f32_e64 v166, v58, v166
    v_mul_f32 v167, v59, v167
    v_cvt_pk_bf16_f32 v172, v164, v165
    v_cvt_pk_bf16_f32 v173, v166, v167
    s_waitcnt lgkmcnt(3)
    v_mfma_f32_32x32x16_bf16 v[224:239], a[32:35], v[80:83], v[224:239]
    ds_read_b128 v[108:111], v14 offset:12288
    v_mul_f32 v164, v60, v60
    v_mul_f32 v165, v61, v61
    v_mul_f32 v166, v62, v62
    v_mul_f32 v167, v63, v63
    v_fma_f32 v164, v164, v149, v148
    v_mfma_f32_32x32x16_bf16 v[224:239], a[36:39], v[84:87], v[224:239]
    ds_read_b128 v[80:83], v11 offset:16384
    buffer_load_dwordx4 v21, s[36:39], s84 offen offset:1024 lds
    v_fma_f32 v165, v165, v149, v148
    v_fma_f32 v166, v166, v149, v148
    v_fma_f32 v167, v167, v149, v148
    v_mul_f32_e64 v164, v60, v164
    v_mfma_f32_32x32x16_bf16 v[224:239], a[40:43], v[88:91], v[224:239]
    ds_read_b128 v[84:87], v12 offset:16384
    v_mul_f32 v165, v61, v165
    v_mul_f32 v166, v62, v166
    v_mul_f32 v167, v63, v167
    v_exp_f32 v164, v164
    v_exp_f32_e64 v165, v165
    v_mfma_f32_32x32x16_bf16 v[224:239], a[44:47], v[92:95], v[224:239]
    ds_read_b128 v[88:91], v13 offset:16384
    s_add_u32 m0, s85, 155648
    s_add_u32 s84, s84, 196608
    s_cmp_eq_u32 s84, 1572864
    s_cselect_b32 s84, 0, s84
    buffer_load_dwordx4 v20, s[36:39], s84 offen offset:0 lds
    v_exp_f32 v166, v166
    v_exp_f32_e64 v167, v167
    v_fma_f32 v164, v164, v150, v150
    v_fma_f32 v165, v165, v150, v150
    v_fma_f32 v166, v166, v150, v150
    v_fma_f32 v167, v167, v150, v150
    s_waitcnt lgkmcnt(3)
    v_mfma_f32_32x32x16_bf16 v[224:239], a[48:51], v[96:99], v[224:239]
    ds_read_b128 v[92:95], v14 offset:16384
    v_rcp_f32 v164, v164
    v_rcp_f32 v165, v165
    v_rcp_f32 v166, v166
    v_mfma_f32_32x32x16_bf16 v[224:239], a[52:55], v[100:103], v[224:239]
    ds_read_b128 v[96:99], v11 offset:20480
    buffer_load_dwordx4 v21, s[36:39], s84 offen offset:1024 lds
    v_rcp_f32 v167, v167
    v_mul_f32 v164, v60, v164
    v_mul_f32 v165, v61, v165
    v_mul_f32 v166, v62, v166
    v_mul_f32_e64 v167, v63, v167
    v_cvt_pk_bf16_f32 v174, v164, v165
    v_cvt_pk_bf16_f32 v175, v166, v167
    buffer_store_dwordx4 v[172:175], v1, s[16:19], s71 offen offset:1024 sc1
    v_mfma_f32_32x32x16_bf16 v[224:239], a[56:59], v[104:107], v[224:239]
    ds_read_b128 v[100:103], v12 offset:20480
    s_lshl_b32 s71, s94, 11
    s_add_u32 s71, s71, s79
    v_mul_f32 v164, v64, v64
    v_mul_f32 v165, v65, v65
    v_mul_f32 v166, v66, v66
    v_mul_f32_e64 v167, v67, v67
    v_fma_f32 v164, v164, v152, v151
    v_fma_f32 v165, v165, v152, v151
    v_mfma_f32_32x32x16_bf16 v[224:239], a[60:63], v[108:111], v[224:239]
    ds_read_b128 v[104:107], v13 offset:20480
    s_add_u32 m0, s85, 0
    s_add_u32 s84, s84, 196608
    s_cmp_eq_u32 s84, 1572864
    s_cselect_b32 s84, 0, s84
    buffer_load_dwordx4 v20, s[36:39], s84 offen offset:0 lds
    s_waitcnt lgkmcnt(3)
    v_mfma_f32_32x32x16_bf16 v[224:239], a[64:67], v[80:83], v[224:239]
    ds_read_b128 v[108:111], v14 offset:20480
    v_fma_f32 v166, v166, v152, v151
    v_fma_f32 v167, v167, v152, v151
    v_mul_f32 v164, v64, v164
    v_mul_f32 v165, v65, v165
    v_mul_f32_e64 v166, v66, v166
    v_mul_f32_e64 v167, v67, v167
    v_exp_f32_e64 v164, v164
    v_mfma_f32_32x32x16_bf16 v[224:239], a[68:71], v[84:87], v[224:239]
    ds_read_b128 v[80:83], v11 offset:24576
    buffer_load_dwordx4 v21, s[36:39], s84 offen offset:1024 lds
    v_exp_f32_e64 v165, v165
    v_exp_f32_e64 v166, v166
    v_exp_f32_e64 v167, v167
    v_fma_f32 v164, v164, v153, v153
    v_fma_f32 v165, v165, v153, v153
    v_mfma_f32_32x32x16_bf16 v[224:239], a[72:75], v[88:91], v[224:239]
    ds_read_b128 v[84:87], v12 offset:24576
    s_add_u32 m0, s85, 8192
    s_add_u32 s84, s84, 196608
    s_cmp_eq_u32 s84, 1572864
    s_cselect_b32 s84, 0, s84
    buffer_load_dwordx4 v20, s[36:39], s84 offen offset:0 lds
    v_fma_f32 v166, v166, v153, v153
    v_fma_f32 v167, v167, v153, v153
    v_rcp_f32 v164, v164
    v_rcp_f32 v165, v165
    v_rcp_f32 v166, v166
    v_mfma_f32_32x32x16_bf16 v[224:239], a[76:79], v[92:95], v[224:239]
    ds_read_b128 v[88:91], v13 offset:24576
    v_rcp_f32 v167, v167
    v_mul_f32 v164, v64, v164
    v_mul_f32 v165, v65, v165
    v_mul_f32_e64 v166, v66, v166
    s_waitcnt lgkmcnt(3)
    v_mfma_f32_32x32x16_bf16 v[224:239], a[80:83], v[96:99], v[224:239]
    ds_read_b128 v[92:95], v14 offset:24576
    buffer_load_dwordx4 v21, s[36:39], s84 offen offset:1024 lds
    v_mul_f32_e64 v167, v67, v167
    v_cvt_pk_bf16_f32 v168, v164, v165
    v_cvt_pk_bf16_f32 v169, v166, v167
    v_mul_f32_e64 v164, v68, v68
    v_mul_f32_e64 v165, v69, v69
    v_mul_f32_e64 v166, v70, v70
    v_mul_f32_e64 v167, v71, v71
    v_fma_f32 v164, v164, v152, v151
    v_fma_f32 v165, v165, v152, v151
    v_fma_f32 v166, v166, v152, v151
    v_mfma_f32_32x32x16_bf16 v[224:239], a[84:87], v[100:103], v[224:239]
    ds_read_b128 v[96:99], v11 offset:28672
    s_add_u32 m0, s85, 16384
    s_add_u32 s84, s84, 196608
    s_cmp_eq_u32 s84, 1572864
    s_cselect_b32 s84, 0, s84
    buffer_load_dwordx4 v20, s[36:39], s84 offen offset:0 lds
    v_fma_f32 v167, v167, v152, v151
    v_mul_f32 v164, v68, v164
    v_mul_f32 v165, v69, v165
    v_mul_f32 v166, v70, v166
    v_mul_f32_e64 v167, v71, v167
    v_exp_f32_e64 v164, v164
    v_exp_f32_e64 v165, v165
    v_mfma_f32_32x32x16_bf16 v[224:239], a[88:91], v[104:107], v[224:239]
    ds_read_b128 v[100:103], v12 offset:28672
    v_exp_f32_e64 v166, v166
    v_exp_f32_e64 v167, v167
    v_fma_f32 v164, v164, v153, v153
    v_mfma_f32_32x32x16_bf16 v[224:239], a[92:95], v[108:111], v[224:239]
    ds_read_b128 v[104:107], v13 offset:28672
    buffer_load_dwordx4 v21, s[36:39], s84 offen offset:1024 lds
    v_fma_f32 v165, v165, v153, v153
    v_fma_f32 v166, v166, v153, v153
    v_fma_f32 v167, v167, v153, v153
    v_rcp_f32 v164, v164
    s_waitcnt lgkmcnt(3)
    v_mfma_f32_32x32x16_bf16 v[224:239], a[96:99], v[80:83], v[224:239]
    ds_read_b128 v[108:111], v14 offset:28672
    s_add_u32 m0, s85, 24576
    s_add_u32 s84, s84, 196608
    s_cmp_eq_u32 s84, 1572864
    s_cselect_b32 s84, 0, s84
    buffer_load_dwordx4 v20, s[36:39], s84 offen offset:0 lds
    v_rcp_f32 v165, v165
    v_rcp_f32 v166, v166
    v_rcp_f32 v167, v167
    s_waitcnt vmcnt(19)
    s_barrier
    v_mfma_f32_32x32x16_bf16 v[224:239], a[100:103], v[84:87], v[224:239]
    ds_read_b128 v[80:83], v11 offset:32768
    buffer_load_dwordx4 v21, s[36:39], s84 offen offset:1024 lds
    s_lshr_b32 s70, s3, 1
    s_lshl1_add_u32 s70, s66, s70
    s_xor_b32 s96, s70, 1
    s_mul_i32 s70, s70, 120832
    s_mul_i32 s96, s96, 120832
    v_add_u32 v3, s70, v29
    v_add_u32_e64 v5, s96, v29
    v_xor_b32 v4, 0x100, v3
    v_xor_b32 v6, 0x100, v5
    v_mul_f32 v164, v68, v164
    v_mul_f32 v165, v69, v165
    v_mul_f32 v166, v70, v166
    v_mul_f32 v167, v71, v167
    v_cvt_pk_bf16_f32 v170, v164, v165
    v_cvt_pk_bf16_f32 v171, v166, v167
    v_mfma_f32_32x32x16_bf16 v[224:239], a[104:107], v[88:91], v[224:239]
    ds_read_b128 v[84:87], v12 offset:32768
    buffer_store_dwordx4 v[168:171], v1, s[16:19], s71 offen offset:0 sc1
    v_mul_f32 v164, v72, v72
    v_mul_f32 v165, v73, v73
    v_mul_f32 v166, v74, v74
    v_mul_f32 v167, v75, v75
    v_mfma_f32_32x32x16_bf16 v[224:239], a[108:111], v[92:95], v[224:239]
    ds_read_b128 v[88:91], v13 offset:32768
    v_fma_f32 v164, v164, v152, v151
    v_fma_f32 v165, v165, v152, v151
    v_fma_f32 v166, v166, v152, v151
    v_fma_f32 v167, v167, v152, v151
    v_mul_f32 v164, v72, v164
    v_mul_f32 v165, v73, v165
    v_mul_f32 v166, v74, v166
    v_mul_f32 v167, v75, v167
    v_exp_f32 v164, v164
    v_exp_f32 v165, v165
    s_waitcnt lgkmcnt(3)
    v_mfma_f32_32x32x16_bf16 v[224:239], a[112:115], v[96:99], v[224:239]
    ds_read_b128 v[92:95], v14 offset:32768
    buffer_load_dwordx4 v[36:39], v7, s[8:11], s91 offen
    v_exp_f32 v166, v166
    v_exp_f32_e64 v167, v167
    v_fma_f32 v164, v164, v153, v153
    v_fma_f32 v165, v165, v153, v153
    v_fma_f32 v166, v166, v153, v153
    v_mfma_f32_32x32x16_bf16 v[224:239], a[116:119], v[100:103], v[224:239]
    ds_read_b128 v[96:99], v11 offset:36864
    v_fma_f32 v167, v167, v153, v153
    v_rcp_f32 v164, v164
    v_rcp_f32 v165, v165
    v_mfma_f32_32x32x16_bf16 v[224:239], a[120:123], v[104:107], v[224:239]
    ds_read_b128 v[100:103], v12 offset:36864
    s_add_u32 s0, s91, 0x2000
    buffer_load_dwordx4 v[40:43], v7, s[8:11], s0 offen
    v_rcp_f32 v166, v166
    v_rcp_f32 v167, v167
    v_mfma_f32_32x32x16_bf16 v[224:239], a[124:127], v[108:111], v[224:239]
    ds_read_b128 v[104:107], v13 offset:36864
    v_mul_f32 v164, v72, v164
    v_mul_f32 v165, v73, v165
    v_mul_f32 v166, v74, v166
    v_mul_f32 v167, v75, v167
    v_cvt_pk_bf16_f32 v172, v164, v165
    v_mfma_f32_32x32x16_bf16 v[48:63], v[112:115], v[132:135], 0
    v_cvt_pk_bf16_f32 v173, v166, v167
    v_mul_f32 v164, v76, v76
    v_mul_f32 v165, v77, v77
    v_mul_f32_e64 v166, v78, v78
    v_mul_f32_e64 v167, v79, v79
    v_fma_f32 v164, v164, v152, v151
    s_waitcnt lgkmcnt(3)
    v_mfma_f32_32x32x16_bf16 v[48:63], a[0:3], v[80:83], v[48:63]
    ds_read_b128 v[108:111], v14 offset:36864
    s_add_u32 m0, s92, 32768
    s_lshl4_add_u32 s1, s86, s67
    buffer_load_dwordx4 v24, s[20:23], s1 offen offset:0 lds
    v_fma_f32 v165, v165, v152, v151
    v_fma_f32 v166, v166, v152, v151
    v_mfma_f32_32x32x16_bf16 v[48:63], a[4:7], v[84:87], v[48:63]
    ds_read_b128 v[80:83], v11 offset:40960
    v_fma_f32 v167, v167, v152, v151
    v_mul_f32 v164, v76, v164
    v_mul_f32 v165, v77, v165
    v_mul_f32 v166, v78, v166
    v_mul_f32 v167, v79, v167
    v_mfma_f32_32x32x16_bf16 v[48:63], a[8:11], v[88:91], v[48:63]
    ds_read_b128 v[84:87], v12 offset:40960
    v_exp_f32 v164, v164
    v_exp_f32 v165, v165
    v_exp_f32_e64 v166, v166
    v_mfma_f32_32x32x16_bf16 v[48:63], a[12:15], v[92:95], v[48:63]
    ds_read_b128 v[88:91], v13 offset:40960
    buffer_load_dwordx4 v25, s[20:23], s1 offen offset:1024 lds
    v_exp_f32_e64 v167, v167
    v_fma_f32 v164, v164, v153, v153
    v_fma_f32 v165, v165, v153, v153
    v_fma_f32 v166, v166, v153, v153
    v_fma_f32 v167, v167, v153, v153
    v_rcp_f32 v164, v164
    s_waitcnt lgkmcnt(3)
    v_mfma_f32_32x32x16_bf16 v[48:63], a[16:19], v[96:99], v[48:63]
    ds_read_b128 v[92:95], v14 offset:40960
    v_rcp_f32 v165, v165
    v_rcp_f32 v166, v166
    v_rcp_f32_e64 v167, v167
    v_mfma_f32_32x32x16_bf16 v[48:63], a[20:23], v[100:103], v[48:63]
    ds_read_b128 v[96:99], v11 offset:45056
    buffer_load_dwordx4 v26, s[20:23], s1 offen offset:2048 lds
    v_mul_f32_e64 v164, v76, v164
    v_mul_f32_e64 v165, v77, v165
    v_mul_f32_e64 v166, v78, v166
    v_mul_f32_e64 v167, v79, v167
    v_mfma_f32_32x32x16_bf16 v[48:63], a[24:27], v[104:107], v[48:63]
    ds_read_b128 v[100:103], v12 offset:45056
    v_cvt_pk_bf16_f32 v174, v164, v165
    v_cvt_pk_bf16_f32 v175, v166, v167
    v_mfma_f32_32x32x16_bf16 v[48:63], a[28:31], v[108:111], v[48:63]
    ds_read_b128 v[104:107], v13 offset:45056
    buffer_store_dwordx4 v[172:175], v1, s[16:19], s71 offen offset:1024 sc1
    s_waitcnt vmcnt(7)
    s_barrier
    s_lshl_b32 s71, s94, 11
    s_add_u32 s71, s71, s80
    s_waitcnt lgkmcnt(3)
    v_mfma_f32_32x32x16_bf16 v[48:63], a[32:35], v[80:83], v[48:63]
    ds_read_b128 v[108:111], v14 offset:45056
    ds_read_b64_tr_b16 a[0:1], v15 offset:0
    ds_read_b64_tr_b16 a[2:3], v15 offset:512
    ds_read_b64_tr_b16 a[4:5], v15 offset:2048
    v_mul_f32 v164, v224, v224
    v_mul_f32_e64 v165, v225, v225
    v_mfma_f32_32x32x16_bf16 v[48:63], a[36:39], v[84:87], v[48:63]
    ds_read_b128 v[80:83], v11 offset:49152
    ds_read_b64_tr_b16 a[6:7], v15 offset:2560
    ds_read_b64_tr_b16 a[8:9], v15 offset:4096
    ds_read_b64_tr_b16 a[10:11], v15 offset:4608
    buffer_load_dwordx4 v27, s[20:23], s1 offen offset:3072 lds
    v_mul_f32_e64 v166, v226, v226
    v_mfma_f32_32x32x16_bf16 v[48:63], a[40:43], v[88:91], v[48:63]
    ds_read_b128 v[84:87], v12 offset:49152
    ds_read_b64_tr_b16 a[12:13], v15 offset:6144
    ds_read_b64_tr_b16 a[14:15], v15 offset:6656
    ds_read_b64_tr_b16 a[16:17], v15 offset:8192
    v_mul_f32_e64 v167, v227, v227
    v_fma_f32 v164, v164, v155, v154
    v_mfma_f32_32x32x16_bf16 v[48:63], a[44:47], v[92:95], v[48:63]
    ds_read_b128 v[88:91], v13 offset:49152
    ds_read_b64_tr_b16 a[18:19], v15 offset:8704
    ds_read_b64_tr_b16 a[20:21], v15 offset:10240
    ds_read_b64_tr_b16 a[22:23], v15 offset:10752
    v_fma_f32 v165, v165, v155, v154
    v_fma_f32 v166, v166, v155, v154
    s_add_u32 m0, s92, 36864
    s_add_u32 s1, s1, 0x8000
    buffer_load_dwordx4 v24, s[20:23], s1 offen offset:0 lds
    s_waitcnt lgkmcnt(15)
    v_mfma_f32_32x32x16_bf16 v[48:63], a[48:51], v[96:99], v[48:63]
    ds_read_b128 v[92:95], v14 offset:49152
    ds_read_b64_tr_b16 a[24:25], v15 offset:12288
    ds_read_b64_tr_b16 a[26:27], v15 offset:12800
    ds_read_b64_tr_b16 a[28:29], v15 offset:14336
    v_fma_f32 v167, v167, v155, v154
    v_mul_f32 v164, v224, v164
    v_mfma_f32_32x32x16_bf16 v[48:63], a[52:55], v[100:103], v[48:63]
    ds_read_b128 v[96:99], v11 offset:53248
    ds_read_b64_tr_b16 a[30:31], v15 offset:14848
    ds_read_b64_tr_b16 a[32:33], v15 offset:16384
    ds_read_b64_tr_b16 a[34:35], v15 offset:16896
    v_mul_f32 v165, v225, v165
    v_mul_f32 v166, v226, v166
    s_waitcnt lgkmcnt(13)
    v_mul_f32 v167, v227, v167
    v_exp_f32_e64 v164, v164
    v_mfma_f32_32x32x16_bf16 v[48:63], a[56:59], v[104:107], v[48:63]
    ds_read_b128 v[100:103], v12 offset:53248
    ds_read_b64_tr_b16 a[36:37], v15 offset:18432
    ds_read_b64_tr_b16 a[38:39], v15 offset:18944
    ds_read_b64_tr_b16 a[40:41], v15 offset:20480
    buffer_load_dwordx4 v25, s[20:23], s1 offen offset:1024 lds
    v_exp_f32 v165, v165
    v_exp_f32 v166, v166
    v_exp_f32_e64 v167, v167
    v_fma_f32 v164, v164, v156, v156
    v_fma_f32 v165, v165, v156, v156
    v_mfma_f32_32x32x16_bf16 v[48:63], a[60:63], v[108:111], v[48:63]
    ds_read_b128 v[104:107], v13 offset:53248
    ds_read_b64_tr_b16 a[42:43], v15 offset:20992
    ds_read_b64_tr_b16 a[44:45], v15 offset:22528
    ds_read_b64_tr_b16 a[46:47], v15 offset:23040
    v_fma_f32 v166, v166, v156, v156
    v_fma_f32 v167, v167, v156, v156
    s_waitcnt lgkmcnt(15)
    v_mfma_f32_32x32x16_bf16 v[48:63], a[64:67], v[80:83], v[48:63]
    ds_read_b128 v[108:111], v14 offset:53248
    ds_read_b64_tr_b16 a[48:49], v15 offset:24576
    ds_read_b64_tr_b16 a[50:51], v15 offset:25088
    ds_read_b64_tr_b16 a[52:53], v15 offset:26624
    buffer_load_dwordx4 v26, s[20:23], s1 offen offset:2048 lds
    v_rcp_f32 v164, v164
    v_rcp_f32 v165, v165
    v_rcp_f32 v166, v166
    v_mfma_f32_32x32x16_bf16 v[48:63], a[68:71], v[84:87], v[48:63]
    ds_read_b128 v[80:83], v11 offset:57344
    ds_read_b64_tr_b16 a[54:55], v15 offset:27136
    ds_read_b64_tr_b16 a[56:57], v15 offset:28672
    ds_read_b64_tr_b16 a[58:59], v15 offset:29184
    v_rcp_f32 v167, v167
    v_mul_f32 v164, v224, v164
    v_mul_f32 v165, v225, v165
    v_mul_f32 v166, v226, v166
    v_mul_f32_e64 v167, v227, v167
    v_cvt_pk_bf16_f32 v168, v164, v165
    v_mfma_f32_32x32x16_bf16 v[48:63], a[72:75], v[88:91], v[48:63]
    ds_read_b128 v[84:87], v12 offset:57344
    ds_read_b64_tr_b16 a[60:61], v15 offset:30720
L_pad_ffn_1:
    s_cbranch_execz L_ret_ffn
    ds_read_b64_tr_b16 a[62:63], v15 offset:31232
    buffer_load_dwordx4 v27, s[20:23], s1 offen offset:3072 lds
    v_subrev_u32 v15, 131072, v15
    v_cvt_pk_bf16_f32 v169, v166, v167
    v_mul_f32 v164, v228, v228
    v_mul_f32 v165, v229, v229
    v_mul_f32 v166, v230, v230
    v_mul_f32_e64 v167, v231, v231
    v_fma_f32 v164, v164, v155, v154
    v_fma_f32 v165, v165, v155, v154
    v_fma_f32 v166, v166, v155, v154
    v_mfma_f32_32x32x16_bf16 v[48:63], a[76:79], v[92:95], v[48:63]
    ds_read_b128 v[88:91], v13 offset:57344
    ds_read_b64_tr_b16 a[64:65], v15 offset:0
    ds_read_b64_tr_b16 a[66:67], v15 offset:512
    ds_read_b64_tr_b16 a[68:69], v15 offset:2048
    v_fma_f32 v167, v167, v155, v154
    v_mul_f32 v164, v228, v164
    s_waitcnt lgkmcnt(14)
    v_mfma_f32_32x32x16_bf16 v[48:63], a[80:83], v[96:99], v[48:63]
    ds_read_b128 v[92:95], v14 offset:57344
    ds_read_b64_tr_b16 a[70:71], v15 offset:2560
    ds_read_b64_tr_b16 a[72:73], v15 offset:4096
    ds_read_b64_tr_b16 a[74:75], v15 offset:4608
    v_mul_f32 v165, v229, v165
    v_mul_f32 v166, v230, v166
    v_mul_f32 v167, v231, v167
    v_exp_f32 v164, v164
    v_exp_f32_e64 v165, v165
    v_mfma_f32_32x32x16_bf16 v[48:63], a[84:87], v[100:103], v[48:63]
    ds_read_b128 v[96:99], v11 offset:61440
    ds_read_b64_tr_b16 a[76:77], v15 offset:6144
    ds_read_b64_tr_b16 a[78:79], v15 offset:6656
    s_waitcnt lgkmcnt(11)
    s_barrier
    s_add_u32 m0, s92, 131072
    s_add_u32 s1, s1, 0x8000
    buffer_load_dwordx4 v24, s[20:23], s1 offen offset:0 lds
    v_exp_f32 v166, v166
    v_exp_f32 v167, v167
    v_fma_f32 v164, v164, v156, v156
    v_fma_f32 v165, v165, v156, v156
    v_fma_f32 v166, v166, v156, v156
    v_mfma_f32_32x32x16_bf16 v[48:63], a[88:91], v[104:107], v[48:63]
    ds_read_b128 v[100:103], v12 offset:61440
    ds_read_b64_tr_b16 a[80:81], v15 offset:8192
    ds_read_b64_tr_b16 a[82:83], v15 offset:8704
    ds_read_b64_tr_b16 a[84:85], v15 offset:10240
    v_fma_f32 v167, v167, v156, v156
    v_rcp_f32_e64 v164, v164
    v_mfma_f32_32x32x16_bf16 v[48:63], a[92:95], v[108:111], v[48:63]
    ds_read_b128 v[104:107], v13 offset:61440
    ds_read_b64_tr_b16 a[86:87], v15 offset:10752
    ds_read_b64_tr_b16 a[88:89], v15 offset:12288
    ds_read_b64_tr_b16 a[90:91], v15 offset:12800
    buffer_load_dwordx4 v25, s[20:23], s1 offen offset:1024 lds
    v_rcp_f32 v165, v165
    v_rcp_f32 v166, v166
    v_rcp_f32 v167, v167
    s_waitcnt lgkmcnt(14)
    v_mfma_f32_32x32x16_bf16 v[48:63], a[96:99], v[80:83], v[48:63]
    ds_read_b128 v[108:111], v14 offset:61440
    ds_read_b64_tr_b16 a[92:93], v15 offset:14336
    ds_read_b64_tr_b16 a[94:95], v15 offset:14848
    ds_read_b64_tr_b16 a[96:97], v15 offset:16384
    v_mul_f32 v164, v228, v164
    v_mul_f32 v165, v229, v165
    v_mul_f32 v166, v230, v166
    v_mul_f32 v167, v231, v167
    v_cvt_pk_bf16_f32 v170, v164, v165
    v_cvt_pk_bf16_f32 v171, v166, v167
    v_mfma_f32_32x32x16_bf16 v[48:63], a[100:103], v[84:87], v[48:63]
    ds_read_b64_tr_b16 a[98:99], v15 offset:16896
    ds_read_b64_tr_b16 a[100:101], v15 offset:18432
    ds_read_b64_tr_b16 a[102:103], v15 offset:18944
    buffer_store_dwordx4 v[168:171], v1, s[16:19], s71 offen offset:0 sc1
    v_mul_f32 v164, v232, v232
    v_mul_f32 v165, v233, v233
    v_mul_f32 v166, v234, v234
    v_mul_f32 v167, v235, v235
    v_fma_f32 v164, v164, v155, v154
    v_fma_f32 v165, v165, v155, v154
    v_fma_f32 v166, v166, v155, v154
    v_mfma_f32_32x32x16_bf16 v[48:63], a[104:107], v[88:91], v[48:63]
    ds_read_b64_tr_b16 a[104:105], v15 offset:20480
    ds_read_b64_tr_b16 a[106:107], v15 offset:20992
    v_fma_f32 v167, v167, v155, v154
    v_mul_f32 v164, v232, v164
    v_mul_f32 v165, v233, v165
    v_mul_f32_e64 v166, v234, v166
    v_mfma_f32_32x32x16_bf16 v[48:63], a[108:111], v[92:95], v[48:63]
    ds_read_b64_tr_b16 a[108:109], v15 offset:22528
    ds_read_b64_tr_b16 a[110:111], v15 offset:23040
    buffer_load_dwordx4 v26, s[20:23], s1 offen offset:2048 lds
    v_mul_f32 v167, v235, v167
    v_exp_f32 v164, v164
    v_exp_f32 v165, v165
    s_waitcnt lgkmcnt(10)
    v_mfma_f32_32x32x16_bf16 v[48:63], a[112:115], v[96:99], v[48:63]
    ds_read_b64_tr_b16 a[112:113], v15 offset:24576
    ds_read_b64_tr_b16 a[114:115], v15 offset:25088
    v_exp_f32 v166, v166
    v_exp_f32 v167, v167
    v_fma_f32 v164, v164, v156, v156
    v_fma_f32 v165, v165, v156, v156
    v_fma_f32 v166, v166, v156, v156
    v_mfma_f32_32x32x16_bf16 v[48:63], a[116:119], v[100:103], v[48:63]
    ds_read_b64_tr_b16 a[116:117], v15 offset:26624
    ds_read_b64_tr_b16 a[118:119], v15 offset:27136
    buffer_load_dwordx4 v27, s[20:23], s1 offen offset:3072 lds
    v_fma_f32 v167, v167, v156, v156
    v_rcp_f32_e64 v164, v164
    v_mfma_f32_32x32x16_bf16 v[48:63], a[120:123], v[104:107], v[48:63]
    ds_read_b64_tr_b16 a[120:121], v15 offset:28672
    ds_read_b64_tr_b16 a[122:123], v15 offset:29184
    v_rcp_f32 v165, v165
    v_rcp_f32 v166, v166
    v_rcp_f32_e64 v167, v167
    v_mfma_f32_32x32x16_bf16 v[48:63], a[124:127], v[108:111], v[48:63]
    ds_read_b64_tr_b16 a[124:125], v15 offset:30720
    ds_read_b64_tr_b16 a[126:127], v15 offset:31232
    s_add_u32 m0, s92, 135168
    s_add_u32 s1, s1, 0x8000
    buffer_load_dwordx4 v24, s[20:23], s1 offen offset:0 lds
    v_add_u32_e64 v20, s92, v28
    v_mfma_f32_16x16x32_bf16 v[140:143], v[144:147], a[0:3], 0
    v_xor_b32 v21, 32, v20
    v_xor_b32 v22, 64, v20
    v_mfma_f32_16x16x32_bf16 v[140:143], v[144:147], a[4:7], v[140:143]
    v_xor_b32 v23, 96, v20
    v_mul_f32 v164, v232, v164
    v_mfma_f32_16x16x32_bf16 v[140:143], v[144:147], a[8:11], v[140:143]
    v_mul_f32 v165, v233, v165
    v_mul_f32 v166, v234, v166
    v_mfma_f32_16x16x32_bf16 v[140:143], v[144:147], a[12:15], v[140:143]
    v_mul_f32 v167, v235, v167
    v_mfma_f32_16x16x32_bf16 v[140:143], v[144:147], a[16:19], v[140:143]
    buffer_load_dwordx4 v25, s[20:23], s1 offen offset:1024 lds
    v_cvt_pk_bf16_f32 v172, v164, v165
    v_mfma_f32_16x16x32_bf16 v[140:143], v[144:147], a[20:23], v[140:143]
    v_cvt_pk_bf16_f32 v173, v166, v167
    v_mul_f32 v164, v236, v236
    v_mfma_f32_16x16x32_bf16 v[140:143], v[144:147], a[24:27], v[140:143]
    v_mul_f32 v165, v237, v237
    v_mul_f32_e64 v166, v238, v238
    v_mfma_f32_16x16x32_bf16 v[140:143], v[144:147], a[28:31], v[140:143]
    s_waitcnt lgkmcnt(0)
    s_barrier
    v_mfma_f32_32x32x16_bf16 v[64:79], a[0:3], a[128:131], 0
    buffer_load_dwordx4 v26, s[20:23], s1 offen offset:2048 lds
    v_mul_f32_e64 v167, v239, v239
    v_fma_f32 v164, v164, v155, v154
    v_fma_f32 v165, v165, v155, v154
    v_fma_f32 v166, v166, v155, v154
    v_mfma_f32_16x16x32_bf16 v[140:143], v[144:147], a[32:35], v[140:143]
    v_fma_f32 v167, v167, v155, v154
    v_mul_f32 v164, v236, v164
    v_mfma_f32_16x16x32_bf16 v[140:143], v[144:147], a[36:39], v[140:143]
    v_mul_f32 v165, v237, v165
    v_mul_f32 v166, v238, v166
    v_mfma_f32_16x16x32_bf16 v[140:143], v[144:147], a[40:43], v[140:143]
    v_mul_f32 v167, v239, v167
    v_exp_f32_e64 v164, v164
    v_mfma_f32_16x16x32_bf16 v[140:143], v[144:147], a[44:47], v[140:143]
    buffer_load_dwordx4 v27, s[20:23], s1 offen offset:3072 lds
    v_mfma_f32_16x16x32_bf16 v[140:143], v[144:147], a[48:51], v[140:143]
    v_exp_f32 v165, v165
    v_mfma_f32_16x16x32_bf16 v[140:143], v[144:147], a[52:55], v[140:143]
    v_exp_f32 v166, v166
    v_mfma_f32_16x16x32_bf16 v[140:143], v[144:147], a[56:59], v[140:143]
    v_exp_f32_e64 v167, v167
    v_mfma_f32_16x16x32_bf16 v[140:143], v[144:147], a[60:63], v[140:143]
    s_add_u32 m0, s92, 0
    s_lshl4_add_u32 s1, s87, s67
    buffer_load_dwordx4 v24, s[20:23], s1 offen offset:0 lds
    v_mfma_f32_32x32x16_bf16 v[64:79], a[4:7], a[132:135], v[64:79]
    v_fma_f32 v164, v164, v156, v156
    v_fma_f32 v165, v165, v156, v156
    v_fma_f32 v166, v166, v156, v156
    v_fma_f32 v167, v167, v156, v156
    v_rcp_f32 v164, v164
    v_mfma_f32_16x16x32_bf16 v[140:143], v[144:147], a[64:67], v[140:143]
    v_rcp_f32 v165, v165
    v_mfma_f32_16x16x32_bf16 v[140:143], v[144:147], a[68:71], v[140:143]
    buffer_load_dwordx4 v25, s[20:23], s1 offen offset:1024 lds
    v_rcp_f32 v166, v166
    v_mfma_f32_16x16x32_bf16 v[140:143], v[144:147], a[72:75], v[140:143]
    v_rcp_f32 v167, v167
    v_mfma_f32_16x16x32_bf16 v[140:143], v[144:147], a[76:79], v[140:143]
    v_mul_f32 v164, v236, v164
    v_mfma_f32_16x16x32_bf16 v[140:143], v[144:147], a[80:83], v[140:143]
    v_mul_f32 v165, v237, v165
    v_mul_f32_e64 v166, v238, v166
    v_mfma_f32_16x16x32_bf16 v[140:143], v[144:147], a[84:87], v[140:143]
    buffer_load_dwordx4 v26, s[20:23], s1 offen offset:2048 lds
    v_mul_f32_e64 v167, v239, v167
    v_mfma_f32_16x16x32_bf16 v[140:143], v[144:147], a[88:91], v[140:143]
    v_cvt_pk_bf16_f32 v174, v164, v165
    v_cvt_pk_bf16_f32 v175, v166, v167
    v_mfma_f32_16x16x32_bf16 v[140:143], v[144:147], a[92:95], v[140:143]
    buffer_store_dwordx4 v[172:175], v1, s[16:19], s71 offen offset:1024 sc1
    v_mfma_f32_32x32x16_bf16 v[64:79], a[8:11], a[136:139], v[64:79]
    s_lshl_b32 s71, s94, 11
    s_add_u32 s71, s71, s81
    v_mul_f32 v164, v48, v48
    v_mul_f32 v165, v49, v49
    v_mul_f32_e64 v166, v50, v50
    v_mfma_f32_16x16x32_bf16 v[140:143], v[144:147], a[96:99], v[140:143]
    v_mul_f32_e64 v167, v51, v51
    v_fma_f32 v164, v164, v158, v157
    v_mfma_f32_16x16x32_bf16 v[140:143], v[144:147], a[100:103], v[140:143]
    v_fma_f32 v165, v165, v158, v157
    v_fma_f32 v166, v166, v158, v157
    v_mfma_f32_16x16x32_bf16 v[140:143], v[144:147], a[104:107], v[140:143]
    buffer_load_dwordx4 v27, s[20:23], s1 offen offset:3072 lds
    v_fma_f32 v167, v167, v158, v157
    v_mfma_f32_16x16x32_bf16 v[140:143], v[144:147], a[108:111], v[140:143]
    v_mul_f32 v164, v48, v164
    v_mfma_f32_16x16x32_bf16 v[140:143], v[144:147], a[112:115], v[140:143]
    v_mul_f32 v165, v49, v165
    v_mul_f32 v166, v50, v166
    v_mfma_f32_16x16x32_bf16 v[140:143], v[144:147], a[116:119], v[140:143]
    v_mul_f32 v167, v51, v167
    v_exp_f32_e64 v164, v164
    v_mfma_f32_16x16x32_bf16 v[140:143], v[144:147], a[120:123], v[140:143]
    s_add_u32 m0, s92, 4096
    s_add_u32 s1, s1, 0x8000
    buffer_load_dwordx4 v24, s[20:23], s1 offen offset:0 lds
    v_mfma_f32_16x16x32_bf16 v[140:143], v[144:147], a[124:127], v[140:143]
    v_exp_f32 v165, v165
    v_mfma_f32_32x32x16_bf16 v[64:79], a[12:15], a[140:143], v[64:79]
    s_waitcnt vmcnt(19)
    ds_read_b64_tr_b16 a[128:129], v20 offset:32768
    ds_read_b64_tr_b16 a[130:131], v20 offset:33280
    ds_read_b64_tr_b16 a[132:133], v21 offset:32768
    ds_read_b64_tr_b16 a[134:135], v21 offset:33280
    ds_read_b64_tr_b16 a[136:137], v22 offset:32768
    v_mfma_f32_32x32x16_bf16 v[64:79], a[16:19], a[144:147], v[64:79]
    ds_read_b64_tr_b16 a[138:139], v22 offset:33280
    ds_read_b64_tr_b16 a[140:141], v23 offset:32768
    ds_read_b64_tr_b16 a[142:143], v23 offset:33280
    buffer_load_dwordx4 v25, s[20:23], s1 offen offset:1024 lds
    v_cvt_pk_bf16_f32 v116, v140, v140
    v_lshlrev_b32 v17, 16, v116
    v_mfma_f32_32x32x16_bf16 v[64:79], a[20:23], a[148:151], v[64:79]
    v_sub_f32 v16, v140, v17
    v_cvt_pk_bf16_f32 v117, v16, v16
    v_exp_f32 v166, v166
    v_exp_f32 v167, v167
    v_mfma_f32_32x32x16_bf16 v[64:79], a[24:27], a[152:155], v[64:79]
    v_fma_f32 v164, v164, v159, v159
    v_fma_f32 v165, v165, v159, v159
    v_fma_f32 v166, v166, v159, v159
    v_fma_f32 v167, v167, v159, v159
    v_rcp_f32 v164, v164
    v_mfma_f32_32x32x16_bf16 v[64:79], a[28:31], a[156:159], v[64:79]
    s_waitcnt vmcnt(16)
    ds_read_b64_tr_b16 a[144:145], v20 offset:36864
    ds_read_b64_tr_b16 a[146:147], v20 offset:37376
    ds_read_b64_tr_b16 a[148:149], v21 offset:36864
    ds_read_b64_tr_b16 a[150:151], v21 offset:37376
    ds_read_b64_tr_b16 a[152:153], v22 offset:36864
    buffer_load_dwordx4 v26, s[20:23], s1 offen offset:2048 lds
    v_mfma_f32_32x32x16_bf16 v[64:79], a[32:35], a[160:163], v[64:79]
    ds_read_b64_tr_b16 a[154:155], v22 offset:37376
    ds_read_b64_tr_b16 a[156:157], v23 offset:36864
    ds_read_b64_tr_b16 a[158:159], v23 offset:37376
    s_waitcnt lgkmcnt(8)
    v_rcp_f32 v165, v165
    v_rcp_f32 v166, v166
    v_rcp_f32 v167, v167
    v_mul_f32 v164, v48, v164
    v_mul_f32 v165, v49, v165
    v_mul_f32 v166, v50, v166
    v_mul_f32 v167, v51, v167
    v_cvt_pk_bf16_f32 v168, v164, v165
    v_cvt_pk_bf16_f32 v169, v166, v167
    v_mul_f32 v164, v52, v52
    v_mul_f32 v165, v53, v53
    v_mul_f32 v166, v54, v54
    v_mul_f32 v167, v55, v55
    v_fma_f32 v164, v164, v158, v157
    buffer_load_dwordx4 v27, s[20:23], s1 offen offset:3072 lds
    v_fma_f32 v165, v165, v158, v157
    v_fma_f32 v166, v166, v158, v157
    v_mfma_f32_32x32x16_bf16 v[64:79], a[36:39], a[164:167], v[64:79]
    v_fma_f32 v167, v167, v158, v157
    v_mul_f32 v164, v52, v164
    v_mul_f32 v165, v53, v165
    v_mul_f32 v166, v54, v166
    v_mul_f32 v167, v55, v167
    v_exp_f32 v164, v164
    v_exp_f32 v165, v165
    v_mfma_f32_32x32x16_bf16 v[64:79], a[40:43], a[168:171], v[64:79]
    s_add_u32 m0, s92, 32768
    s_add_u32 s1, s1, 0x8000
    buffer_load_dwordx4 v24, s[20:23], s1 offen offset:0 lds
    v_exp_f32 v166, v166
    v_exp_f32 v167, v167
    v_fma_f32 v164, v164, v159, v159
    v_fma_f32 v165, v165, v159, v159
    v_fma_f32 v166, v166, v159, v159
    v_mfma_f32_32x32x16_bf16 v[64:79], a[44:47], a[172:175], v[64:79]
    v_add_u32 v20, 131072, v20
    v_add_u32 v21, 131072, v21
    v_add_u32 v22, 131072, v22
    v_add_u32 v23, 131072, v23
    s_waitcnt vmcnt(14)
    v_fma_f32 v167, v167, v159, v159
    v_rcp_f32 v164, v164
    v_rcp_f32 v165, v165
    v_rcp_f32 v166, v166
    v_rcp_f32 v167, v167
    v_mul_f32 v164, v52, v164
    buffer_load_dwordx4 v25, s[20:23], s1 offen offset:1024 lds
    v_mul_f32 v165, v53, v165
    v_mul_f32 v166, v54, v166
    v_mul_f32_e64 v167, v55, v167
    v_cvt_pk_bf16_f32 v170, v164, v165
    v_cvt_pk_bf16_f32 v171, v166, v167
    ds_read_b64_tr_b16 a[160:161], v20 offset:0
    ds_read_b64_tr_b16 a[162:163], v20 offset:512
    ds_read_b64_tr_b16 a[164:165], v21 offset:0
    ds_read_b64_tr_b16 a[166:167], v21 offset:512
    ds_read_b64_tr_b16 a[168:169], v22 offset:0
    ds_read_b64_tr_b16 a[170:171], v22 offset:512
    ds_read_b64_tr_b16 a[172:173], v23 offset:0
    ds_read_b64_tr_b16 a[174:175], v23 offset:512
    s_waitcnt lgkmcnt(8)
    buffer_store_dwordx4 v[168:171], v1, s[16:19], s71 offen offset:0 sc1
    v_mul_f32 v164, v56, v56
    v_mul_f32 v165, v57, v57
    v_mul_f32 v166, v58, v58
    v_mul_f32_e64 v167, v59, v59
    v_fma_f32 v164, v164, v158, v157
    v_fma_f32 v165, v165, v158, v157
    v_fma_f32 v166, v166, v158, v157
    v_mfma_f32_32x32x16_bf16 v[64:79], a[48:51], a[176:179], v[64:79]
    v_fma_f32 v167, v167, v158, v157
    v_mul_f32 v164, v56, v164
    v_mul_f32 v165, v57, v165
    v_mul_f32 v166, v58, v166
    v_mul_f32 v167, v59, v167
    v_exp_f32 v164, v164
    v_exp_f32 v165, v165
    v_mfma_f32_32x32x16_bf16 v[64:79], a[52:55], a[180:183], v[64:79]
    buffer_load_dwordx4 v26, s[20:23], s1 offen offset:2048 lds
    v_exp_f32 v166, v166
    v_exp_f32 v167, v167
    v_fma_f32 v164, v164, v159, v159
    v_fma_f32 v165, v165, v159, v159
    v_fma_f32 v166, v166, v159, v159
    v_fma_f32 v167, v167, v159, v159
    v_rcp_f32 v164, v164
    v_rcp_f32 v165, v165
    v_rcp_f32 v166, v166
    v_rcp_f32 v167, v167
    v_mfma_f32_32x32x16_bf16 v[64:79], a[56:59], a[184:187], v[64:79]
    buffer_load_dwordx4 v27, s[20:23], s1 offen offset:3072 lds
    v_mul_f32 v164, v56, v164
    v_mul_f32 v165, v57, v165
    v_mul_f32 v166, v58, v166
    v_mul_f32 v167, v59, v167
    v_cvt_pk_bf16_f32 v172, v164, v165
    v_cvt_pk_bf16_f32 v173, v166, v167
    v_mul_f32 v164, v60, v60
    v_mul_f32 v165, v61, v61
    v_mul_f32 v166, v62, v62
    v_mul_f32_e64 v167, v63, v63
    v_fma_f32 v164, v164, v158, v157
    v_fma_f32 v165, v165, v158, v157
    v_fma_f32 v166, v166, v158, v157
    v_fma_f32 v167, v167, v158, v157
    v_mfma_f32_32x32x16_bf16 v[64:79], a[60:63], a[188:191], v[64:79]
    s_waitcnt vmcnt(14)
    ds_read_b64_tr_b16 a[176:177], v20 offset:4096
    ds_read_b64_tr_b16 a[178:179], v20 offset:4608
    ds_read_b64_tr_b16 a[180:181], v21 offset:4096
    ds_read_b64_tr_b16 a[182:183], v21 offset:4608
    ds_read_b64_tr_b16 a[184:185], v22 offset:4096
    s_add_u32 m0, s92, 36864
    s_add_u32 s1, s1, 0x8000
    buffer_load_dwordx4 v24, s[20:23], s1 offen offset:0 lds
    v_mul_f32 v164, v60, v164
    v_mul_f32 v165, v61, v165
    v_mul_f32 v166, v62, v166
    v_mul_f32 v167, v63, v167
    v_exp_f32 v164, v164
    v_exp_f32 v165, v165
    v_mfma_f32_32x32x16_bf16 v[64:79], a[64:67], a[192:195], v[64:79]
    ds_read_b64_tr_b16 a[186:187], v22 offset:4608
    ds_read_b64_tr_b16 a[188:189], v23 offset:4096
    ds_read_b64_tr_b16 a[190:191], v23 offset:4608
    buffer_load_dwordx4 v25, s[20:23], s1 offen offset:1024 lds
    s_waitcnt lgkmcnt(8)
    v_exp_f32 v166, v166
    v_exp_f32_e64 v167, v167
    v_fma_f32 v164, v164, v159, v159
    v_fma_f32 v165, v165, v159, v159
    v_fma_f32 v166, v166, v159, v159
    v_fma_f32 v167, v167, v159, v159
    v_rcp_f32 v164, v164
    v_rcp_f32 v165, v165
    v_rcp_f32 v166, v166
    v_rcp_f32 v167, v167
    v_mfma_f32_32x32x16_bf16 v[64:79], a[68:71], a[196:199], v[64:79]
    buffer_load_dwordx4 v26, s[20:23], s1 offen offset:2048 lds
    v_mul_f32 v164, v60, v164
    v_mul_f32 v165, v61, v165
    v_mul_f32_e64 v166, v62, v166
    v_mul_f32_e64 v167, v63, v167
    v_cvt_pk_bf16_f32 v174, v164, v165
    v_cvt_pk_bf16_f32 v175, v166, v167
    buffer_store_dwordx4 v[172:175], v1, s[16:19], s71 offen offset:1024 sc1
    v_mfma_f32_32x32x16_bf16 v[64:79], a[72:75], a[200:203], v[64:79]
    s_lshl2_add_u32 s73, s5, s3
    s_lshl_b32 s72, s4, 10
    s_lshl3_add_u32 s73, s73, s72
    s_add_u32 s73, s73, 12288
    s_cmp_lg_u32 s98, 0
    s_cselect_b32 s71, s81, s80
    s_cselect_b32 s81, s80, s81
    s_mov_b32 s80, s71
    v_mfma_f32_32x32x16_bf16 v[64:79], a[76:79], a[204:207], v[64:79]
    v_add_u32 v20, -131072, v20
    v_add_u32 v21, -131072, v21
    v_add_u32 v22, -131072, v22
    v_add_u32 v23, -131072, v23
    s_waitcnt vmcnt(13)
    v_cndmask_b32 v160, v148, v148, s[98:99]
    v_mfma_f32_32x32x16_bf16 v[64:79], a[80:83], a[208:211], v[64:79]
    ds_read_b64_tr_b16 a[192:193], v20 offset:0
    ds_read_b64_tr_b16 a[194:195], v20 offset:512
    ds_read_b64_tr_b16 a[196:197], v21 offset:0
    ds_read_b64_tr_b16 a[198:199], v21 offset:512
    ds_read_b64_tr_b16 a[200:201], v22 offset:0
    buffer_load_dwordx4 v27, s[20:23], s1 offen offset:3072 lds
    v_mfma_f32_32x32x16_bf16 v[64:79], a[84:87], a[212:215], v[64:79]
    ds_read_b64_tr_b16 a[202:203], v22 offset:512
    ds_read_b64_tr_b16 a[204:205], v23 offset:0
    ds_read_b64_tr_b16 a[206:207], v23 offset:512
    s_waitcnt lgkmcnt(8)
    v_mul_f32 v161, 0xbf206c99, v160
    v_mfma_f32_32x32x16_bf16 v[64:79], a[88:91], a[216:219], v[64:79]
    v_mfma_f32_32x32x16_bf16 v[64:79], a[92:95], a[220:223], v[64:79]
    s_waitcnt vmcnt(10)
    ds_read_b64_tr_b16 a[208:209], v20 offset:4096
    ds_read_b64_tr_b16 a[210:211], v20 offset:4608
    ds_read_b64_tr_b16 a[212:213], v21 offset:4096
    ds_read_b64_tr_b16 a[214:215], v21 offset:4608
    ds_read_b64_tr_b16 a[216:217], v22 offset:4096
    s_add_u32 m0, s92, 131072
    s_lshl3_add_u32 s1, s93, s67
    buffer_load_dwordx4 v24, s[24:27], s1 offen offset:0 lds
    v_mfma_f32_32x32x16_bf16 v[64:79], a[96:99], a[224:227], v[64:79]
    ds_read_b64_tr_b16 a[218:219], v22 offset:4608
    ds_read_b64_tr_b16 a[220:221], v23 offset:4096
    ds_read_b64_tr_b16 a[222:223], v23 offset:4608
    v_add_u32 v11, s97, v11
    v_add_u32_e64 v12, s97, v12
    v_add_u32_e64 v13, s97, v13
    v_add_u32_e64 v14, s97, v14
    v_mfma_f32_32x32x16_bf16 v[64:79], a[100:103], a[228:231], v[64:79]
    ds_read_b128 v[80:83], v11 offset:0
    buffer_load_dwordx4 v25, s[24:27], s1 offen offset:1024 lds
    s_waitcnt lgkmcnt(9)
    v_mfma_f32_32x32x16_bf16 v[64:79], a[104:107], a[232:235], v[64:79]
    ds_read_b128 v[84:87], v12 offset:0
    v_mfma_f32_32x32x16_bf16 v[64:79], a[108:111], a[236:239], v[64:79]
    ds_read_b128 v[88:91], v13 offset:0
    buffer_load_dwordx4 v26, s[24:27], s1 offen offset:2048 lds
    v_mfma_f32_32x32x16_bf16 v[64:79], a[112:115], a[240:243], v[64:79]
    ds_read_b128 v[92:95], v14 offset:0
    v_mfma_f32_32x32x16_bf16 v[64:79], a[116:119], a[244:247], v[64:79]
    ds_read_b128 v[96:99], v11 offset:4096
    s_waitcnt vmcnt(8)
    ds_read_b64_tr_b16 a[224:225], v20 offset:32768
    ds_read_b64_tr_b16 a[226:227], v20 offset:33280
    ds_read_b64_tr_b16 a[228:229], v21 offset:32768
    buffer_load_dwordx4 v27, s[24:27], s1 offen offset:3072 lds
    v_mfma_f32_32x32x16_bf16 v[64:79], a[120:123], a[248:251], v[64:79]
    ds_read_b128 v[100:103], v12 offset:4096
    ds_read_b64_tr_b16 a[230:231], v21 offset:33280
    ds_read_b64_tr_b16 a[232:233], v22 offset:32768
    ds_read_b64_tr_b16 a[234:235], v22 offset:33280
    v_mfma_f32_32x32x16_bf16 v[64:79], a[124:127], a[252:255], v[64:79]
    ds_read_b128 v[104:107], v13 offset:4096
    ds_read_b64_tr_b16 a[236:237], v23 offset:32768
    ds_read_b64_tr_b16 a[238:239], v23 offset:33280
    s_add_u32 m0, s92, 135168
    s_add_u32 s1, s1, 0x8000
    buffer_load_dwordx4 v24, s[24:27], s1 offen offset:0 lds
    v_mfma_f32_32x32x16_bf16 v[64:79], v[116:119], v[120:123], v[64:79]
    s_waitcnt lgkmcnt(15)
    s_nop 4
    v_mfma_f32_32x32x16_bf16 v[48:63], v[116:119], v[136:139], 0
    s_nop 5
    s_waitcnt lgkmcnt(11)
    v_mfma_f32_32x32x16_bf16 v[48:63], a[0:3], v[80:83], v[48:63]
    ds_read_b128 v[108:111], v14 offset:4096
    buffer_load_dwordx4 v25, s[24:27], s1 offen offset:1024 lds
    v_cvt_pk_bf16_f32 v164, v64, v65
    v_cvt_pk_bf16_f32 v165, v66, v67
    v_cvt_pk_bf16_f32 v166, v68, v69
    v_cvt_pk_bf16_f32 v167, v70, v71
    v_mfma_f32_32x32x16_bf16 v[48:63], a[4:7], v[84:87], v[48:63]
    ds_read_b128 v[80:83], v11 offset:8192
    v_cvt_pk_bf16_f32 v196, v72, v73
    v_cvt_pk_bf16_f32 v197, v74, v75
    s_waitcnt vmcnt(7)
    s_mov_b64 exec, 1
    buffer_store_dwordx2 v[8:9], v33, s[16:19], s73 offen sc1
    s_mov_b64 exec, -1
    v_mfma_f32_32x32x16_bf16 v[48:63], a[8:11], v[88:91], v[48:63]
    ds_read_b128 v[84:87], v12 offset:8192
    s_mul_i32 s73, s6, 17408
    s_add_u32 s73, s73, 262144
    v_add_u32 v240, s73, v1
    v_and_b32_e64 v2, 0x30, v1
    v_lshrrev_b32_e64 v15, 4, v0
    v_mfma_f32_32x32x16_bf16 v[48:63], a[12:15], v[92:95], v[48:63]
    ds_read_b128 v[88:91], v13 offset:8192
    v_lshl_add_u32 v2, v15, 2, v2
    v_cvt_pk_bf16_f32 v198, v76, v77
    v_cvt_pk_bf16_f32 v199, v78, v79
    s_nop 1
    v_mfma_f32_32x32x16_bf16 v[64:79], v[204:207], v[196:199], 0
    buffer_load_dwordx4 v26, s[24:27], s1 offen offset:2048 lds
    v_mfma_f32_32x32x16_bf16 v[176:191], v[200:203], v[164:167], 0
    s_nop 5
    s_waitcnt lgkmcnt(3)
    v_mfma_f32_32x32x16_bf16 v[48:63], a[16:19], v[96:99], v[48:63]
    ds_read_b128 v[92:95], v14 offset:8192
    buffer_load_dwordx4 v27, s[24:27], s1 offen offset:3072 lds
    s_nop 0
    v_max3_f32 v18, v64, v65, v66
    v_max3_f32 v19, v67, v68, v69
    v_max3_f32 v18, v18, v70, v71
    v_max3_f32 v19, v19, v72, v73
    v_max3_f32 v18, v18, v74, v75
    v_max3_f32 v19, v19, v76, v77
    s_waitcnt vmcnt(9)
    v_max3_f32 v18, v18, v78, v79
    v_max_f32 v18, v18, v19
    v_mul_f32_e64 v18, v18, v161
    v_mfma_f32_32x32x16_bf16 v[48:63], a[20:23], v[100:103], v[48:63]
    ds_read_b128 v[96:99], v11 offset:12288
    ds_read_b64_tr_b16 a[240:241], v20 offset:36864
    ds_read_b64_tr_b16 a[242:243], v20 offset:37376
    ds_read_b64_tr_b16 a[244:245], v21 offset:36864
    v_fma_f32 v64, v64, v161, -v18
    v_fma_f32 v65, v65, v161, -v18
    v_mfma_f32_32x32x16_bf16 v[48:63], a[24:27], v[104:107], v[48:63]
    ds_read_b128 v[100:103], v12 offset:12288
    ds_read_b64_tr_b16 a[246:247], v21 offset:37376
    ds_read_b64_tr_b16 a[248:249], v22 offset:36864
    ds_read_b64_tr_b16 a[250:251], v22 offset:37376
    buffer_load_dwordx2 v[30:31], v32, s[16:19], s95 offen offset:0 sc1
    v_fma_f32 v66, v66, v161, -v18
    v_fma_f32 v67, v67, v161, -v18
    v_fma_f32 v68, v68, v161, -v18
    v_fma_f32 v69, v69, v161, -v18
    v_fma_f32 v70, v70, v161, -v18
    v_fma_f32 v71, v71, v161, -v18
    v_fma_f32 v72, v72, v161, -v18
    v_fma_f32 v73, v73, v161, -v18
    v_fma_f32 v74, v74, v161, -v18
    v_mfma_f32_32x32x16_bf16 v[48:63], a[28:31], v[108:111], v[48:63]
    ds_read_b128 v[104:107], v13 offset:12288
    ds_read_b64_tr_b16 a[252:253], v23 offset:36864
    ds_read_b64_tr_b16 a[254:255], v23 offset:37376
    s_add_u32 m0, s92, 0
    s_add_u32 s1, s1, 0x8000
    buffer_load_dwordx4 v24, s[24:27], s1 offen offset:0 lds
    v_fma_f32 v75, v75, v161, -v18
    v_fma_f32 v76, v76, v161, -v18
    v_fma_f32 v77, v77, v161, -v18
    v_fma_f32 v78, v78, v161, -v18
    v_fma_f32 v79, v79, v161, -v18
    v_exp_f32 v64, v64
    v_exp_f32 v65, v65
    v_exp_f32 v66, v66
    s_waitcnt lgkmcnt(11)
    v_mfma_f32_32x32x16_bf16 v[48:63], a[32:35], v[80:83], v[48:63]
    ds_read_b128 v[108:111], v14 offset:12288
    buffer_load_dwordx4 v25, s[24:27], s1 offen offset:1024 lds
    v_exp_f32 v67, v67
    v_exp_f32 v68, v68
    v_mfma_f32_32x32x16_bf16 v[48:63], a[36:39], v[84:87], v[48:63]
    ds_read_b128 v[80:83], v11 offset:16384
    v_exp_f32 v69, v69
    v_exp_f32 v70, v70
    v_exp_f32 v71, v71
    v_mfma_f32_32x32x16_bf16 v[48:63], a[40:43], v[88:91], v[48:63]
    ds_read_b128 v[84:87], v12 offset:16384
    buffer_load_dwordx4 v26, s[24:27], s1 offen offset:2048 lds
    s_waitcnt lgkmcnt(3)
    v_exp_f32 v72, v72
    v_exp_f32 v73, v73
    v_exp_f32 v74, v74
    v_exp_f32 v75, v75
    v_exp_f32 v76, v76
    v_mfma_f32_32x32x16_bf16 v[48:63], a[44:47], v[92:95], v[48:63]
    ds_read_b128 v[88:91], v13 offset:16384
L_pad_ffn_2:
    s_cbranch_execz L_ret_ffn
    buffer_load_dwordx4 v27, s[24:27], s1 offen offset:3072 lds
    v_exp_f32 v77, v77
    v_exp_f32 v78, v78
    v_exp_f32 v79, v79
    v_add_f32 v18, v64, v65
    v_add_f32 v19, v66, v67
    v_add_f32 v18, v18, v68
    v_add_f32_e64 v19, v19, v69
    s_waitcnt lgkmcnt(3)
    v_mfma_f32_32x32x16_bf16 v[48:63], a[48:51], v[96:99], v[48:63]
    ds_read_b128 v[92:95], v14 offset:16384
    s_add_u32 m0, s92, 4096
    s_add_u32 s1, s1, 0x8000
    buffer_load_dwordx4 v24, s[24:27], s1 offen offset:0 lds
    v_add_f32 v18, v18, v70
    v_add_f32 v19, v19, v71
    v_mfma_f32_32x32x16_bf16 v[48:63], a[52:55], v[100:103], v[48:63]
    ds_read_b128 v[96:99], v11 offset:20480
    v_add_f32 v18, v18, v72
    v_add_f32 v19, v19, v73
    v_add_f32 v18, v18, v74
    v_add_f32 v19, v19, v75
    v_add_f32 v18, v18, v76
    v_add_f32 v19, v19, v77
    v_add_f32 v18, v18, v78
    v_add_f32 v19, v19, v79
    v_add_f32_e64 v18, v18, v19
    v_mfma_f32_32x32x16_bf16 v[48:63], a[56:59], v[104:107], v[48:63]
    ds_read_b128 v[100:103], v12 offset:20480
    buffer_load_dwordx4 v25, s[24:27], s1 offen offset:1024 lds
    v_rcp_f32 v18, v18
    s_nop 0
    v_mul_f32 v64, v64, v18
    v_mul_f32 v65, v65, v18
    v_mul_f32 v66, v66, v18
    v_mul_f32 v67, v67, v18
    v_mul_f32 v68, v68, v18
    v_mul_f32 v69, v69, v18
    v_mul_f32 v70, v70, v18
    v_mul_f32 v71, v71, v18
    v_mfma_f32_32x32x16_bf16 v[48:63], a[60:63], v[108:111], v[48:63]
    ds_read_b128 v[104:107], v13 offset:20480
    buffer_load_dwordx4 v26, s[24:27], s1 offen offset:2048 lds
    v_mul_f32 v72, v72, v18
    v_mul_f32 v73, v73, v18
    v_mul_f32 v74, v74, v18
    s_waitcnt lgkmcnt(3)
    v_mfma_f32_32x32x16_bf16 v[48:63], a[64:67], v[80:83], v[48:63]
    ds_read_b128 v[108:111], v14 offset:20480
    v_mul_f32 v75, v75, v18
    v_mul_f32 v76, v76, v18
    v_mul_f32 v77, v77, v18
    v_mul_f32 v78, v78, v18
    v_mul_f32_e64 v79, v79, v18
    v_cvt_pk_bf16_f32 v216, v64, v65
    v_cvt_pk_bf16_f32 v217, v66, v67
    v_mfma_f32_32x32x16_bf16 v[48:63], a[68:71], v[84:87], v[48:63]
    ds_read_b128 v[80:83], v11 offset:24576
    buffer_load_dwordx4 v27, s[24:27], s1 offen offset:3072 lds
    v_cvt_pk_bf16_f32 v218, v68, v69
    v_cvt_pk_bf16_f32 v219, v70, v71
    v_cvt_pk_bf16_f32 v220, v72, v73
    v_cvt_pk_bf16_f32 v221, v74, v75
    v_cvt_pk_bf16_f32 v222, v76, v77
    v_cvt_pk_bf16_f32 v223, v78, v79
    v_max3_f32 v18, v176, v177, v178
    v_max3_f32 v19, v179, v180, v181
    v_max3_f32 v18, v18, v182, v183
    v_max3_f32 v19, v19, v184, v185
    v_max3_f32 v18, v18, v186, v187
    v_mfma_f32_32x32x16_bf16 v[48:63], a[72:75], v[88:91], v[48:63]
    ds_read_b128 v[84:87], v12 offset:24576
    s_add_u32 m0, s92, 32768
    s_lshl4_add_u32 s1, s88, s67
    buffer_load_dwordx4 v24, s[20:23], s1 offen offset:0 lds
    s_waitcnt vmcnt(9)
    v_cmp_ne_u64 vcc, v[30:31], v[8:9]
    s_nop 1
    s_cbranch_vccnz L_retry_23
L_ok_25:
    v_and_b32 v32, 0x38, v32
    s_add_u32 s73, s93, 69632
    v_add_u32 v112, s73, v1
    v_xor_b32 v113, 0x4000, v112
    v_add_u32 v114, s73, v2
    v_lshl_add_u32 v115, v15, 4, s73
    v_max3_f32 v19, v19, v188, v189
    v_max3_f32 v18, v18, v190, v191
    v_max_f32 v18, v18, v19
    v_mul_f32 v18, v18, v161
    v_fma_f32 v176, v176, v161, -v18
    v_fma_f32 v177, v177, v161, -v18
    v_fma_f32 v178, v178, v161, -v18
    v_fma_f32 v179, v179, v161, -v18
    v_fma_f32 v180, v180, v161, -v18
    v_fma_f32 v181, v181, v161, -v18
    v_mfma_f32_32x32x16_bf16 v[48:63], a[76:79], v[92:95], v[48:63]
    ds_read_b128 v[88:91], v13 offset:24576
    buffer_load_dwordx4 v25, s[20:23], s1 offen offset:1024 lds
    v_fma_f32 v182, v182, v161, -v18
    v_fma_f32 v183, v183, v161, -v18
    v_fma_f32 v184, v184, v161, -v18
    v_fma_f32 v185, v185, v161, -v18
    s_waitcnt lgkmcnt(3)
    v_mfma_f32_32x32x16_bf16 v[48:63], a[80:83], v[96:99], v[48:63]
    ds_read_b128 v[92:95], v14 offset:24576
    v_fma_f32 v186, v186, v161, -v18
    v_fma_f32 v187, v187, v161, -v18
    v_fma_f32 v188, v188, v161, -v18
    v_fma_f32 v189, v189, v161, -v18
    v_fma_f32 v190, v190, v161, -v18
    v_fma_f32 v191, v191, v161, -v18
    v_exp_f32 v176, v176
    v_mfma_f32_32x32x16_bf16 v[48:63], a[84:87], v[100:103], v[48:63]
    ds_read_b128 v[96:99], v11 offset:28672
    buffer_load_dwordx4 v26, s[20:23], s1 offen offset:2048 lds
    v_exp_f32 v177, v177
    v_exp_f32 v178, v178
    v_exp_f32 v179, v179
    v_exp_f32 v180, v180
    v_exp_f32_e64 v181, v181
    v_mfma_f32_32x32x16_bf16 v[48:63], a[88:91], v[104:107], v[48:63]
    ds_read_b128 v[100:103], v12 offset:28672
    buffer_load_dwordx4 v27, s[20:23], s1 offen offset:3072 lds
    v_exp_f32_e64 v182, v182
    v_mfma_f32_32x32x16_bf16 v[48:63], a[92:95], v[108:111], v[48:63]
    ds_read_b128 v[104:107], v13 offset:28672
    v_exp_f32 v183, v183
    v_exp_f32 v184, v184
    v_exp_f32 v185, v185
    v_exp_f32_e64 v186, v186
    s_waitcnt lgkmcnt(3)
    v_mfma_f32_32x32x16_bf16 v[48:63], a[96:99], v[80:83], v[48:63]
    ds_read_b128 v[108:111], v14 offset:28672
    s_movk_i32 s0, 0x4000
    buffer_load_dwordx4 v[128:131], v240, s[16:19], s0 offen sc1
    v_exp_f32 v187, v187
    v_exp_f32 v188, v188
    v_exp_f32 v189, v189
    v_exp_f32 v190, v190
    v_exp_f32_e64 v191, v191
    v_mfma_f32_32x32x16_bf16 v[48:63], a[100:103], v[84:87], v[48:63]
    s_lshl_b32 s0, s64, 11
    s_and_b32 s0, s0, 12288
    buffer_load_dwordx4 a[0:3], v240, s[16:19], s0 offen offset:0 sc1
    v_add_f32 v18, v176, v177
    v_add_f32 v19, v178, v179
    v_add_f32 v18, v18, v180
    v_add_f32 v19, v19, v181
    v_add_f32 v18, v18, v182
    v_add_f32 v19, v19, v183
    v_add_f32 v18, v18, v184
    v_add_f32 v19, v19, v185
    v_add_f32 v18, v18, v186
    v_add_f32 v19, v19, v187
    v_mfma_f32_32x32x16_bf16 v[48:63], a[104:107], v[88:91], v[48:63]
    buffer_load_dwordx4 a[4:7], v240, s[16:19], s0 offen offset:1024 sc1
    v_add_f32 v18, v18, v188
    v_add_f32 v19, v19, v189
    v_mfma_f32_32x32x16_bf16 v[48:63], a[108:111], v[92:95], v[48:63]
    v_add_f32 v18, v18, v190
    v_add_f32 v19, v19, v191
    v_add_f32 v18, v18, v19
    v_rcp_f32 v18, v18
    s_nop 0
    v_mul_f32 v176, v176, v18
    v_mul_f32 v177, v177, v18
    v_mul_f32 v178, v178, v18
    v_mul_f32 v179, v179, v18
    s_waitcnt lgkmcnt(0)
    s_barrier
    v_mfma_f32_32x32x16_bf16 v[48:63], a[112:115], v[96:99], v[48:63]
    ds_write_b128 v112, v[216:219] offset:0
    buffer_load_dwordx4 a[8:11], v240, s[16:19], s0 offen offset:2048 sc1
    v_mul_f32 v180, v180, v18
    v_mul_f32 v181, v181, v18
    v_mul_f32 v182, v182, v18
    v_mul_f32 v183, v183, v18
    v_mul_f32 v184, v184, v18
    v_mul_f32 v185, v185, v18
    v_mul_f32 v186, v186, v18
    v_mul_f32 v187, v187, v18
    v_mul_f32 v188, v188, v18
    v_mul_f32 v189, v189, v18
    v_mfma_f32_32x32x16_bf16 v[48:63], a[116:119], v[100:103], v[48:63]
    ds_write_b128 v112, v[220:223] offset:1024
    buffer_load_dwordx4 a[12:15], v240, s[16:19], s0 offen offset:3072 sc1
    v_mul_f32 v190, v190, v18
    v_mul_f32_e64 v191, v191, v18
    v_mfma_f32_32x32x16_bf16 v[48:63], a[120:123], v[104:107], v[48:63]
    v_cvt_pk_bf16_f32 v208, v176, v177
    v_cvt_pk_bf16_f32 v209, v178, v179
    v_cvt_pk_bf16_f32 v210, v180, v181
    v_cvt_pk_bf16_f32 v211, v182, v183
    v_cvt_pk_bf16_f32 v212, v184, v185
    v_cvt_pk_bf16_f32 v213, v186, v187
    v_cvt_pk_bf16_f32 v214, v188, v189
    v_cvt_pk_bf16_f32 v215, v190, v191
    v_mfma_f32_32x32x16_bf16 v[48:63], a[124:127], v[108:111], v[48:63]
    s_add_u32 s0, s0, 4096
    s_and_b32 s0, s0, 0x3fff
    buffer_load_dwordx4 a[16:19], v240, s[16:19], s0 offen offset:0 sc1
    v_cndmask_b32 v160, v154, v157, s[98:99]
    v_mul_f32 v161, 0xbf206c99, v160
    v_add_u32 v11, 131072, v28
    v_xor_b32 v12, 32, v11
    v_xor_b32_e64 v13, 64, v11
    v_xor_b32 v14, 96, v11
    s_waitcnt vmcnt(10)
    s_nop 1
    v_cvt_pk_bf16_f32 v164, v48, v49
    v_cvt_pk_bf16_f32 v165, v50, v51
    buffer_load_dwordx4 a[20:23], v240, s[16:19], s0 offen offset:1024 sc1
    v_cvt_pk_bf16_f32 v166, v52, v53
    v_cvt_pk_bf16_f32 v167, v54, v55
    v_cvt_pk_bf16_f32 v196, v56, v57
    v_cvt_pk_bf16_f32 v197, v58, v59
    v_cvt_pk_bf16_f32 v198, v60, v61
    v_cvt_pk_bf16_f32 v199, v62, v63
    s_nop 1
    v_mfma_f32_32x32x16_bf16 v[48:63], v[204:207], v[196:199], 0
    v_mfma_f32_32x32x16_bf16 v[176:191], v[200:203], v[164:167], 0
    buffer_load_dwordx4 a[24:27], v240, s[16:19], s0 offen offset:2048 sc1
    s_nop 4
    s_nop 4
    v_max3_f32 v18, v48, v49, v50
    v_max3_f32 v19, v51, v52, v53
    buffer_load_dwordx4 a[28:31], v240, s[16:19], s0 offen offset:3072 sc1
    v_max3_f32 v18, v18, v54, v55
    v_max3_f32 v19, v19, v56, v57
    v_max3_f32 v18, v18, v58, v59
    v_max3_f32 v19, v19, v60, v61
    v_max3_f32 v18, v18, v62, v63
    v_max_f32 v18, v18, v19
    v_mul_f32 v18, v18, v161
    v_pk_fma_f32 v[48:49], v[48:49], v[160:161], v[18:19] op_sel:[0,1,0] op_sel_hi:[1,1,0] neg_lo:[0,0,1] neg_hi:[0,0,1]
    v_pk_fma_f32 v[50:51], v[50:51], v[160:161], v[18:19] op_sel:[0,1,0] op_sel_hi:[1,1,0] neg_lo:[0,0,1] neg_hi:[0,0,1]
    s_add_u32 s0, s0, 4096
    s_and_b32 s0, s0, 0x3fff
    buffer_load_dwordx4 a[32:35], v240, s[16:19], s0 offen offset:0 sc1
    s_waitcnt vmcnt(9)
    v_lshlrev_b32 v168, 16, v128
    v_and_b32 v172, 0xffff0000, v128
    v_lshlrev_b32 v169, 16, v129
    v_and_b32 v173, 0xffff0000, v129
    v_lshlrev_b32 v170, 16, v130
    v_and_b32 v174, 0xffff0000, v130
    v_lshlrev_b32 v171, 16, v131
    v_and_b32 v175, 0xffff0000, v131
    v_permlane16_swap_b32 v168, v169
    v_permlane16_swap_b32_e64 v170, v171
    buffer_load_dwordx4 a[36:39], v240, s[16:19], s0 offen offset:1024 sc1
    v_permlane16_swap_b32 v172, v173
    v_permlane16_swap_b32 v174, v175
    v_add_f32 v168, v168, v169
    v_add_f32 v170, v170, v171
    v_add_f32 v172, v172, v173
    v_add_f32 v174, v174, v175
    v_permlane32_swap_b32 v168, v170
    v_pk_fma_f32 v[52:53], v[52:53], v[160:161], v[18:19] op_sel:[0,1,0] op_sel_hi:[1,1,0] neg_lo:[0,0,1] neg_hi:[0,0,1]
    v_permlane32_swap_b32 v172, v174
    v_add_f32 v168, v168, v170
    v_add_f32 v172, v172, v174
    buffer_load_dwordx4 a[40:43], v240, s[16:19], s0 offen offset:2048 sc1
    v_add_f32_dpp v168, v168, v168 row_ror:4 row_mask:0xf bank_mask:0xf
    v_add_f32_dpp v172, v172, v172 row_ror:4 row_mask:0xf bank_mask:0xf
    v_pk_fma_f32 v[54:55], v[54:55], v[160:161], v[18:19] op_sel:[0,1,0] op_sel_hi:[1,1,0] neg_lo:[0,0,1] neg_hi:[0,0,1]
    v_add_f32_dpp v168, v168, v168 row_ror:8 row_mask:0xf bank_mask:0xf
    v_add_f32_dpp v172, v172, v172 row_ror:8 row_mask:0xf bank_mask:0xf
    v_cvt_pk_bf16_f32 v128, v168, v172
    v_pk_fma_f32 v[56:57], v[56:57], v[160:161], v[18:19] op_sel:[0,1,0] op_sel_hi:[1,1,0] neg_lo:[0,0,1] neg_hi:[0,0,1]
    v_pk_fma_f32 v[58:59], v[58:59], v[160:161], v[18:19] op_sel:[0,1,0] op_sel_hi:[1,1,0] neg_lo:[0,0,1] neg_hi:[0,0,1]
    v_pk_fma_f32 v[60:61], v[60:61], v[160:161], v[18:19] op_sel:[0,1,0] op_sel_hi:[1,1,0] neg_lo:[0,0,1] neg_hi:[0,0,1]
    v_pk_fma_f32 v[62:63], v[62:63], v[160:161], v[18:19] op_sel:[0,1,0] op_sel_hi:[1,1,0] neg_lo:[0,0,1] neg_hi:[0,0,1]
    v_exp_f32 v48, v48
    buffer_load_dwordx4 a[44:47], v240, s[16:19], s0 offen offset:3072 sc1
    v_exp_f32 v49, v49
    v_exp_f32 v50, v50
    v_exp_f32 v51, v51
    v_exp_f32 v52, v52
    v_exp_f32 v53, v53
    s_add_u32 s0, s0, 4096
    s_and_b32 s0, s0, 0x3fff
    buffer_load_dwordx4 a[48:51], v240, s[16:19], s0 offen offset:0 sc1
    v_exp_f32 v54, v54
    v_exp_f32 v55, v55
    v_exp_f32 v56, v56
    v_exp_f32 v57, v57
    v_exp_f32 v58, v58
    v_exp_f32 v59, v59
    buffer_load_dwordx4 a[52:55], v240, s[16:19], s0 offen offset:1024 sc1
    v_exp_f32 v60, v60
    v_exp_f32 v61, v61
    v_exp_f32 v62, v62
    v_exp_f32 v63, v63
    v_pk_add_f32 v[18:19], v[48:49], v[50:51]
    v_pk_add_f32 v[18:19], v[18:19], v[52:53]
    v_pk_add_f32 v[18:19], v[18:19], v[54:55]
    buffer_load_dwordx4 a[56:59], v240, s[16:19], s0 offen offset:2048 sc1
    v_pk_add_f32 v[18:19], v[18:19], v[56:57]
    v_pk_add_f32 v[18:19], v[18:19], v[58:59]
    v_pk_add_f32 v[18:19], v[18:19], v[60:61]
    v_pk_add_f32 v[18:19], v[18:19], v[62:63]
    v_add_f32 v18, v18, v19
    v_rcp_f32 v18, v18
    ds_write_b32 v114, v128 offset:4096
    v_pk_mul_f32 v[48:49], v[48:49], v[18:19] op_sel_hi:[1,0]
    v_pk_mul_f32 v[50:51], v[50:51], v[18:19] op_sel_hi:[1,0]
    buffer_load_dwordx4 a[60:63], v240, s[16:19], s0 offen offset:3072 sc1
    v_pk_mul_f32 v[52:53], v[52:53], v[18:19] op_sel_hi:[1,0]
    v_pk_mul_f32 v[54:55], v[54:55], v[18:19] op_sel_hi:[1,0]
    v_pk_mul_f32 v[56:57], v[56:57], v[18:19] op_sel_hi:[1,0]
    buffer_load_dwordx2 v[30:31], v32, s[16:19], s68 offen offset:0 sc1
    v_pk_mul_f32 v[58:59], v[58:59], v[18:19] op_sel_hi:[1,0]
    v_pk_mul_f32 v[60:61], v[60:61], v[18:19] op_sel_hi:[1,0]
    v_pk_mul_f32 v[62:63], v[62:63], v[18:19] op_sel_hi:[1,0]
    v_cvt_pk_bf16_f32 v232, v48, v49
    v_cvt_pk_bf16_f32 v233, v50, v51
    v_cvt_pk_bf16_f32 v234, v52, v53
    v_cvt_pk_bf16_f32 v235, v54, v55
    v_cvt_pk_bf16_f32 v236, v56, v57
    v_cvt_pk_bf16_f32 v237, v58, v59
    v_cvt_pk_bf16_f32 v238, v60, v61
    v_cvt_pk_bf16_f32 v239, v62, v63
    s_add_u32 m0, s92, 36864
    s_lshl4_add_u32 s1, s89, s67
    buffer_load_dwordx4 v24, s[20:23], s1 offen offset:0 lds
    s_waitcnt vmcnt(16)
    v_mfma_f32_32x32x16_bf16 v[80:95], v[192:195], a[0:3], 0
    ds_read_b128 v[128:131], v115 offset:4096
    ds_write_b128 v112, v[232:235] offset:2048
    v_max3_f32 v18, v176, v177, v178
    v_max3_f32 v19, v179, v180, v181
    v_max3_f32 v18, v18, v182, v183
    v_max3_f32 v19, v19, v184, v185
    v_mfma_f32_32x32x16_bf16 v[80:95], v[192:195], a[4:7], v[80:95]
    ds_write_b128 v112, v[236:239] offset:3072
    buffer_load_dwordx4 v25, s[20:23], s1 offen offset:1024 lds
    s_waitcnt vmcnt(15)
    v_mfma_f32_32x32x16_bf16 v[80:95], v[192:195], a[8:11], v[80:95]
    v_max3_f32 v18, v18, v186, v187
    v_max3_f32 v19, v19, v188, v189
    v_max3_f32 v18, v18, v190, v191
    v_max_f32 v18, v18, v19
    v_mul_f32 v18, v18, v161
    v_fma_f32 v176, v176, v161, -v18
    v_mfma_f32_32x32x16_bf16 v[80:95], v[192:195], a[12:15], v[80:95]
    s_waitcnt vmcnt(13)
    v_fma_f32 v177, v177, v161, -v18
    v_fma_f32 v178, v178, v161, -v18
    v_fma_f32 v179, v179, v161, -v18
    v_fma_f32 v180, v180, v161, -v18
    v_fma_f32 v181, v181, v161, -v18
    v_mfma_f32_32x32x16_bf16 v[80:95], v[192:195], a[16:19], v[80:95]
    buffer_load_dwordx4 v26, s[20:23], s1 offen offset:2048 lds
    v_fma_f32 v182, v182, v161, -v18
    v_fma_f32 v183, v183, v161, -v18
    v_fma_f32 v184, v184, v161, -v18
    v_fma_f32 v185, v185, v161, -v18
    v_fma_f32 v186, v186, v161, -v18
    v_mfma_f32_32x32x16_bf16 v[80:95], v[192:195], a[20:23], v[80:95]
    s_waitcnt vmcnt(12)
    v_fma_f32 v187, v187, v161, -v18
    v_fma_f32 v188, v188, v161, -v18
    v_fma_f32 v189, v189, v161, -v18
    v_fma_f32 v190, v190, v161, -v18
    s_waitcnt lgkmcnt(0)
    v_mfma_f32_32x32x16_bf16 v[80:95], v[192:195], a[24:27], v[80:95]
    buffer_load_dwordx4 v27, s[20:23], s1 offen offset:3072 lds
    s_barrier
    v_fma_f32 v191, v191, v161, -v18
    v_mfma_f32_32x32x16_bf16 v[80:95], v[192:195], a[28:31], v[80:95]
    ds_read_b128 v[216:219], v113 offset:0
    ds_read_b128 v[220:223], v113 offset:1024
    s_waitcnt vmcnt(11)
    v_exp_f32 v176, v176
    v_exp_f32 v177, v177
    v_mfma_f32_32x32x16_bf16 v[80:95], v[192:195], a[32:35], v[80:95]
    ds_read_b128 v[232:235], v113 offset:2048
    ds_read_b128 v[236:239], v113 offset:3072
    s_add_u32 m0, s93, 65536
    s_lshl4_add_u32 s1, s90, s67
    buffer_load_dwordx4 v24, s[20:23], s1 offen offset:0 lds
    v_exp_f32 v178, v178
    v_mfma_f32_32x32x16_bf16 v[80:95], v[192:195], a[36:39], v[80:95]
    s_waitcnt vmcnt(10)
    v_exp_f32 v179, v179
    v_exp_f32 v180, v180
    v_exp_f32 v181, v181
    v_mfma_f32_32x32x16_bf16 v[80:95], v[192:195], a[40:43], v[80:95]
    buffer_load_dwordx4 v25, s[20:23], s1 offen offset:1024 lds
    v_exp_f32 v182, v182
    v_exp_f32 v183, v183
    v_mfma_f32_32x32x16_bf16 v[80:95], v[192:195], a[44:47], v[80:95]
    s_waitcnt vmcnt(9)
    v_exp_f32 v184, v184
    v_exp_f32 v185, v185
    v_exp_f32 v186, v186
    v_mfma_f32_32x32x16_bf16 v[80:95], v[192:195], a[48:51], v[80:95]
    buffer_load_dwordx4 v26, s[20:23], s1 offen offset:2048 lds
    s_waitcnt lgkmcnt(0)
    v_exp_f32 v187, v187
    v_exp_f32 v188, v188
    v_mfma_f32_32x32x16_bf16 v[80:95], v[192:195], a[52:55], v[80:95]
    v_exp_f32 v189, v189
    v_exp_f32 v190, v190
    s_waitcnt vmcnt(8)
    v_exp_f32_e64 v191, v191
    v_mfma_f32_32x32x16_bf16 v[80:95], v[192:195], a[56:59], v[80:95]
    buffer_load_dwordx4 v27, s[20:23], s1 offen offset:3072 lds
    v_add_f32 v18, v176, v177
    v_add_f32 v19, v178, v179
    v_add_f32 v18, v18, v180
    v_add_f32 v19, v19, v181
    v_add_f32 v18, v18, v182
    v_mfma_f32_32x32x16_bf16 v[80:95], v[192:195], a[60:63], v[80:95]
    s_add_u32 s84, s6, 86
    s_lshl_b32 s84, s84, 10
    v_add_f32 v19, v19, v183
    s_waitcnt vmcnt(8)
    v_cmp_ne_u64 vcc, v[30:31], v[8:9]
    s_nop 1
    s_cbranch_vccnz L_retry_26
L_ok_28:
    v_add_f32 v18, v18, v184
    v_add_f32 v19, v19, v185
    buffer_load_dwordx4 a[64:67], v3, s[16:19], s86 offen offset:0 sc1
    v_add_f32 v18, v18, v186
    v_add_f32_e64 v19, v19, v187
    v_cvt_pk_bf16_f32 v96, v80, v81
    v_cvt_pk_bf16_f32 v97, v82, v83
    v_cvt_pk_bf16_f32 v98, v84, v85
    v_cvt_pk_bf16_f32 v99, v86, v87
    v_permlane16_swap_b32 v96, v128
    v_permlane16_swap_b32 v97, v129
    v_permlane16_swap_b32 v98, v130
    v_permlane16_swap_b32 v99, v131
    v_add_f32 v18, v18, v188
    v_add_f32 v19, v19, v189
    v_mfma_f32_32x32x16_bf16 v[64:79], v[96:99], v[208:211], 0
    v_add_f32 v18, v18, v190
    v_add_f32 v19, v19, v191
    v_add_f32 v18, v18, v19
    v_rcp_f32_e64 v18, v18
    s_nop 0
    v_mfma_f32_32x32x16_bf16 v[64:79], v[128:131], v[212:215], v[64:79]
    buffer_load_dwordx4 a[68:71], v4, s[16:19], s86 offen offset:0 sc1
    v_mul_f32 v176, v176, v18
    v_mul_f32 v177, v177, v18
    v_mul_f32 v178, v178, v18
    v_mul_f32 v179, v179, v18
    v_mul_f32 v180, v180, v18
    v_mfma_f32_32x32x16_bf16 v[80:95], v[96:99], v[216:219], 0
    v_mul_f32 v181, v181, v18
    v_mul_f32 v182, v182, v18
    v_mul_f32 v183, v183, v18
    v_mul_f32 v184, v184, v18
    v_mul_f32 v185, v185, v18
    v_mul_f32 v186, v186, v18
    v_mfma_f32_32x32x16_bf16 v[80:95], v[128:131], v[220:223], v[80:95]
    v_mul_f32 v187, v187, v18
    v_mul_f32 v188, v188, v18
    v_mul_f32 v189, v189, v18
    v_mul_f32 v190, v190, v18
    v_mul_f32 v191, v191, v18
    v_cvt_pk_bf16_f32 v224, v176, v177
    v_mfma_f32_32x32x16_bf16 v[48:63], v[96:99], v[232:235], 0
    buffer_load_dwordx4 a[72:75], v5, s[16:19], s86 offen offset:0 sc1
    v_cvt_pk_bf16_f32 v225, v178, v179
    v_cvt_pk_bf16_f32 v226, v180, v181
    v_cvt_pk_bf16_f32 v227, v182, v183
    v_cvt_pk_bf16_f32 v228, v184, v185
    v_cvt_pk_bf16_f32 v229, v186, v187
    v_mfma_f32_32x32x16_bf16 v[48:63], v[128:131], v[236:239], v[48:63]
    v_cvt_pk_bf16_f32 v230, v188, v189
    v_cvt_pk_bf16_f32 v231, v190, v191
    v_add_f32 v72, 0x358637bd, v72
    v_rcp_f32 v72, v72
    s_add_u32 s85, s78, s84
    v_mfma_f32_32x32x16_bf16 v[176:191], v[96:99], v[224:227], 0
    v_mul_f32 v64, v64, v72
    v_mul_f32 v65, v65, v72
    v_mul_f32 v66, v66, v72
    v_mul_f32 v67, v67, v72
    v_mul_f32 v68, v68, v72
    v_mul_f32 v69, v69, v72
    v_mfma_f32_32x32x16_bf16 v[176:191], v[128:131], v[228:231], v[176:191]
    buffer_load_dwordx4 a[76:79], v6, s[16:19], s86 offen offset:0 sc1
    v_mul_f32 v70, v70, v72
    v_mul_f32 v71, v71, v72
    v_cvt_pk_bf16_f32 v76, v64, v65
    v_cvt_pk_bf16_f32 v77, v66, v67
    v_cvt_pk_bf16_f32 v78, v68, v69
    v_cvt_pk_bf16_f32 v79, v70, v71
    buffer_store_dwordx4 v[76:79], v1, s[16:19], s85 offen sc1
    v_add_f32 v88, 0x358637bd, v88
    v_rcp_f32 v88, v88
    s_add_u32 s85, s79, s84
    v_mul_f32 v80, v80, v88
    v_mul_f32 v81, v81, v88
    v_mul_f32 v82, v82, v88
    v_mul_f32 v83, v83, v88
    v_mul_f32 v84, v84, v88
    v_mul_f32 v85, v85, v88
    v_mul_f32 v86, v86, v88
    v_mul_f32 v87, v87, v88
    v_cvt_pk_bf16_f32 v92, v80, v81
    v_cvt_pk_bf16_f32 v93, v82, v83
    v_cvt_pk_bf16_f32 v94, v84, v85
    v_cvt_pk_bf16_f32 v95, v86, v87
    buffer_store_dwordx4 v[92:95], v1, s[16:19], s85 offen sc1
    v_add_f32 v56, 0x358637bd, v56
    v_rcp_f32 v56, v56
    s_add_u32 s85, s81, s84
    v_mul_f32 v48, v48, v56
    v_mul_f32 v49, v49, v56
    v_mul_f32 v50, v50, v56
    v_mul_f32 v51, v51, v56
    v_mul_f32 v52, v52, v56
    v_mul_f32 v53, v53, v56
    v_mul_f32 v54, v54, v56
    v_mul_f32 v55, v55, v56
    v_cvt_pk_bf16_f32 v60, v48, v49
    v_cvt_pk_bf16_f32 v61, v50, v51
    v_cvt_pk_bf16_f32 v62, v52, v53
    v_cvt_pk_bf16_f32 v63, v54, v55
    buffer_store_dwordx4 v[60:63], v1, s[16:19], s85 offen sc1
    v_add_f32 v184, 0x358637bd, v184
    v_rcp_f32 v184, v184
    s_add_u32 s85, s80, s84
    v_mul_f32 v176, v176, v184
    v_mul_f32 v177, v177, v184
    v_mul_f32 v178, v178, v184
    v_mul_f32 v179, v179, v184
    v_mul_f32_e64 v180, v180, v184
    v_mul_f32_e64 v181, v181, v184
    v_mul_f32_e64 v182, v182, v184
    v_mul_f32_e64 v183, v183, v184
    v_cvt_pk_bf16_f32 v188, v176, v177
    v_cvt_pk_bf16_f32 v189, v178, v179
    v_cvt_pk_bf16_f32 v190, v180, v181
    v_cvt_pk_bf16_f32 v191, v182, v183
    buffer_store_dwordx4 v[188:191], v1, s[16:19], s85 offen sc1
    s_mov_b32 s73, s6
    s_lshl_b32 s72, s4, 10
    s_lshl3_add_u32 s73, s73, s72
    s_add_u32 s73, s73, 12800
    s_barrier
    ds_read_b64_tr_b16 v[96:97], v11 offset:0
    ds_read_b64_tr_b16 v[98:99], v11 offset:512
    ds_read_b64_tr_b16 v[100:101], v12 offset:0
    ds_read_b64_tr_b16 v[102:103], v12 offset:512
    ds_read_b64_tr_b16 v[104:105], v13 offset:0
    ds_read_b64_tr_b16 v[106:107], v13 offset:512
    ds_read_b64_tr_b16 v[108:109], v14 offset:0
    ds_read_b64_tr_b16 v[110:111], v14 offset:512
    ds_read_b64_tr_b16 v[112:113], v11 offset:4096
    buffer_load_dwordx4 a[80:83], v3, s[16:19], s86 offen offset:2048 sc1
    ds_read_b64_tr_b16 v[114:115], v11 offset:4608
    ds_read_b64_tr_b16 v[116:117], v12 offset:4096
    ds_read_b64_tr_b16 v[118:119], v12 offset:4608
    ds_read_b64_tr_b16 v[120:121], v13 offset:4096
    ds_read_b64_tr_b16 v[122:123], v13 offset:4608
    ds_read_b64_tr_b16 v[124:125], v14 offset:4096
    ds_read_b64_tr_b16 v[126:127], v14 offset:4608
    ds_read_b64_tr_b16 v[128:129], v11 offset:8192
    ds_read_b64_tr_b16 v[130:131], v11 offset:8704
    ds_read_b64_tr_b16 v[132:133], v12 offset:8192
    ds_read_b64_tr_b16 v[134:135], v12 offset:8704
    ds_read_b64_tr_b16 v[136:137], v13 offset:8192
    ds_read_b64_tr_b16 v[138:139], v13 offset:8704
    s_waitcnt vmcnt(7)
    v_mfma_f32_16x16x32_bf16 a[0:3], a[128:131], a[64:67], 0
    ds_read_b64_tr_b16 v[140:141], v14 offset:8192
    buffer_load_dwordx4 a[84:87], v4, s[16:19], s86 offen offset:2048 sc1
    v_mfma_f32_16x16x32_bf16 a[4:7], a[132:135], a[64:67], 0
    ds_read_b64_tr_b16 v[142:143], v14 offset:8704
    v_mfma_f32_16x16x32_bf16 a[8:11], a[136:139], a[64:67], 0
    ds_read_b64_tr_b16 v[144:145], v11 offset:12288
    v_mfma_f32_16x16x32_bf16 a[12:15], a[140:143], a[64:67], 0
    ds_read_b64_tr_b16 v[146:147], v11 offset:12800
    v_mfma_f32_16x16x32_bf16 a[28:31], a[140:143], a[68:71], 0
    ds_read_b64_tr_b16 v[148:149], v12 offset:12288
    v_mfma_f32_16x16x32_bf16 a[24:27], a[136:139], a[68:71], 0
    buffer_load_dwordx4 a[88:91], v5, s[16:19], s86 offen offset:2048 sc1
    v_mfma_f32_16x16x32_bf16 a[20:23], a[132:135], a[68:71], 0
    ds_read_b64_tr_b16 v[150:151], v12 offset:12800
    v_mfma_f32_16x16x32_bf16 a[16:19], a[128:131], a[68:71], 0
    ds_read_b64_tr_b16 v[152:153], v13 offset:12288
    ds_read_b64_tr_b16 v[154:155], v13 offset:12800
    ds_read_b64_tr_b16 v[156:157], v14 offset:12288
    ds_read_b64_tr_b16 v[158:159], v14 offset:12800
    ds_read_b64_tr_b16 v[160:161], v11 offset:16384
    ds_read_b64_tr_b16 v[162:163], v11 offset:16896
    ds_read_b64_tr_b16 v[164:165], v12 offset:16384
    ds_read_b64_tr_b16 v[166:167], v12 offset:16896
    ds_read_b64_tr_b16 v[168:169], v13 offset:16384
    ds_read_b64_tr_b16 v[170:171], v13 offset:16896
    buffer_load_dwordx4 a[92:95], v6, s[16:19], s86 offen offset:2048 sc1
    ds_read_b64_tr_b16 v[172:173], v14 offset:16384
    ds_read_b64_tr_b16 v[174:175], v14 offset:16896
    ds_read_b64_tr_b16 v[176:177], v11 offset:20480
    ds_read_b64_tr_b16 v[178:179], v11 offset:20992
    ds_read_b64_tr_b16 v[180:181], v12 offset:20480
    ds_read_b64_tr_b16 v[182:183], v12 offset:20992
    s_waitcnt vmcnt(8)
    v_mfma_f32_16x16x32_bf16 a[32:35], a[128:131], a[72:75], 0
    ds_read_b64_tr_b16 v[184:185], v13 offset:20480
    v_mfma_f32_16x16x32_bf16 a[36:39], a[132:135], a[72:75], 0
    ds_read_b64_tr_b16 v[186:187], v13 offset:20992
    v_mfma_f32_16x16x32_bf16 a[40:43], a[136:139], a[72:75], 0
    s_add_u32 s86, s86, 4096
    buffer_load_dwordx4 a[96:99], v3, s[16:19], s86 offen offset:0 sc1
    v_mfma_f32_16x16x32_bf16 a[44:47], a[140:143], a[72:75], 0
    ds_read_b64_tr_b16 v[188:189], v14 offset:20480
    v_mfma_f32_16x16x32_bf16 a[60:63], a[140:143], a[76:79], 0
    ds_read_b64_tr_b16 v[190:191], v14 offset:20992
    v_mfma_f32_16x16x32_bf16 a[56:59], a[136:139], a[76:79], 0
    ds_read_b64_tr_b16 v[192:193], v11 offset:24576
    v_mfma_f32_16x16x32_bf16 a[52:55], a[132:135], a[76:79], 0
    ds_read_b64_tr_b16 v[194:195], v11 offset:25088
    v_mfma_f32_16x16x32_bf16 a[48:51], a[128:131], a[76:79], 0
    buffer_load_dwordx4 a[100:103], v4, s[16:19], s86 offen offset:0 sc1
    ds_read_b64_tr_b16 a[128:129], v20 offset:32768
    ds_read_b64_tr_b16 a[130:131], v20 offset:33280
    ds_read_b64_tr_b16 a[132:133], v21 offset:32768
    ds_read_b64_tr_b16 a[134:135], v21 offset:33280
    ds_read_b64_tr_b16 a[136:137], v22 offset:32768
    ds_read_b64_tr_b16 a[138:139], v22 offset:33280
    ds_read_b64_tr_b16 a[140:141], v23 offset:32768
    ds_read_b64_tr_b16 a[142:143], v23 offset:33280
    ds_read_b64_tr_b16 v[196:197], v12 offset:24576
    ds_read_b64_tr_b16 v[198:199], v12 offset:25088
    ds_read_b64_tr_b16 v[200:201], v13 offset:24576
    ds_read_b64_tr_b16 v[202:203], v13 offset:25088
    ds_read_b64_tr_b16 v[204:205], v14 offset:24576
    ds_read_b64_tr_b16 v[206:207], v14 offset:25088
    ds_read_b64_tr_b16 v[208:209], v11 offset:28672
L_pad_ffn_3:
    s_cbranch_execz L_ret_ffn
    ds_read_b64_tr_b16 v[210:211], v11 offset:29184
    buffer_load_dwordx4 a[104:107], v5, s[16:19], s86 offen offset:0 sc1
    ds_read_b64_tr_b16 v[212:213], v12 offset:28672
    ds_read_b64_tr_b16 v[214:215], v12 offset:29184
    ds_read_b64_tr_b16 v[216:217], v13 offset:28672
    ds_read_b64_tr_b16 v[218:219], v13 offset:29184
    ds_read_b64_tr_b16 v[220:221], v14 offset:28672
    ds_read_b64_tr_b16 v[222:223], v14 offset:29184
    v_add_u32 v11, -131072, v11
    v_add_u32 v12, -131072, v12
    v_add_u32 v13, -131072, v13
    v_add_u32 v14, -131072, v14
    ds_read_b64_tr_b16 v[224:225], v11 offset:0
    ds_read_b64_tr_b16 v[226:227], v11 offset:512
    ds_read_b64_tr_b16 v[228:229], v12 offset:0
    ds_read_b64_tr_b16 v[230:231], v12 offset:512
    ds_read_b64_tr_b16 v[232:233], v13 offset:0
    ds_read_b64_tr_b16 v[234:235], v13 offset:512
    buffer_load_dwordx4 a[108:111], v6, s[16:19], s86 offen offset:0 sc1
    ds_read_b64_tr_b16 v[236:237], v14 offset:0
    ds_read_b64_tr_b16 v[238:239], v14 offset:512
    ds_read_b64_tr_b16 v[240:241], v11 offset:4096
    s_waitcnt vmcnt(8)
    s_mov_b64 exec, 1
    buffer_store_dwordx2 v[8:9], v33, s[16:19], s73 offen sc1
    s_mov_b64 exec, -1
    ds_read_b64_tr_b16 v[242:243], v11 offset:4608
    ds_read_b64_tr_b16 v[244:245], v12 offset:4096
    ds_read_b64_tr_b16 v[246:247], v12 offset:4608
    ds_read_b64_tr_b16 v[248:249], v13 offset:4096
    ds_read_b64_tr_b16 v[250:251], v13 offset:4608
    ds_read_b64_tr_b16 v[252:253], v14 offset:4096
    ds_read_b64_tr_b16 v[254:255], v14 offset:4608
    buffer_load_dwordx4 a[112:115], v3, s[16:19], s86 offen offset:2048 sc1
    buffer_load_dwordx4 a[116:119], v4, s[16:19], s86 offen offset:2048 sc1
    s_waitcnt vmcnt(9)
    v_mfma_f32_16x16x32_bf16 a[0:3], a[144:147], a[80:83], a[0:3]
    v_mfma_f32_16x16x32_bf16 a[4:7], a[148:151], a[80:83], a[4:7]
    v_mfma_f32_16x16x32_bf16 a[8:11], a[152:155], a[80:83], a[8:11]
    v_mfma_f32_16x16x32_bf16 a[12:15], a[156:159], a[80:83], a[12:15]
    v_mfma_f32_16x16x32_bf16 a[28:31], a[156:159], a[84:87], a[28:31]
    buffer_load_dwordx4 a[120:123], v5, s[16:19], s86 offen offset:2048 sc1
    v_mfma_f32_16x16x32_bf16 a[24:27], a[152:155], a[84:87], a[24:27]
    v_mfma_f32_16x16x32_bf16 a[20:23], a[148:151], a[84:87], a[20:23]
    v_mfma_f32_16x16x32_bf16 a[16:19], a[144:147], a[84:87], a[16:19]
    buffer_load_dwordx4 a[124:127], v6, s[16:19], s86 offen offset:2048 sc1
    s_waitcnt vmcnt(9)
    v_mfma_f32_16x16x32_bf16 a[32:35], a[144:147], a[88:91], a[32:35]
    v_mfma_f32_16x16x32_bf16 a[36:39], a[148:151], a[88:91], a[36:39]
    v_mfma_f32_16x16x32_bf16 a[40:43], a[152:155], a[88:91], a[40:43]
    v_mfma_f32_16x16x32_bf16 a[44:47], a[156:159], a[88:91], a[44:47]
    v_mfma_f32_16x16x32_bf16 a[60:63], a[156:159], a[92:95], a[60:63]
    buffer_load_dwordx4 a[64:67], v3, s[16:19], s87 offen offset:0 sc1
    v_mfma_f32_16x16x32_bf16 a[56:59], a[152:155], a[92:95], a[56:59]
    v_mfma_f32_16x16x32_bf16 a[52:55], a[148:151], a[92:95], a[52:55]
    v_mfma_f32_16x16x32_bf16 a[48:51], a[144:147], a[92:95], a[48:51]
    ds_read_b64_tr_b16 a[144:145], v20 offset:36864
    ds_read_b64_tr_b16 a[146:147], v20 offset:37376
    ds_read_b64_tr_b16 a[148:149], v21 offset:36864
    ds_read_b64_tr_b16 a[150:151], v21 offset:37376
    ds_read_b64_tr_b16 a[152:153], v22 offset:36864
    s_waitcnt vmcnt(8)
    v_mfma_f32_16x16x32_bf16 a[0:3], a[160:163], a[96:99], a[0:3]
    buffer_load_dwordx4 a[68:71], v4, s[16:19], s87 offen offset:0 sc1
    v_mfma_f32_16x16x32_bf16 a[4:7], a[164:167], a[96:99], a[4:7]
    ds_read_b64_tr_b16 a[154:155], v22 offset:37376
    v_mfma_f32_16x16x32_bf16 a[8:11], a[168:171], a[96:99], a[8:11]
    ds_read_b64_tr_b16 a[156:157], v23 offset:36864
    v_mfma_f32_16x16x32_bf16 a[12:15], a[172:175], a[96:99], a[12:15]
    ds_read_b64_tr_b16 a[158:159], v23 offset:37376
    v_mfma_f32_16x16x32_bf16 a[28:31], a[172:175], a[100:103], a[28:31]
    v_mfma_f32_16x16x32_bf16 a[24:27], a[168:171], a[100:103], a[24:27]
    buffer_load_dwordx4 a[72:75], v5, s[16:19], s87 offen offset:0 sc1
    v_mfma_f32_16x16x32_bf16 a[20:23], a[164:167], a[100:103], a[20:23]
    v_mfma_f32_16x16x32_bf16 a[16:19], a[160:163], a[100:103], a[16:19]
    buffer_load_dwordx4 a[76:79], v6, s[16:19], s87 offen offset:0 sc1
    s_waitcnt vmcnt(9)
    v_mfma_f32_16x16x32_bf16 a[32:35], a[160:163], a[104:107], a[32:35]
    buffer_load_dwordx2 v[30:31], v32, s[16:19], s68 offen offset:256 sc1
    v_mfma_f32_16x16x32_bf16 a[36:39], a[164:167], a[104:107], a[36:39]
    v_mfma_f32_16x16x32_bf16 a[40:43], a[168:171], a[104:107], a[40:43]
    v_mfma_f32_16x16x32_bf16 a[44:47], a[172:175], a[104:107], a[44:47]
    v_mfma_f32_16x16x32_bf16 a[60:63], a[172:175], a[108:111], a[60:63]
    v_mfma_f32_16x16x32_bf16 a[56:59], a[168:171], a[108:111], a[56:59]
    buffer_load_dwordx4 a[80:83], v3, s[16:19], s87 offen offset:2048 sc1
    v_mfma_f32_16x16x32_bf16 a[52:55], a[164:167], a[108:111], a[52:55]
    v_mfma_f32_16x16x32_bf16 a[48:51], a[160:163], a[108:111], a[48:51]
    s_add_u32 s97, s92, 65536
    v_add_u32 v20, s97, v20
    s_waitcnt vmcnt(8)
    v_mfma_f32_16x16x32_bf16 a[0:3], a[176:179], a[112:115], a[0:3]
    v_add_u32 v21, s97, v21
    v_add_u32 v22, s97, v22
    v_mfma_f32_16x16x32_bf16 a[4:7], a[180:183], a[112:115], a[4:7]
    v_add_u32_e64 v23, s97, v23
    v_mfma_f32_16x16x32_bf16 a[8:11], a[184:187], a[112:115], a[8:11]
    buffer_load_dwordx4 a[84:87], v4, s[16:19], s87 offen offset:2048 sc1
    v_mfma_f32_16x16x32_bf16 a[12:15], a[188:191], a[112:115], a[12:15]
    ds_read_b64_tr_b16 a[160:161], v20 offset:0
    v_mfma_f32_16x16x32_bf16 a[28:31], a[188:191], a[116:119], a[28:31]
    ds_read_b64_tr_b16 a[162:163], v20 offset:512
    v_mfma_f32_16x16x32_bf16 a[24:27], a[184:187], a[116:119], a[24:27]
    ds_read_b64_tr_b16 a[164:165], v21 offset:0
    v_mfma_f32_16x16x32_bf16 a[20:23], a[180:183], a[116:119], a[20:23]
    ds_read_b64_tr_b16 a[166:167], v21 offset:512
    v_mfma_f32_16x16x32_bf16 a[16:19], a[176:179], a[116:119], a[16:19]
    buffer_load_dwordx4 a[88:91], v5, s[16:19], s87 offen offset:2048 sc1
    s_waitcnt vmcnt(8)
    v_mfma_f32_16x16x32_bf16 a[32:35], a[176:179], a[120:123], a[32:35]
    ds_read_b64_tr_b16 a[168:169], v22 offset:0
    v_mfma_f32_16x16x32_bf16 a[36:39], a[180:183], a[120:123], a[36:39]
    ds_read_b64_tr_b16 a[170:171], v22 offset:512
    v_mfma_f32_16x16x32_bf16 a[40:43], a[184:187], a[120:123], a[40:43]
    ds_read_b64_tr_b16 a[172:173], v23 offset:0
    v_mfma_f32_16x16x32_bf16 a[44:47], a[188:191], a[120:123], a[44:47]
    ds_read_b64_tr_b16 a[174:175], v23 offset:512
    v_lshrrev_b32 v16, 4, v0
    v_mfma_f32_16x16x32_bf16 a[60:63], a[188:191], a[124:127], a[60:63]
    buffer_load_dwordx4 a[92:95], v6, s[16:19], s87 offen offset:2048 sc1
    v_and_b32 v17, 7, v0
    v_mfma_f32_16x16x32_bf16 a[56:59], a[184:187], a[124:127], a[56:59]
    v_xor_b32 v16, v16, v17
    v_and_b32 v34, 0xf0, v1
    v_mfma_f32_16x16x32_bf16 a[52:55], a[180:183], a[124:127], a[52:55]
    v_add_lshl_u32 v16, v34, v16, 4
    s_add_u32 s70, s93, 65536
    v_mfma_f32_16x16x32_bf16 a[48:51], a[176:179], a[124:127], a[48:51]
    ds_read_b64_tr_b16 a[176:177], v11 offset:8192
    v_add_u32 v34, s70, v16
    s_waitcnt vmcnt(7)
    v_mfma_f32_16x16x32_bf16 a[0:3], a[192:195], a[64:67], a[0:3]
    s_add_u32 s87, s87, 4096
    buffer_load_dwordx4 a[96:99], v3, s[16:19], s87 offen offset:0 sc1
    v_mfma_f32_16x16x32_bf16 a[4:7], a[196:199], a[64:67], a[4:7]
    ds_read_b64_tr_b16 a[178:179], v11 offset:8704
    v_xor_b32_e64 v35, 64, v34
    v_mfma_f32_16x16x32_bf16 a[8:11], a[200:203], a[64:67], a[8:11]
    ds_read_b64_tr_b16 a[180:181], v12 offset:8192
    v_lshrrev_b32_e64 v16, 3, v0
    v_mfma_f32_16x16x32_bf16 a[12:15], a[204:207], a[64:67], a[12:15]
    ds_read_b64_tr_b16 a[182:183], v12 offset:8704
    v_lshlrev_b32 v17, 1, v17
    v_mfma_f32_16x16x32_bf16 a[28:31], a[204:207], a[68:71], a[28:31]
    ds_read_b64_tr_b16 a[184:185], v13 offset:8192
    v_xor_b32 v17, v17, v16
    v_mfma_f32_16x16x32_bf16 a[24:27], a[200:203], a[68:71], a[24:27]
    buffer_load_dwordx4 a[100:103], v4, s[16:19], s87 offen offset:0 sc1
    v_lshlrev_b32_e64 v17, 4, v17
    v_mfma_f32_16x16x32_bf16 a[20:23], a[196:199], a[68:71], a[20:23]
    ds_read_b64_tr_b16 a[186:187], v13 offset:8704
    v_lshl_add_u32 v16, v16, 8, v17
    v_mfma_f32_16x16x32_bf16 a[16:19], a[192:195], a[68:71], a[16:19]
    ds_read_b64_tr_b16 a[188:189], v14 offset:8192
    v_add_u32 v16, s70, v16
    s_waitcnt vmcnt(7)
    v_mfma_f32_16x16x32_bf16 a[32:35], a[192:195], a[72:75], a[32:35]
    ds_read_b64_tr_b16 a[190:191], v14 offset:8704
    v_xor_b32 v24, 16384, v16
    v_mfma_f32_16x16x32_bf16 a[36:39], a[196:199], a[72:75], a[36:39]
    v_xor_b32 v25, 16400, v16
    v_xor_b32 v26, 36864, v16
    v_mfma_f32_16x16x32_bf16 a[40:43], a[200:203], a[72:75], a[40:43]
    buffer_load_dwordx4 a[104:107], v5, s[16:19], s87 offen offset:0 sc1
    v_xor_b32 v27, 36880, v16
    v_mfma_f32_16x16x32_bf16 a[44:47], a[204:207], a[72:75], a[44:47]
    v_xor_b32 v18, 57344, v16
    v_xor_b32 v19, 57360, v16
    v_mfma_f32_16x16x32_bf16 a[60:63], a[204:207], a[76:79], a[60:63]
    v_xor_b32 v15, 12288, v16
    v_xor_b32 v2, 12304, v16
    v_mfma_f32_16x16x32_bf16 a[56:59], a[200:203], a[76:79], a[56:59]
    v_lshlrev_b32 v48, 16, v36
    v_and_b32 v49, 0xffff0000, v36
    v_mfma_f32_16x16x32_bf16 a[52:55], a[196:199], a[76:79], a[52:55]
    v_lshlrev_b32 v50, 16, v37
    v_and_b32 v51, 0xffff0000, v37
    v_mfma_f32_16x16x32_bf16 a[48:51], a[192:195], a[76:79], a[48:51]
    buffer_load_dwordx4 a[108:111], v6, s[16:19], s87 offen offset:0 sc1
    v_lshlrev_b32 v52, 16, v38
    s_waitcnt vmcnt(8)
    v_cmp_ne_u64 vcc, v[30:31], v[8:9]
    s_nop 1
    s_cbranch_vccnz L_retry_29
L_ok_31:
    v_lshrrev_b32_e64 v32, 1, v10
    s_and_b32 s68, s68, 0xffffff3f
    s_waitcnt vmcnt(6)
    v_mfma_f32_16x16x32_bf16 a[0:3], a[208:211], a[80:83], a[0:3]
    ds_read_b64_tr_b16 a[192:193], v11 offset:12288
    v_and_b32 v53, 0xffff0000, v38
    v_mfma_f32_16x16x32_bf16 a[4:7], a[212:215], a[80:83], a[4:7]
    ds_read_b64_tr_b16 a[194:195], v11 offset:12800
    v_lshlrev_b32_e64 v54, 16, v39
    v_mfma_f32_16x16x32_bf16 a[8:11], a[216:219], a[80:83], a[8:11]
    buffer_load_dwordx4 a[112:115], v3, s[16:19], s87 offen offset:2048 sc1
    v_and_b32 v55, 0xffff0000, v39
    v_mfma_f32_16x16x32_bf16 a[12:15], a[220:223], a[80:83], a[12:15]
    ds_read_b64_tr_b16 a[196:197], v12 offset:12288
    v_lshlrev_b32_e64 v56, 16, v40
    v_mfma_f32_16x16x32_bf16 a[28:31], a[220:223], a[84:87], a[28:31]
    ds_read_b64_tr_b16 a[198:199], v12 offset:12800
    v_and_b32 v57, 0xffff0000, v40
    v_mfma_f32_16x16x32_bf16 a[24:27], a[216:219], a[84:87], a[24:27]
    ds_read_b64_tr_b16 a[200:201], v13 offset:12288
    v_lshlrev_b32_e64 v58, 16, v41
    v_mfma_f32_16x16x32_bf16 a[20:23], a[212:215], a[84:87], a[20:23]
    ds_read_b64_tr_b16 a[202:203], v13 offset:12800
    v_and_b32 v59, 0xffff0000, v41
    v_mfma_f32_16x16x32_bf16 a[16:19], a[208:211], a[84:87], a[16:19]
    buffer_load_dwordx4 a[116:119], v4, s[16:19], s87 offen offset:2048 sc1
    v_lshlrev_b32 v60, 16, v42
    s_waitcnt vmcnt(6)
    v_mfma_f32_16x16x32_bf16 a[32:35], a[208:211], a[88:91], a[32:35]
    ds_read_b64_tr_b16 a[204:205], v14 offset:12288
    v_and_b32 v61, 0xffff0000, v42
    v_mfma_f32_16x16x32_bf16 a[36:39], a[212:215], a[88:91], a[36:39]
    ds_read_b64_tr_b16 a[206:207], v14 offset:12800
    v_lshlrev_b32_e64 v62, 16, v43
    v_mfma_f32_16x16x32_bf16 a[40:43], a[216:219], a[88:91], a[40:43]
    buffer_load_dwordx4 a[120:123], v5, s[16:19], s87 offen offset:2048 sc1
    v_and_b32 v63, 0xffff0000, v43
    v_mfma_f32_16x16x32_bf16 a[44:47], a[220:223], a[88:91], a[44:47]
    v_lshlrev_b32_e64 v16, 16, v44
    v_and_b32 v17, 0xffff0000, v44
    v_mfma_f32_16x16x32_bf16 a[60:63], a[220:223], a[92:95], a[60:63]
    v_add_f32 v48, v48, v16
    v_add_f32 v49, v49, v17
    v_mfma_f32_16x16x32_bf16 a[56:59], a[216:219], a[92:95], a[56:59]
    v_add_f32 v56, v56, v16
    v_add_f32 v57, v57, v17
    v_mfma_f32_16x16x32_bf16 a[52:55], a[212:215], a[92:95], a[52:55]
    v_lshlrev_b32_e64 v16, 16, v45
    v_and_b32 v17, 0xffff0000, v45
    v_mfma_f32_16x16x32_bf16 a[48:51], a[208:211], a[92:95], a[48:51]
    buffer_load_dwordx4 a[124:127], v6, s[16:19], s87 offen offset:2048 sc1
    v_add_f32 v50, v50, v16
    s_waitcnt vmcnt(6)
    v_mfma_f32_16x16x32_bf16 a[0:3], a[224:227], a[96:99], a[0:3]
    buffer_load_dwordx2 v[30:31], v32, s[16:19], s68 offen offset:512 sc1
    v_mfma_f32_16x16x32_bf16 a[4:7], a[228:231], a[96:99], a[4:7]
    ds_read_b64_tr_b16 a[208:209], v11 offset:16384
    v_add_f32_e64 v51, v51, v17
    v_mfma_f32_16x16x32_bf16 a[8:11], a[232:235], a[96:99], a[8:11]
    ds_read_b64_tr_b16 a[210:211], v11 offset:16896
    v_add_f32 v58, v58, v16
    v_mfma_f32_16x16x32_bf16 a[12:15], a[236:239], a[96:99], a[12:15]
    ds_read_b64_tr_b16 a[212:213], v12 offset:16384
    v_add_f32 v59, v59, v17
    v_mfma_f32_16x16x32_bf16 a[28:31], a[236:239], a[100:103], a[28:31]
    ds_read_b64_tr_b16 a[214:215], v12 offset:16896
    v_lshlrev_b32_e64 v16, 16, v46
    v_mfma_f32_16x16x32_bf16 a[24:27], a[232:235], a[100:103], a[24:27]
    buffer_load_dwordx4 a[64:67], v3, s[16:19], s88 offen offset:0 sc1
    v_and_b32 v17, 0xffff0000, v46
    v_mfma_f32_16x16x32_bf16 a[20:23], a[228:231], a[100:103], a[20:23]
    ds_read_b64_tr_b16 a[216:217], v13 offset:16384
    v_add_f32 v52, v52, v16
    v_mfma_f32_16x16x32_bf16 a[16:19], a[224:227], a[100:103], a[16:19]
    ds_read_b64_tr_b16 a[218:219], v13 offset:16896
    v_add_f32_e64 v53, v53, v17
    s_waitcnt vmcnt(6)
    v_mfma_f32_16x16x32_bf16 a[32:35], a[224:227], a[104:107], a[32:35]
    ds_read_b64_tr_b16 a[220:221], v14 offset:16384
    v_add_f32_e64 v60, v60, v16
    v_mfma_f32_16x16x32_bf16 a[36:39], a[228:231], a[104:107], a[36:39]
    buffer_load_dwordx4 a[68:71], v4, s[16:19], s88 offen offset:0 sc1
    v_add_f32 v61, v61, v17
    v_mfma_f32_16x16x32_bf16 a[40:43], a[232:235], a[104:107], a[40:43]
    ds_read_b64_tr_b16 a[222:223], v14 offset:16896
    v_lshlrev_b32 v16, 16, v47
    v_mfma_f32_16x16x32_bf16 a[44:47], a[236:239], a[104:107], a[44:47]
    v_and_b32 v17, 0xffff0000, v47
    v_add_f32 v54, v54, v16
    v_mfma_f32_16x16x32_bf16 a[60:63], a[236:239], a[108:111], a[60:63]
    v_add_f32 v55, v55, v17
    v_add_f32_e64 v62, v62, v16
    v_mfma_f32_16x16x32_bf16 a[56:59], a[232:235], a[108:111], a[56:59]
    v_add_f32_e64 v63, v63, v17
    s_add_u32 s71, s91, 0x2000
    v_mfma_f32_16x16x32_bf16 a[52:55], a[228:231], a[108:111], a[52:55]
    buffer_load_dwordx4 a[72:75], v5, s[16:19], s88 offen offset:0 sc1
    v_mfma_f32_16x16x32_bf16 a[48:51], a[224:227], a[108:111], a[48:51]
    ds_read_b64_tr_b16 a[224:225], v11 offset:20480
    s_waitcnt vmcnt(6)
    v_mfma_f32_16x16x32_bf16 a[0:3], a[240:243], a[112:115], a[0:3]
    ds_read_b64_tr_b16 a[226:227], v11 offset:20992
    v_mfma_f32_16x16x32_bf16 a[4:7], a[244:247], a[112:115], a[4:7]
    buffer_load_dwordx4 a[76:79], v6, s[16:19], s88 offen offset:0 sc1
    v_mfma_f32_16x16x32_bf16 a[8:11], a[248:251], a[112:115], a[8:11]
    ds_read_b64_tr_b16 a[228:229], v12 offset:20480
    v_mfma_f32_16x16x32_bf16 a[12:15], a[252:255], a[112:115], a[12:15]
    ds_read_b64_tr_b16 a[230:231], v12 offset:20992
    v_mfma_f32_16x16x32_bf16 a[28:31], a[252:255], a[116:119], a[28:31]
    ds_read_b64_tr_b16 a[232:233], v13 offset:20480
    v_mfma_f32_16x16x32_bf16 a[24:27], a[248:251], a[116:119], a[24:27]
    ds_read_b64_tr_b16 a[234:235], v13 offset:20992
    v_mfma_f32_16x16x32_bf16 a[20:23], a[244:247], a[116:119], a[20:23]
    buffer_load_dwordx4 a[80:83], v3, s[16:19], s89 offen offset:0 sc1
    v_mfma_f32_16x16x32_bf16 a[16:19], a[240:243], a[116:119], a[16:19]
    ds_read_b64_tr_b16 a[236:237], v14 offset:20480
    s_waitcnt vmcnt(6)
    v_mfma_f32_16x16x32_bf16 a[32:35], a[240:243], a[120:123], a[32:35]
    ds_read_b64_tr_b16 a[238:239], v14 offset:20992
    v_mfma_f32_16x16x32_bf16 a[36:39], a[244:247], a[120:123], a[36:39]
    buffer_load_dwordx4 a[84:87], v4, s[16:19], s89 offen offset:0 sc1
    v_mfma_f32_16x16x32_bf16 a[40:43], a[248:251], a[120:123], a[40:43]
    v_mfma_f32_16x16x32_bf16 a[44:47], a[252:255], a[120:123], a[44:47]
    v_mfma_f32_16x16x32_bf16 a[60:63], a[252:255], a[124:127], a[60:63]
    v_mfma_f32_16x16x32_bf16 a[56:59], a[248:251], a[124:127], a[56:59]
    v_mfma_f32_16x16x32_bf16 a[52:55], a[244:247], a[124:127], a[52:55]
    buffer_load_dwordx4 a[88:91], v5, s[16:19], s89 offen offset:0 sc1
    v_mfma_f32_16x16x32_bf16 a[48:51], a[240:243], a[124:127], a[48:51]
    ds_read_b64_tr_b16 a[240:241], v11 offset:24576
    ds_read_b64_tr_b16 a[242:243], v11 offset:25088
    ds_read_b64_tr_b16 a[244:245], v12 offset:24576
    ds_read_b64_tr_b16 a[246:247], v12 offset:25088
    ds_read_b64_tr_b16 a[248:249], v13 offset:24576
    ds_read_b64_tr_b16 a[250:251], v13 offset:25088
    ds_read_b64_tr_b16 a[252:253], v14 offset:24576
    ds_read_b64_tr_b16 a[254:255], v14 offset:25088
    buffer_load_dwordx4 a[92:95], v6, s[16:19], s89 offen offset:0 sc1
    s_waitcnt vmcnt(8)
    v_cmp_ne_u64 vcc, v[30:31], v[8:9]
    s_nop 1
    s_cbranch_vccnz L_retry_32
L_ok_34:
    s_waitcnt lgkmcnt(15)
    s_waitcnt vmcnt(6)
    v_mfma_f32_16x16x32_bf16 a[0:3], a[128:131], a[64:67], a[0:3]
    v_mfma_f32_16x16x32_bf16 a[4:7], a[132:135], a[64:67], a[4:7]
    s_cmp_eq_u32 s90, 88064
    s_cselect_b32 s90, 0x20000000, s90
    buffer_load_dwordx4 a[96:99], v3, s[16:19], s90 offen offset:0 sc1
    v_mfma_f32_16x16x32_bf16 a[8:11], a[136:139], a[64:67], a[8:11]
    v_mfma_f32_16x16x32_bf16 a[12:15], a[140:143], a[64:67], a[12:15]
    v_mfma_f32_16x16x32_bf16 a[28:31], a[140:143], a[68:71], a[28:31]
    v_mfma_f32_16x16x32_bf16 a[24:27], a[136:139], a[68:71], a[24:27]
    v_mfma_f32_16x16x32_bf16 a[20:23], a[132:135], a[68:71], a[20:23]
    buffer_load_dwordx4 a[100:103], v4, s[16:19], s90 offen offset:0 sc1
    v_mfma_f32_16x16x32_bf16 a[16:19], a[128:131], a[68:71], a[16:19]
    s_waitcnt vmcnt(6)
    v_mfma_f32_16x16x32_bf16 a[32:35], a[128:131], a[72:75], a[32:35]
    v_mfma_f32_16x16x32_bf16 a[36:39], a[132:135], a[72:75], a[36:39]
    buffer_load_dwordx4 a[104:107], v5, s[16:19], s90 offen offset:0 sc1
    v_mfma_f32_16x16x32_bf16 a[40:43], a[136:139], a[72:75], a[40:43]
    v_mfma_f32_16x16x32_bf16 a[44:47], a[140:143], a[72:75], a[44:47]
    v_mfma_f32_16x16x32_bf16 a[60:63], a[140:143], a[76:79], a[60:63]
    v_mfma_f32_16x16x32_bf16 a[56:59], a[136:139], a[76:79], a[56:59]
    v_mfma_f32_16x16x32_bf16 a[52:55], a[132:135], a[76:79], a[52:55]
    buffer_load_dwordx4 a[108:111], v6, s[16:19], s90 offen offset:0 sc1
    v_mfma_f32_16x16x32_bf16 a[48:51], a[128:131], a[76:79], a[48:51]
    ds_read_b64_tr_b16 a[128:129], v11 offset:28672
    s_waitcnt vmcnt(6)
    v_mfma_f32_16x16x32_bf16 a[0:3], a[144:147], a[80:83], a[0:3]
    ds_read_b64_tr_b16 a[130:131], v11 offset:29184
    v_mfma_f32_16x16x32_bf16 a[4:7], a[148:151], a[80:83], a[4:7]
    s_mov_b32 s0, 88064
    buffer_load_dwordx4 a[112:115], v3, s[16:19], s0 offen offset:0 sc1
    v_mfma_f32_16x16x32_bf16 a[8:11], a[152:155], a[80:83], a[8:11]
    ds_read_b64_tr_b16 a[132:133], v12 offset:28672
    v_mfma_f32_16x16x32_bf16 a[12:15], a[156:159], a[80:83], a[12:15]
    ds_read_b64_tr_b16 a[134:135], v12 offset:29184
    v_mfma_f32_16x16x32_bf16 a[28:31], a[156:159], a[84:87], a[28:31]
    ds_read_b64_tr_b16 a[136:137], v13 offset:28672
    v_mfma_f32_16x16x32_bf16 a[24:27], a[152:155], a[84:87], a[24:27]
    ds_read_b64_tr_b16 a[138:139], v13 offset:29184
    v_mfma_f32_16x16x32_bf16 a[20:23], a[148:151], a[84:87], a[20:23]
    buffer_load_dwordx4 a[116:119], v3, s[16:19], s0 offen offset:2048 sc1
    v_mfma_f32_16x16x32_bf16 a[16:19], a[144:147], a[84:87], a[16:19]
    ds_read_b64_tr_b16 a[140:141], v14 offset:28672
    s_waitcnt vmcnt(6)
    v_mfma_f32_16x16x32_bf16 a[32:35], a[144:147], a[88:91], a[32:35]
    ds_read_b64_tr_b16 a[142:143], v14 offset:29184
    v_mfma_f32_16x16x32_bf16 a[36:39], a[148:151], a[88:91], a[36:39]
    v_mfma_f32_16x16x32_bf16 a[40:43], a[152:155], a[88:91], a[40:43]
    s_mov_b32 s0, 96256
    buffer_load_dwordx4 a[120:123], v3, s[16:19], s0 offen offset:0 sc1
    v_mfma_f32_16x16x32_bf16 a[44:47], a[156:159], a[88:91], a[44:47]
    v_mfma_f32_16x16x32_bf16 a[60:63], a[156:159], a[92:95], a[60:63]
    v_mfma_f32_16x16x32_bf16 a[56:59], a[152:155], a[92:95], a[56:59]
    v_mfma_f32_16x16x32_bf16 a[52:55], a[148:151], a[92:95], a[52:55]
    v_mfma_f32_16x16x32_bf16 a[48:51], a[144:147], a[92:95], a[48:51]
    buffer_load_dwordx4 a[124:127], v3, s[16:19], s0 offen offset:2048 sc1
    s_waitcnt vmcnt(5)
    v_mfma_f32_16x16x32_bf16 a[16:19], a[160:163], a[100:103], a[16:19]
    s_mov_b32 s0, 104448
    buffer_load_dwordx4 a[64:67], v3, s[16:19], s0 offen offset:0 sc1
    v_mfma_f32_16x16x32_bf16 a[20:23], a[164:167], a[100:103], a[20:23]
    v_mfma_f32_16x16x32_bf16 a[24:27], a[168:171], a[100:103], a[24:27]
    v_mfma_f32_16x16x32_bf16 a[28:31], a[172:175], a[100:103], a[28:31]
    s_nop 1
    v_mfma_f32_16x16x32_bf16 a[44:47], a[172:175], a[104:107], a[44:47]
    ds_write_b128 v34, a[16:19] offset:0
    s_nop 0
    v_mfma_f32_16x16x32_bf16 a[40:43], a[168:171], a[104:107], a[40:43]
    buffer_load_dwordx4 a[68:71], v3, s[16:19], s0 offen offset:2048 sc1
    v_mfma_f32_16x16x32_bf16 a[36:39], a[164:167], a[104:107], a[36:39]
    v_mfma_f32_16x16x32_bf16 a[32:35], a[160:163], a[104:107], a[32:35]
    ds_write_b128 v35, a[20:23] offset:0
    s_waitcnt vmcnt(6)
    v_mfma_f32_16x16x32_bf16 a[48:51], a[160:163], a[108:111], a[48:51]
    v_mfma_f32_16x16x32_bf16 a[52:55], a[164:167], a[108:111], a[52:55]
    s_mov_b32 s0, 112640
    buffer_load_dwordx4 a[72:75], v3, s[16:19], s0 offen offset:0 sc1
    v_mfma_f32_16x16x32_bf16 a[56:59], a[168:171], a[108:111], a[56:59]
    ds_write_b128 v34, a[24:27] offset:128
    v_mfma_f32_16x16x32_bf16 a[60:63], a[172:175], a[108:111], a[60:63]
    v_mfma_f32_16x16x32_bf16 a[12:15], a[172:175], a[96:99], a[12:15]
    v_mfma_f32_16x16x32_bf16 a[8:11], a[168:171], a[96:99], a[8:11]
    ds_write_b128 v35, a[28:31] offset:128
    buffer_load_dwordx4 a[76:79], v3, s[16:19], s0 offen offset:2048 sc1
    v_mfma_f32_16x16x32_bf16 a[4:7], a[164:167], a[96:99], a[4:7]
    v_mfma_f32_16x16x32_bf16 a[0:3], a[160:163], a[96:99], a[0:3]
    s_waitcnt vmcnt(6)
    v_mfma_f32_16x16x32_bf16 a[0:3], v[96:99], a[112:115], a[0:3]
    ds_write_b128 v34, a[32:35] offset:4096
    v_mfma_f32_16x16x32_bf16 a[4:7], v[100:103], a[112:115], a[4:7]
    v_mfma_f32_16x16x32_bf16 a[8:11], v[104:107], a[112:115], a[8:11]
    s_mov_b32 s0, 92160
    buffer_load_dwordx4 a[80:83], v3, s[16:19], s0 offen offset:0 sc1
    v_mfma_f32_16x16x32_bf16 a[12:15], v[108:111], a[112:115], a[12:15]
    ds_write_b128 v35, a[36:39] offset:4096
    v_mfma_f32_16x16x32_bf16 a[0:3], v[112:115], a[116:119], a[0:3]
    v_mfma_f32_16x16x32_bf16 a[4:7], v[116:119], a[116:119], a[4:7]
    v_mfma_f32_16x16x32_bf16 a[8:11], v[120:123], a[116:119], a[8:11]
    ds_write_b128 v34, a[40:43] offset:4224
    buffer_load_dwordx4 a[84:87], v3, s[16:19], s0 offen offset:2048 sc1
    v_mfma_f32_16x16x32_bf16 a[12:15], v[124:127], a[116:119], a[12:15]
    s_waitcnt vmcnt(6)
    v_mfma_f32_16x16x32_bf16 a[0:3], v[128:131], a[120:123], a[0:3]
    v_mfma_f32_16x16x32_bf16 a[4:7], v[132:135], a[120:123], a[4:7]
    ds_write_b128 v35, a[44:47] offset:4224
    v_mfma_f32_16x16x32_bf16 a[8:11], v[136:139], a[120:123], a[8:11]
    v_mfma_f32_16x16x32_bf16 a[12:15], v[140:143], a[120:123], a[12:15]
    s_mov_b32 s0, 100352
    buffer_load_dwordx4 a[88:91], v3, s[16:19], s0 offen offset:0 sc1
    v_mfma_f32_16x16x32_bf16 a[0:3], v[144:147], a[124:127], a[0:3]
    ds_write_b128 v34, a[48:51] offset:8192
    v_mfma_f32_16x16x32_bf16 a[4:7], v[148:151], a[124:127], a[4:7]
    v_mfma_f32_16x16x32_bf16 a[8:11], v[152:155], a[124:127], a[8:11]
    v_mfma_f32_16x16x32_bf16 a[12:15], v[156:159], a[124:127], a[12:15]
    ds_write_b128 v35, a[52:55] offset:8192
    buffer_load_dwordx4 a[92:95], v3, s[16:19], s0 offen offset:2048 sc1
    s_waitcnt vmcnt(6)
    v_mfma_f32_16x16x32_bf16 a[0:3], v[160:163], a[64:67], a[0:3]
    ds_write_b128 v34, a[56:59] offset:8320
    v_mfma_f32_16x16x32_bf16 a[4:7], v[164:167], a[64:67], a[4:7]
    s_mov_b32 s0, 108544
    buffer_load_dwordx4 a[96:99], v3, s[16:19], s0 offen offset:0 sc1
    v_mfma_f32_16x16x32_bf16 a[8:11], v[168:171], a[64:67], a[8:11]
    v_mfma_f32_16x16x32_bf16 a[12:15], v[172:175], a[64:67], a[12:15]
    ds_write_b128 v35, a[60:63] offset:8320
    v_mfma_f32_16x16x32_bf16 a[0:3], v[176:179], a[68:71], a[0:3]
    v_mfma_f32_16x16x32_bf16 a[4:7], v[180:183], a[68:71], a[4:7]
    v_mfma_f32_16x16x32_bf16 a[8:11], v[184:187], a[68:71], a[8:11]
    buffer_load_dwordx4 a[100:103], v3, s[16:19], s0 offen offset:2048 sc1
    v_mfma_f32_16x16x32_bf16 a[12:15], v[188:191], a[68:71], a[12:15]
    s_waitcnt vmcnt(6)
    v_mfma_f32_16x16x32_bf16 a[0:3], v[192:195], a[72:75], a[0:3]
    s_waitcnt lgkmcnt(0)
    v_mfma_f32_16x16x32_bf16 a[4:7], v[196:199], a[72:75], a[4:7]
    s_mov_b32 s0, 116736
    buffer_load_dwordx4 a[104:107], v3, s[16:19], s0 offen offset:0 sc1
    v_mfma_f32_16x16x32_bf16 a[8:11], v[200:203], a[72:75], a[8:11]
    s_barrier
    v_mfma_f32_16x16x32_bf16 a[12:15], v[204:207], a[72:75], a[12:15]
    ds_read_b128 v[64:67], v24 offset:0
    v_mfma_f32_16x16x32_bf16 a[0:3], v[208:211], a[76:79], a[0:3]
    ds_read_b128 v[68:71], v25 offset:0
    v_mfma_f32_16x16x32_bf16 a[4:7], v[212:215], a[76:79], a[4:7]
    ds_read_b128 v[72:75], v24 offset:2048
    buffer_load_dwordx4 a[108:111], v3, s[16:19], s0 offen offset:2048 sc1
    v_mfma_f32_16x16x32_bf16 a[8:11], v[216:219], a[76:79], a[8:11]
    ds_read_b128 v[76:79], v25 offset:2048
    v_mfma_f32_16x16x32_bf16 a[12:15], v[220:223], a[76:79], a[12:15]
    ds_read_b128 v[80:83], v26 offset:0
    s_waitcnt vmcnt(6)
    v_mfma_f32_16x16x32_bf16 a[0:3], v[224:227], a[80:83], a[0:3]
    ds_read_b128 v[84:87], v27 offset:0
    v_mfma_f32_16x16x32_bf16 a[4:7], v[228:231], a[80:83], a[4:7]
    ds_read_b128 v[88:91], v26 offset:2048
    v_mfma_f32_16x16x32_bf16 a[8:11], v[232:235], a[80:83], a[8:11]
    ds_read_b128 v[92:95], v27 offset:2048
    v_mfma_f32_16x16x32_bf16 a[12:15], v[236:239], a[80:83], a[12:15]
    v_mfma_f32_16x16x32_bf16 a[0:3], v[240:243], a[84:87], a[0:3]
    v_mfma_f32_16x16x32_bf16 a[4:7], v[244:247], a[84:87], a[4:7]
    v_mfma_f32_16x16x32_bf16 a[8:11], v[248:251], a[84:87], a[8:11]
    s_waitcnt lgkmcnt(4)
    v_add_f32 v48, v48, v64
    v_mfma_f32_16x16x32_bf16 a[12:15], v[252:255], a[84:87], a[12:15]
    v_add_f32 v49, v49, v65
    v_add_f32_e64 v50, v50, v66
    s_waitcnt vmcnt(4)
    v_mfma_f32_16x16x32_bf16 a[0:3], a[176:179], a[88:91], a[0:3]
    v_add_f32 v51, v51, v67
    v_add_f32 v52, v52, v68
    v_mfma_f32_16x16x32_bf16 a[4:7], a[180:183], a[88:91], a[4:7]
    v_add_f32 v53, v53, v69
    v_add_f32 v54, v54, v70
    v_mfma_f32_16x16x32_bf16 a[8:11], a[184:187], a[88:91], a[8:11]
    v_add_f32 v55, v55, v71
    v_add_f32 v56, v56, v72
    v_mfma_f32_16x16x32_bf16 a[12:15], a[188:191], a[88:91], a[12:15]
    v_add_f32 v57, v57, v73
    v_add_f32 v58, v58, v74
    v_mfma_f32_16x16x32_bf16 a[0:3], a[192:195], a[92:95], a[0:3]
    v_add_f32 v59, v59, v75
    v_add_f32 v60, v60, v76
    v_mfma_f32_16x16x32_bf16 a[4:7], a[196:199], a[92:95], a[4:7]
    v_add_f32 v61, v61, v77
    v_add_f32 v62, v62, v78
    v_mfma_f32_16x16x32_bf16 a[8:11], a[200:203], a[92:95], a[8:11]
    v_add_f32 v63, v63, v79
    s_waitcnt lgkmcnt(0)
    v_mfma_f32_16x16x32_bf16 a[12:15], a[204:207], a[92:95], a[12:15]
    ds_read_b128 v[64:67], v18 offset:0
    v_add_f32 v48, v48, v80
    s_waitcnt vmcnt(3)
    v_mfma_f32_16x16x32_bf16 a[0:3], a[208:211], a[96:99], a[0:3]
    ds_read_b128 v[68:71], v19 offset:0
    v_add_f32_e64 v49, v49, v81
    v_mfma_f32_16x16x32_bf16 a[4:7], a[212:215], a[96:99], a[4:7]
    ds_read_b128 v[72:75], v18 offset:2048
    v_add_f32_e64 v50, v50, v82
    v_mfma_f32_16x16x32_bf16 a[8:11], a[216:219], a[96:99], a[8:11]
    ds_read_b128 v[76:79], v19 offset:2048
    v_add_f32 v51, v51, v83
    v_mfma_f32_16x16x32_bf16 a[12:15], a[220:223], a[96:99], a[12:15]
    v_add_f32 v52, v52, v84
    v_add_f32 v53, v53, v85
    s_waitcnt vmcnt(2)
    v_mfma_f32_16x16x32_bf16 a[0:3], a[224:227], a[100:103], a[0:3]
    v_add_f32 v54, v54, v86
    v_add_f32 v55, v55, v87
    v_mfma_f32_16x16x32_bf16 a[4:7], a[228:231], a[100:103], a[4:7]
    v_add_f32 v56, v56, v88
    v_add_f32 v57, v57, v89
    v_mfma_f32_16x16x32_bf16 a[8:11], a[232:235], a[100:103], a[8:11]
    v_add_f32 v58, v58, v90
    v_add_f32 v59, v59, v91
    v_mfma_f32_16x16x32_bf16 a[12:15], a[236:239], a[100:103], a[12:15]
    v_add_f32 v60, v60, v92
    v_add_f32 v61, v61, v93
    s_waitcnt vmcnt(1)
    v_mfma_f32_16x16x32_bf16 a[0:3], a[240:243], a[104:107], a[0:3]
    v_add_f32 v62, v62, v94
    v_add_f32_e64 v63, v63, v95
    v_mfma_f32_16x16x32_bf16 a[4:7], a[244:247], a[104:107], a[4:7]
    v_mfma_f32_16x16x32_bf16 a[8:11], a[248:251], a[104:107], a[8:11]
    s_waitcnt lgkmcnt(0)
    v_add_f32 v48, v48, v64
    v_mfma_f32_16x16x32_bf16 a[12:15], a[252:255], a[104:107], a[12:15]
    v_add_f32 v49, v49, v65
    v_add_f32 v50, v50, v66
    s_waitcnt vmcnt(0)
    v_mfma_f32_16x16x32_bf16 a[0:3], a[128:131], a[108:111], a[0:3]
    v_add_f32 v51, v51, v67
    v_add_f32 v52, v52, v68
    v_mfma_f32_16x16x32_bf16 a[4:7], a[132:135], a[108:111], a[4:7]
    v_add_f32 v53, v53, v69
    v_add_f32 v54, v54, v70
    v_mfma_f32_16x16x32_bf16 a[8:11], a[136:139], a[108:111], a[8:11]
    v_add_f32 v55, v55, v71
    v_add_f32_e64 v56, v56, v72
    v_mfma_f32_16x16x32_bf16 a[12:15], a[140:143], a[108:111], a[12:15]
    ds_write_b128 v34, a[0:3] offset:12288
    v_add_f32 v57, v57, v73
    v_add_f32 v58, v58, v74
    v_add_f32 v59, v59, v75
    v_add_f32 v60, v60, v76
    v_add_f32 v61, v61, v77
    v_add_f32 v62, v62, v78
L_pad_ffn_4:
    s_cbranch_execz L_ret_ffn
    v_add_f32 v63, v63, v79
    ds_write_b128 v35, a[4:7] offset:12288
    ds_write_b128 v34, a[8:11] offset:12416
    ds_write_b128 v35, a[12:15] offset:12416
    ds_read_b128 v[80:83], v15 offset:0
    ds_read_b128 v[84:87], v2 offset:0
    ds_read_b128 v[88:91], v15 offset:2048
    ds_read_b128 v[92:95], v2 offset:2048
    s_waitcnt lgkmcnt(2)
    v_pk_add_f32 v[48:49], v[48:49], v[80:81]
    v_pk_add_f32 v[50:51], v[50:51], v[82:83]
    v_pk_add_f32 v[52:53], v[52:53], v[84:85]
    v_pk_add_f32 v[54:55], v[54:55], v[86:87]
    v_cvt_pk_bf16_f32 v36, v48, v49
    v_cvt_pk_bf16_f32 v37, v50, v51
    v_cvt_pk_bf16_f32 v38, v52, v53
    v_cvt_pk_bf16_f32 v39, v54, v55
    buffer_store_dwordx4 v[36:39], v7, s[28:31], s91 offen sc1
    s_waitcnt lgkmcnt(0)
    v_pk_add_f32 v[56:57], v[56:57], v[88:89]
    v_pk_add_f32 v[58:59], v[58:59], v[90:91]
    v_pk_add_f32 v[60:61], v[60:61], v[92:93]
    v_pk_add_f32 v[62:63], v[62:63], v[94:95]
    v_cvt_pk_bf16_f32 v40, v56, v57
    v_cvt_pk_bf16_f32 v41, v58, v59
    v_cvt_pk_bf16_f32 v42, v60, v61
    v_cvt_pk_bf16_f32 v43, v62, v63
    buffer_store_dwordx4 v[40:43], v7, s[28:31], s71 offen sc1
    s_endpgm
L_retry_17:
    s_mov_b32 s72, 0
L_poll_18:
    s_and_b32 s70, s3, 1
    s_xor_b32 s70, s70, 0
    s_add_u32 s70, s70, s65
    s_and_b32 s70, s70, 3
    s_lshl_b32 s70, s70, 9
    s_add_u32 s70, s70, s69
    buffer_load_dwordx4 v[120:123], v10, s[16:19], s70 offen sc1
    s_and_b32 s70, s3, 1
    s_xor_b32 s70, s70, 1
    s_add_u32 s70, s70, s65
    s_and_b32 s70, s70, 3
    s_lshl_b32 s70, s70, 9
    s_add_u32 s70, s70, s69
    buffer_load_dwordx4 v[124:127], v10, s[16:19], s70 offen sc1
    s_add_u32 s72, s72, 1
    s_cmp_gt_u32 s72, 2000000
    s_cbranch_scc1 L_ok_19
    s_waitcnt vmcnt(0)
    v_xor_b32 v16, v8, v121
    v_xor_b32 v17, v8, v123
    v_xor_b32 v30, v8, v125
    v_xor_b32 v31, v8, v127
    v_or3_b32 v16, v16, v30, v31
    v_cmp_ne_u64 vcc, 0, v[16:17]
    s_nop 4
    s_cbranch_vccnz L_poll_18
    s_branch L_ok_19
L_retry_20:
    s_mov_b32 s72, 0
L_poll_21:
    s_add_u32 s70, s65, 2
    s_and_b32 s70, s70, 3
    s_lshl_b32 s70, s70, 9
    s_add_u32 s70, s70, s69
    buffer_load_dwordx4 v[128:131], v10, s[16:19], s70 offen sc1
    s_add_u32 s70, s65, 3
    s_and_b32 s70, s70, 3
    s_lshl_b32 s70, s70, 9
    s_add_u32 s70, s70, s69
    buffer_load_dwordx4 v[132:135], v10, s[16:19], s70 offen sc1
    s_add_u32 s72, s72, 1
    s_cmp_gt_u32 s72, 2000000
    s_cbranch_scc1 L_ok_22
    s_waitcnt vmcnt(0)
    v_xor_b32 v16, v8, v129
    v_xor_b32 v17, v8, v131
    v_xor_b32 v30, v8, v133
    v_xor_b32_e64 v31, v8, v135
    v_or3_b32 v16, v16, v30, v31
    v_cmp_ne_u64 vcc, 0, v[16:17]
    s_nop 4
    s_cbranch_vccnz L_poll_21
    s_branch L_ok_22
L_retry_23:
    s_mov_b32 s72, 0
L_poll_24:
    buffer_load_dwordx2 v[30:31], v32, s[16:19], s95 offen offset:0 sc1
    s_add_u32 s72, s72, 1
    s_cmp_gt_u32 s72, 2000000
    s_cbranch_scc1 L_ok_25
    s_waitcnt vmcnt(0)
    v_cmp_ne_u64 vcc, v[30:31], v[8:9]
    s_nop 4
    s_cbranch_vccnz L_poll_24
    s_branch L_ok_25
L_retry_26:
    s_mov_b32 s72, 0
L_poll_27:
    buffer_load_dwordx2 v[30:31], v32, s[16:19], s68 offen offset:0 sc1
    s_add_u32 s72, s72, 1
    s_cmp_gt_u32 s72, 2000000
    s_cbranch_scc1 L_ok_28
    s_waitcnt vmcnt(0)
    v_cmp_ne_u64 vcc, v[30:31], v[8:9]
    s_nop 4
    s_cbranch_vccnz L_poll_27
    s_branch L_ok_28
L_retry_29:
    s_mov_b32 s72, 0
L_poll_30:
    buffer_load_dwordx2 v[30:31], v32, s[16:19], s68 offen offset:256 sc1
    s_add_u32 s72, s72, 1
    s_cmp_gt_u32 s72, 2000000
    s_cbranch_scc1 L_ok_31
    s_waitcnt vmcnt(0)
    v_cmp_ne_u64 vcc, v[30:31], v[8:9]
    s_nop 4
    s_cbranch_vccnz L_poll_30
    s_branch L_ok_31
L_retry_32:
    s_mov_b32 s72, 0
L_poll_33:
    buffer_load_dwordx2 v[30:31], v32, s[16:19], s68 offen offset:512 sc1
    s_add_u32 s72, s72, 1
    s_cmp_gt_u32 s72, 2000000
    s_cbranch_scc1 L_ok_34
    s_waitcnt vmcnt(0)
    v_cmp_ne_u64 vcc, v[30:31], v[8:9]
    s_nop 4
    s_cbranch_vccnz L_poll_33
    s_branch L_ok_34
L_end:
    s_endpgm
.section .rodata,"a"
.p2align 6
.amdhsa_kernel parallel_sum__linear_kernel_hedgehog__dense_activation_gelu__prompt_kernel
  .amdhsa_next_free_vgpr 512
  .amdhsa_next_free_sgpr 102
  .amdhsa_accum_offset 256
  .amdhsa_group_segment_fixed_size 0
  .amdhsa_kernarg_size 96
  .amdhsa_user_sgpr_count 2
  .amdhsa_user_sgpr_kernarg_segment_ptr 1
  .amdhsa_system_sgpr_workgroup_id_x 1
  .amdhsa_float_denorm_mode_32 3
  .amdhsa_float_denorm_mode_16_64 3
  .amdhsa_ieee_mode 0
  .amdhsa_dx10_clamp 1
.end_amdhsa_kernel
```
